```python
import torch

def _softmax(x, axis=-1):
    return torch.softmax(x, dim=axis)
def _gelu(x):
    return torch.nn.functional.gelu(x, approximate="tanh")
def _silu(x):
    return torch.nn.functional.silu(x)
def _sigmoid(x):
    return torch.sigmoid(x)
def _layernorm(x, axis=-1, eps=1e-5):
    m = x.mean(dim=axis, keepdim=True)
    v = x.var(dim=axis, keepdim=True, unbiased=False)
    return (x - m) / torch.sqrt(v + eps)
def _scatter_add(tgt, idx, src, axis=0):
    return tgt.clone().index_add_(axis, idx, src)
def _segment_sum(src, seg, n):
    out = torch.zeros((n,) + src.shape[1:], dtype=src.dtype)
    return out.index_add_(0, seg, src)
def _pad(x, pw):
    flat = tuple(v for pair in reversed(pw) for v in pair)
    return torch.nn.functional.pad(x, flat)

kernel_name = 'recurrent_scan__sliding_block_cached__dense_activation_gelu__prompt'

def setup_inputs():

    _w = (lambda a: (lambda t: t.to(torch.bfloat16) if t.is_floating_point() else t)(torch.as_tensor(a)))
    def _A_setup():
        B, Sq, D = 1, 2048, 448
        Hq, Hkv, Sk, Dh = 16, 8, 2048, 256
        assert Hq % Hkv == 0, (Hq, Hkv)
        return {
            "x": _w((lambda *s: torch.randn(*s, dtype=torch.bfloat16) * 0.05)(B, Sq, D)),
            "k_cache": _w((lambda *s: torch.randn(*s, dtype=torch.bfloat16) * 3.2)(B, Hkv, Sk, Dh)),
            "v_cache": _w((lambda *s: torch.randn(*s, dtype=torch.bfloat16) * 3.2)(B, Hkv, Sk, Dh)),
            "wq": _w((lambda *s: torch.randn(*s, dtype=torch.bfloat16) * 3.2)(D, Hq * Dh) * (D ** -0.5)),
            "wo": _w((lambda *s: torch.randn(*s, dtype=torch.bfloat16) * 3.2)(Hq * Dh, D) * ((Hq * Dh) ** -0.5)),
        }
    _A_in = _A_setup()

    def _B_setup():
        B, S, D, F = 1, 2048, 448, 1792
        return {
            "x": _w((lambda *s: torch.randn(*s, dtype=torch.bfloat16) * 0.05)(B, S, D)),
            "w1": _w((lambda *s: torch.randn(*s, dtype=torch.bfloat16) * 3.2)(D, F) * (D ** -0.5)),
            "b1": _w((lambda *s: torch.randn(*s, dtype=torch.bfloat16) * 3.2)(F) * 0.01),
            "w2": _w((lambda *s: torch.randn(*s, dtype=torch.bfloat16) * 0.4)(F, D) * (F ** -0.5)),
            "b2": _w((lambda *s: torch.randn(*s, dtype=torch.bfloat16) * 0.4)(D) * 0.01),
        }
    _B_in = _B_setup()

    return {
        "A_x": _A_in["x"],
        "A_k_cache": _A_in["k_cache"],
        "A_v_cache": _A_in["v_cache"],
        "A_wq": _A_in["wq"],
        "A_wo": _A_in["wo"],
        "B_x": _B_in["x"],
        "B_w1": _B_in["w1"],
        "B_b1": _B_in["b1"],
        "B_w2": _B_in["w2"],
        "B_b2": _B_in["b2"],
    }

def reference(A_x, A_k_cache, A_v_cache, A_wq, A_wo, B_x, B_w1, B_b1, B_w2, B_b2):
    def _A_ref(x, k_cache, v_cache, wq, wo):
        B, Sq, D = x.shape
        Hq, Dh = 16, 256
        Hkv, Sk = k_cache.shape[1], k_cache.shape[2]
        W = min(4096, max(256, Sk // 4))
        rep = Hq // Hkv
        q = (lambda x, *d: x.permute(*d))((x @ wq).reshape(B, Sq, Hq, Dh), 0, 2, 1, 3)
        k = (lambda x, n, axis: torch.repeat_interleave(x, n, dim=axis))(k_cache[:, :, Sk - W:, :], rep, axis=1)
        v = (lambda x, n, axis: torch.repeat_interleave(x, n, dim=axis))(v_cache[:, :, Sk - W:, :], rep, axis=1)
        scores = torch.einsum("bhqd,bhkd->bhqk", q, k) * (Dh ** -0.5)
        p = _softmax(scores, axis=-1)
        o = torch.einsum("bhqk,bhkd->bhqd", p, v)
        return (lambda x, *d: x.permute(*d))(o, 0, 2, 1, 3).reshape(B, Sq, Hq * Dh) @ wo

    def _B_ref(x, w1, b1, w2, b2):
        h = torch.einsum("bsd,df->bsf", x, w1) + b1
        h = _gelu(h)
        return torch.einsum("bsf,fd->bsd", h, w2) + b2

    x = A_x
    xn = _layernorm(x, axis=-1)
    s = _A_ref(xn, A_k_cache, A_v_cache, A_wq, A_wo)
    g = _silu(_B_ref(xn, B_w1, B_b1, B_w2, B_b2))
    return x + s * g
```

```asm
; @launch grid=(256,1,1) block=(256,1,1) lds=163840
.amdgcn_target "amdgcn-amd-amdhsa--gfx950"
.text
.globl recurrent_scan__sliding_block_cached__dense_activation_gelu__prompt_kernel
.p2align 8
.type recurrent_scan__sliding_block_cached__dense_activation_gelu__prompt_kernel,@function
recurrent_scan__sliding_block_cached__dense_activation_gelu__prompt_kernel:
    s_cmp_ge_u32 s2, 256
    s_cbranch_scc1 L_k1_end
    s_load_dwordx16 s[8:23], s[0:1], 0
    s_load_dwordx8 s[24:31], s[0:1], 64
    s_load_dwordx2 s[32:33], s[0:1], 96
    s_memrealtime s[34:35]
    s_getpc_b64 s[72:73]
L_k1_pc:
    s_mov_b32 s74, L_code_end-L_k1_pc
    s_mov_b32 s75, 0x20000
    v_and_b32 v251, 63, v0
    v_lshrrev_b32 v189, 6, v0
    s_nop 0
    v_readfirstlane_b32 s76, v189
    s_lshr_b32 s83, s2, 3
    s_lshl_b32 s83, s83, 2
    s_add_u32 s83, s83, s76
    v_mov_b32 v203, 0x7f000000
    s_mul_i32 s86, s83, 5
    v_add_u32 v188, s86, v251
    v_lshlrev_b32 v188, 7, v188
    v_cmp_gt_u32 vcc, 5, v251
    s_nop 1
    v_cndmask_b32 v188, v203, v188, vcc
    buffer_load_dword v252, v188, s[72:75], 0 offen
    s_and_b32 s79, s2, 7
    s_lshr_b32 s80, s2, 3
    s_mov_b32 s89, s83
    s_and_b32 s77, s76, 1
    s_lshr_b32 s78, s76, 1
    s_lshl_b32 s81, s76, 12
    s_lshl_b32 s84, s76, 13
    v_lshrrev_b32 v193, 3, v251
    v_and_b32 v194, 7, v251
    v_lshlrev_b32 v194, 4, v194
    v_lshrrev_b32 v195, 4, v251
    v_mul_u32_u24 v191, 896, v193
    s_mul_i32 s86, s76, 14336
    v_add3_u32 v191, v191, v194, s86
    v_add_u32 v192, 7168, v191
    s_mul_i32 s86, s89, 28
    v_add_u32 v120, s86, v251
    v_lshlrev_b32 v120, 7, v120
    v_cmp_gt_u32 vcc, 28, v251
    s_nop 1
    v_cndmask_b32 v120, v203, v120, vcc
    v_and_b32 v197, 0x380, v120
    v_and_b32 v198, 0xfffffc00, v120
    v_lshl_add_u32 v198, v198, 3, v197
    v_cndmask_b32 v120, v203, v198, vcc
    s_mul_i32 s86, s89, 14
    v_add_u32 v121, s86, v251
    v_lshlrev_b32 v121, 7, v121
    v_cmp_gt_u32 vcc, 14, v251
    s_nop 1
    v_cndmask_b32 v121, v203, v121, vcc
    v_and_b32 v197, 0x180, v121
    v_lshrrev_b32 v198, 9, v121
    v_mul_u32_u24 v198, 3584, v198
    v_add_u32 v198, v198, v197
    v_cndmask_b32 v121, v203, v198, vcc
    s_mul_i32 s86, s89, 2
    v_add_u32 v122, s86, v251
    v_lshlrev_b32 v122, 7, v122
    v_cmp_gt_u32 vcc, 2, v251
    s_nop 1
    v_cndmask_b32 v122, v203, v122, vcc
    v_and_b32 v197, 0x380, v122
    v_and_b32 v198, 0xfffffc00, v122
    v_lshl_add_u32 v198, v198, 3, v197
    v_cndmask_b32 v122, v203, v198, vcc
    s_mul_i32 s86, s89, 8
    v_add_u32 v123, s86, v251
    v_lshlrev_b32 v123, 7, v123
    v_cmp_gt_u32 vcc, 8, v251
    s_nop 1
    v_cndmask_b32 v123, v203, v123, vcc
    v_and_b32 v197, 0x180, v123
    v_lshrrev_b32 v198, 9, v123
    v_mul_u32_u24 v198, 3584, v198
    v_add_u32 v198, v198, v197
    v_cndmask_b32 v123, v203, v198, vcc
    v_lshlrev_b32 v125, 3, v195
    s_lshl_b32 s86, s76, 5
    v_add_u32 v124, s86, v125
    s_lshl_b32 s86, s78, 5
    v_add_u32 v125, s86, v125
    v_and_b32 v126, 15, v251
    v_mul_u32_u24 v126, 896, v126
    v_lshl_add_u32 v126, v195, 7, v126
    s_mul_i32 s86, s76, 14336
    s_add_u32 s86, s86, 896
    v_add_u32 v126, s86, v126
    v_cmp_gt_u32 vcc, 0, v251
    s_nop 1
    v_cndmask_b32 v126, v203, v126, vcc
    s_mul_i32 s87, s80, 57344
    s_waitcnt lgkmcnt(0)
    s_add_u32 s36, s8, s87
    s_addc_u32 s37, s9, 0
    s_mov_b32 s38, 57344
    s_mov_b32 s39, 0x20000
    s_lshl_b32 s86, s79, 10
    s_add_u32 s40, s14, s86
    s_addc_u32 s41, s15, 0
    s_sub_u32 s42, 3670016, s86
    s_mov_b32 s43, 0x20000
    s_mul_i32 s86, s79, 448
    s_add_u32 s44, s20, s86
    s_addc_u32 s45, s21, 0
    s_sub_u32 s46, 1605632, s86
    s_mov_b32 s47, 0x20000
    s_add_u32 s68, s22, s86
    s_addc_u32 s69, s23, 0
    s_mov_b32 s70, 448
    s_mov_b32 s71, 0x20000
    buffer_load_dword v252, v122, s[40:43], 0 offen
    buffer_load_dword v252, v123, s[44:47], 0 offen
    buffer_load_dwordx2 v[0:1], v124, s[68:71], 0 offen offset:0
    buffer_load_dwordx2 v[2:3], v124, s[68:71], 0 offen offset:128
    buffer_load_dwordx2 v[4:5], v124, s[68:71], 0 offen offset:256
    buffer_load_dwordx2 v[6:7], v125, s[68:71], 0 offen offset:384
    buffer_load_dwordx4 v[128:131], v191, s[36:39], 0 offen offset:0
    buffer_load_dwordx4 v[156:159], v192, s[36:39], 0 offen offset:0
    buffer_load_dwordx4 v[132:135], v191, s[36:39], 0 offen offset:128
    buffer_load_dwordx4 v[160:163], v192, s[36:39], 0 offen offset:128
    buffer_load_dwordx4 v[136:139], v191, s[36:39], 0 offen offset:256
    buffer_load_dwordx4 v[164:167], v192, s[36:39], 0 offen offset:256
    buffer_load_dwordx4 v[140:143], v191, s[36:39], 0 offen offset:384
    buffer_load_dwordx4 v[168:171], v192, s[36:39], 0 offen offset:384
    buffer_load_dwordx4 v[144:147], v191, s[36:39], 0 offen offset:512
    buffer_load_dwordx4 v[172:175], v192, s[36:39], 0 offen offset:512
    buffer_load_dwordx4 v[148:151], v191, s[36:39], 0 offen offset:640
    buffer_load_dwordx4 v[176:179], v192, s[36:39], 0 offen offset:640
    buffer_load_dwordx4 v[152:155], v191, s[36:39], 0 offen offset:768
    buffer_load_dwordx4 v[180:183], v192, s[36:39], 0 offen offset:768
    s_lshl_b32 s87, s76, 8
    v_and_b32 v196, 1, v195
    v_lshlrev_b32 v196, 5, v196
    v_xor_b32 v196, v196, v194
    v_xor_b32 v197, 64, v196
    v_lshlrev_b32 v198, 13, v193
    v_add_u32 v198, s87, v198
    v_add_u32 v204, v198, v196
    v_add_u32 v205, v198, v197
    v_add_u32 v205, 64512, v205
    v_add_u32 v206, v198, v196
    v_add_u32 v206, 129024, v206
    v_add_u32 v207, v198, v197
    v_add_u32 v207, 193536, v207
    s_lshl_b32 s87, s76, 7
    v_mul_u32_u24 v198, 3584, v193
    v_add_u32 v198, s87, v198
    s_cmp_eq_u32 s76, 3
    s_cselect_b32 s86, 0x1000000, 0
    v_and_b32 v199, 64, v196
    v_mul_lo_u32 v199, v199, s86
    v_add3_u32 v208, v198, v196, v199
    v_and_b32 v199, 64, v197
    v_mul_lo_u32 v199, v199, s86
    v_add3_u32 v209, v198, v197, v199
    v_add_u32 v209, 27648, v209
    v_and_b32 v199, 64, v196
    v_mul_lo_u32 v199, v199, s86
    v_add3_u32 v210, v198, v196, v199
    v_add_u32 v210, 55296, v210
    v_and_b32 v199, 64, v197
    v_mul_lo_u32 v199, v199, s86
    v_add3_u32 v211, v198, v197, v199
    v_add_u32 v211, 82944, v211
    v_lshlrev_b32 v198, 9, v193
    v_add_u32 v198, s87, v198
    v_lshlrev_b32 v199, 4, v195
    v_xor_b32 v199, v199, v194
    v_xad_u32 v212, v199, 0, v198
    v_xad_u32 v213, v199, 64, v198
    v_add_u32 v213, 3072, v213
    v_xad_u32 v214, v199, 0, v198
    v_add_u32 v214, 6144, v214
    v_xad_u32 v215, v199, 64, v198
    v_add_u32 v215, 9216, v215
    v_lshlrev_b32 v199, 5, v195
    v_xor_b32 v199, v199, v194
    v_add_u32 v216, v198, v199
    v_add_u32 v217, 3072, v216
    v_add_u32 v218, 6144, v216
    v_add_u32 v219, 9216, v216
    v_mul_u32_u24 v198, 896, v193
    s_mul_i32 s86, s76, 28672
    v_add3_u32 v220, v198, v199, s86
    v_add_u32 v221, 6144, v220
    v_add_u32 v222, 12288, v220
    v_add_u32 v223, 18432, v220
    v_bfe_u32 v196, v251, 2, 2
    v_and_b32 v197, 3, v251
    v_lshlrev_b32 v197, 3, v197
    v_and_b32 v198, 1, v195
    v_lshlrev_b32 v198, 6, v198
    v_lshrrev_b32 v199, 1, v196
    v_lshl_or_b32 v198, v199, 5, v198
    v_lshl_or_b32 v197, v196, 7, v197
    v_or_b32 v197, v197, v198
    v_lshl_add_u32 v190, v195, 10, v197
    v_lshlrev_b32 v250, 9, v195
    v_sub_u32 v249, v190, v250
    v_and_b32 v196, 0xffffffe7, v190
    v_and_b32 v197, 1, v251
    v_lshl_or_b32 v196, v197, 4, v196
    v_and_b32 v197, 2, v251
    v_lshlrev_b32 v197, 4, v197
    v_xor_b32 v196, v196, v197
    v_add_u32 v196, s84, v196
    v_xor_b32 v224, 0, v196
    v_add_u32 v225, 65536, v224
    v_xor_b32 v226, 8, v196
    v_add_u32 v227, 65536, v226
    v_xor_b32 v228, 64, v196
    v_add_u32 v229, 65536, v228
    v_xor_b32 v230, 72, v196
    v_add_u32 v231, 65536, v230
    s_lshl_b32 s86, s76, 5
    s_lshl_b32 s87, s78, 5
    v_xor_b32 v232, s86, v190
    v_add_u32 v233, 65536, v232
    v_add_u32 v234, 131072, v232
    v_xor_b32 v235, s87, v190
    v_add_u32 v236, 65536, v235
    v_and_b32 v196, 15, v251
    v_lshrrev_b32 v197, 1, v196
    v_xor_b32 v197, v197, v195
    v_lshlrev_b32 v197, 4, v197
    v_lshl_or_b32 v238, v196, 7, v197
    v_xor_b32 v240, 64, v238
    v_add_u32 v239, 65536, v238
    v_add_u32 v241, 65536, v240
    v_lshrrev_b32 v197, 2, v196
    v_sub_u32 v197, 0, v197
    v_and_b32 v197, 3, v197
    v_xor_b32 v197, v197, v195
    v_lshlrev_b32 v197, 4, v197
    v_lshl_or_b32 v197, v196, 6, v197
    s_lshl_b32 s86, s77, 11
    s_add_u32 s86, s86, 106496
    v_add_u32 v243, s86, v197
    v_xor_b32 v244, 2048, v243
    v_lshrrev_b32 v197, 5, v251
    v_sub_u32 v197, 0, v197
    v_and_b32 v197, 3, v197
    v_and_b32 v198, 3, v251
    v_xor_b32 v197, v197, v198
    v_lshlrev_b32 v197, 4, v197
    v_lshl_or_b32 v197, v193, 6, v197
    v_bfe_u32 v198, v251, 2, 1
    v_lshl_or_b32 v197, v198, 12, v197
    s_lshl_b32 s86, s76, 10
    s_add_u32 s86, s86, 106496
    v_add_u32 v242, s86, v197
    v_xor_b32 v200, 32, v242
    v_add_u32 v200, 512, v200
    v_lshlrev_b32 v253, 4, v251
    v_add_u32 v245, 131072, v253
    v_mov_b32 v184, 0x3f803f80
    v_mov_b32 v185, 0x3f803f80
    v_mov_b32 v186, 0x3f803f80
    v_mov_b32 v187, 0x3f803f80
    s_lshl_b32 s86, s79, 20
    s_add_u32 s86, s86, 786432
    s_add_u32 s48, s10, s86
    s_addc_u32 s49, s11, 0
    s_mov_b32 s50, 262144
    s_mov_b32 s51, 0x20000
    s_add_u32 s52, s12, s86
    s_addc_u32 s53, s13, 0
    s_mov_b32 s54, 262144
    s_mov_b32 s55, 0x20000
    s_mul_i32 s86, s79, 458752
    s_add_u32 s56, s16, s86
    s_addc_u32 s57, s17, 0
    s_mov_b32 s58, 458752
    s_mov_b32 s59, 0x20000
    s_mul_i32 s86, s79, 200704
    s_add_u32 s60, s24, s86
    s_addc_u32 s61, s25, 0
    s_mov_b32 s62, 200704
    s_mov_b32 s63, 0x20000
    s_mul_i32 s86, s79, 1835008
    s_add_u32 s64, s32, s86
    s_addc_u32 s65, s33, 0
    s_mov_b32 s66, 16515072
    s_mov_b32 s67, 0x20000
    s_mov_b32 s85, 0xc30c6bf3
    v_mov_b32 v248, 0xc1cc422a
    s_waitcnt vmcnt(14)
    v_lshlrev_b32 v196, 16, v0
    v_and_b32 v197, 0xffff0000, v0
    v_lshlrev_b32 v198, 16, v1
    v_and_b32 v199, 0xffff0000, v1
    v_mul_f32 v196, 0x3db8aa3b, v196
    v_mul_f32 v197, 0x3db8aa3b, v197
    v_mul_f32 v198, 0x3db8aa3b, v198
    v_mul_f32 v199, 0x3db8aa3b, v199
    v_accvgpr_write_b32 a64, v196
    v_accvgpr_write_b32 a65, v197
    v_accvgpr_write_b32 a66, v198
    v_accvgpr_write_b32 a67, v199
    v_accvgpr_write_b32 a68, v196
    v_accvgpr_write_b32 a69, v197
    v_accvgpr_write_b32 a70, v198
    v_accvgpr_write_b32 a71, v199
    v_accvgpr_write_b32 a72, v196
    v_accvgpr_write_b32 a73, v197
    v_accvgpr_write_b32 a74, v198
    v_accvgpr_write_b32 a75, v199
    v_accvgpr_write_b32 a76, v196
    v_accvgpr_write_b32 a77, v197
    v_accvgpr_write_b32 a78, v198
    v_accvgpr_write_b32 a79, v199
    v_lshlrev_b32 v196, 16, v2
    v_and_b32 v197, 0xffff0000, v2
    v_lshlrev_b32 v198, 16, v3
    v_and_b32 v199, 0xffff0000, v3
    v_mul_f32 v196, 0x3db8aa3b, v196
    v_mul_f32 v197, 0x3db8aa3b, v197
    v_mul_f32 v198, 0x3db8aa3b, v198
    v_mul_f32 v199, 0x3db8aa3b, v199
    v_accvgpr_write_b32 a80, v196
    v_accvgpr_write_b32 a81, v197
    v_accvgpr_write_b32 a82, v198
    v_accvgpr_write_b32 a83, v199
    v_accvgpr_write_b32 a84, v196
    v_accvgpr_write_b32 a85, v197
    v_accvgpr_write_b32 a86, v198
    v_accvgpr_write_b32 a87, v199
    v_accvgpr_write_b32 a88, v196
    v_accvgpr_write_b32 a89, v197
    v_accvgpr_write_b32 a90, v198
    v_accvgpr_write_b32 a91, v199
    v_accvgpr_write_b32 a92, v196
    v_accvgpr_write_b32 a93, v197
    v_accvgpr_write_b32 a94, v198
    v_accvgpr_write_b32 a95, v199
    v_lshlrev_b32 v196, 16, v4
    v_and_b32 v197, 0xffff0000, v4
    v_lshlrev_b32 v198, 16, v5
    v_and_b32 v199, 0xffff0000, v5
    v_mul_f32 v196, 0x3db8aa3b, v196
    v_mul_f32 v197, 0x3db8aa3b, v197
    v_mul_f32 v198, 0x3db8aa3b, v198
    v_mul_f32 v199, 0x3db8aa3b, v199
    v_accvgpr_write_b32 a96, v196
    v_accvgpr_write_b32 a97, v197
    v_accvgpr_write_b32 a98, v198
    v_accvgpr_write_b32 a99, v199
    v_accvgpr_write_b32 a100, v196
    v_accvgpr_write_b32 a101, v197
    v_accvgpr_write_b32 a102, v198
    v_accvgpr_write_b32 a103, v199
    v_accvgpr_write_b32 a104, v196
    v_accvgpr_write_b32 a105, v197
    v_accvgpr_write_b32 a106, v198
    v_accvgpr_write_b32 a107, v199
    v_accvgpr_write_b32 a108, v196
    v_accvgpr_write_b32 a109, v197
    v_accvgpr_write_b32 a110, v198
    v_accvgpr_write_b32 a111, v199
    v_lshlrev_b32 v196, 16, v6
    v_and_b32 v197, 0xffff0000, v6
    v_lshlrev_b32 v198, 16, v7
    v_and_b32 v199, 0xffff0000, v7
    v_mul_f32 v196, 0x3db8aa3b, v196
    v_mul_f32 v197, 0x3db8aa3b, v197
    v_mul_f32 v198, 0x3db8aa3b, v198
    v_mul_f32 v199, 0x3db8aa3b, v199
    v_accvgpr_write_b32 a112, v196
    v_accvgpr_write_b32 a113, v197
    v_accvgpr_write_b32 a114, v198
    v_accvgpr_write_b32 a115, v199
    v_accvgpr_write_b32 a116, v196
    v_accvgpr_write_b32 a117, v197
    v_accvgpr_write_b32 a118, v198
    v_accvgpr_write_b32 a119, v199
    v_mov_b32 v196, 0
    v_mov_b32 v197, 0
    v_mov_b32 v198, 0
    v_mov_b32 v199, 0
    s_waitcnt vmcnt(12)
    v_dot2_f32_bf16 v196, v128, v184, v196
    v_dot2_f32_bf16 v198, v128, v128, v198
    v_dot2_f32_bf16 v197, v156, v184, v197
    v_dot2_f32_bf16 v199, v156, v156, v199
    v_dot2_f32_bf16 v196, v129, v184, v196
    v_dot2_f32_bf16 v198, v129, v129, v198
    v_dot2_f32_bf16 v197, v157, v184, v197
    v_dot2_f32_bf16 v199, v157, v157, v199
    v_dot2_f32_bf16 v196, v130, v184, v196
    v_dot2_f32_bf16 v198, v130, v130, v198
    v_dot2_f32_bf16 v197, v158, v184, v197
    v_dot2_f32_bf16 v199, v158, v158, v199
    v_dot2_f32_bf16 v196, v131, v184, v196
    v_dot2_f32_bf16 v198, v131, v131, v198
    v_dot2_f32_bf16 v197, v159, v184, v197
    v_dot2_f32_bf16 v199, v159, v159, v199
    s_waitcnt vmcnt(10)
    v_dot2_f32_bf16 v196, v132, v184, v196
    v_dot2_f32_bf16 v198, v132, v132, v198
    v_dot2_f32_bf16 v197, v160, v184, v197
    v_dot2_f32_bf16 v199, v160, v160, v199
    v_dot2_f32_bf16 v196, v133, v184, v196
    v_dot2_f32_bf16 v198, v133, v133, v198
    v_dot2_f32_bf16 v197, v161, v184, v197
    v_dot2_f32_bf16 v199, v161, v161, v199
    v_dot2_f32_bf16 v196, v134, v184, v196
    v_dot2_f32_bf16 v198, v134, v134, v198
    v_dot2_f32_bf16 v197, v162, v184, v197
    v_dot2_f32_bf16 v199, v162, v162, v199
    v_dot2_f32_bf16 v196, v135, v184, v196
    v_dot2_f32_bf16 v198, v135, v135, v198
    v_dot2_f32_bf16 v197, v163, v184, v197
    v_dot2_f32_bf16 v199, v163, v163, v199
    s_waitcnt vmcnt(8)
    v_dot2_f32_bf16 v196, v136, v184, v196
    v_dot2_f32_bf16 v198, v136, v136, v198
    v_dot2_f32_bf16 v197, v164, v184, v197
    v_dot2_f32_bf16 v199, v164, v164, v199
    v_dot2_f32_bf16 v196, v137, v184, v196
    v_dot2_f32_bf16 v198, v137, v137, v198
    v_dot2_f32_bf16 v197, v165, v184, v197
    v_dot2_f32_bf16 v199, v165, v165, v199
    v_dot2_f32_bf16 v196, v138, v184, v196
    v_dot2_f32_bf16 v198, v138, v138, v198
    v_dot2_f32_bf16 v197, v166, v184, v197
    v_dot2_f32_bf16 v199, v166, v166, v199
    v_dot2_f32_bf16 v196, v139, v184, v196
    v_dot2_f32_bf16 v198, v139, v139, v198
    v_dot2_f32_bf16 v197, v167, v184, v197
    v_dot2_f32_bf16 v199, v167, v167, v199
    s_waitcnt vmcnt(6)
    v_dot2_f32_bf16 v196, v140, v184, v196
    v_dot2_f32_bf16 v198, v140, v140, v198
    v_dot2_f32_bf16 v197, v168, v184, v197
    v_dot2_f32_bf16 v199, v168, v168, v199
    v_dot2_f32_bf16 v196, v141, v184, v196
    v_dot2_f32_bf16 v198, v141, v141, v198
    v_dot2_f32_bf16 v197, v169, v184, v197
    v_dot2_f32_bf16 v199, v169, v169, v199
    v_dot2_f32_bf16 v196, v142, v184, v196
    v_dot2_f32_bf16 v198, v142, v142, v198
    v_dot2_f32_bf16 v197, v170, v184, v197
    v_dot2_f32_bf16 v199, v170, v170, v199
    v_dot2_f32_bf16 v196, v143, v184, v196
    v_dot2_f32_bf16 v198, v143, v143, v198
    v_dot2_f32_bf16 v197, v171, v184, v197
    v_dot2_f32_bf16 v199, v171, v171, v199
    s_waitcnt vmcnt(4)
    v_dot2_f32_bf16 v196, v144, v184, v196
    v_dot2_f32_bf16 v198, v144, v144, v198
    v_dot2_f32_bf16 v197, v172, v184, v197
    v_dot2_f32_bf16 v199, v172, v172, v199
    v_dot2_f32_bf16 v196, v145, v184, v196
    v_dot2_f32_bf16 v198, v145, v145, v198
    v_dot2_f32_bf16 v197, v173, v184, v197
    v_dot2_f32_bf16 v199, v173, v173, v199
    v_dot2_f32_bf16 v196, v146, v184, v196
    v_dot2_f32_bf16 v198, v146, v146, v198
    v_dot2_f32_bf16 v197, v174, v184, v197
    v_dot2_f32_bf16 v199, v174, v174, v199
    v_dot2_f32_bf16 v196, v147, v184, v196
    v_dot2_f32_bf16 v198, v147, v147, v198
    v_dot2_f32_bf16 v197, v175, v184, v197
    v_dot2_f32_bf16 v199, v175, v175, v199
    s_waitcnt vmcnt(2)
    v_dot2_f32_bf16 v196, v148, v184, v196
    v_dot2_f32_bf16 v198, v148, v148, v198
    v_dot2_f32_bf16 v197, v176, v184, v197
    v_dot2_f32_bf16 v199, v176, v176, v199
    v_dot2_f32_bf16 v196, v149, v184, v196
    v_dot2_f32_bf16 v198, v149, v149, v198
    v_dot2_f32_bf16 v197, v177, v184, v197
    v_dot2_f32_bf16 v199, v177, v177, v199
    v_dot2_f32_bf16 v196, v150, v184, v196
    v_dot2_f32_bf16 v198, v150, v150, v198
    v_dot2_f32_bf16 v197, v178, v184, v197
    v_dot2_f32_bf16 v199, v178, v178, v199
    v_dot2_f32_bf16 v196, v151, v184, v196
    v_dot2_f32_bf16 v198, v151, v151, v198
    v_dot2_f32_bf16 v197, v179, v184, v197
    v_dot2_f32_bf16 v199, v179, v179, v199
    s_waitcnt vmcnt(0)
    v_dot2_f32_bf16 v196, v152, v184, v196
    v_dot2_f32_bf16 v198, v152, v152, v198
    v_dot2_f32_bf16 v197, v180, v184, v197
    v_dot2_f32_bf16 v199, v180, v180, v199
    v_dot2_f32_bf16 v196, v153, v184, v196
    v_dot2_f32_bf16 v198, v153, v153, v198
    v_dot2_f32_bf16 v197, v181, v184, v197
    v_dot2_f32_bf16 v199, v181, v181, v199
    v_dot2_f32_bf16 v196, v154, v184, v196
    v_dot2_f32_bf16 v198, v154, v154, v198
    v_dot2_f32_bf16 v197, v182, v184, v197
    v_dot2_f32_bf16 v199, v182, v182, v199
    v_dot2_f32_bf16 v196, v155, v184, v196
    s_add_u32 m0, s81, 0
    s_mov_b32 s82, 0
    buffer_load_dwordx4 v208, s[44:47], s82 offen offset:0 lds
    v_dot2_f32_bf16 v198, v155, v155, v198
    v_dot2_f32_bf16 v197, v183, v184, v197
    v_dot2_f32_bf16 v199, v183, v183, v199
    v_add_f32_dpp v196, v196, v196 quad_perm:[1,0,3,2] row_mask:0xf bank_mask:0xf
    s_nop 0
    v_add_f32_dpp v197, v197, v197 quad_perm:[1,0,3,2] row_mask:0xf bank_mask:0xf
    v_add_f32_dpp v198, v198, v198 quad_perm:[1,0,3,2] row_mask:0xf bank_mask:0xf
    v_add_f32_dpp v199, v199, v199 quad_perm:[1,0,3,2] row_mask:0xf bank_mask:0xf
    v_add_f32_dpp v196, v196, v196 quad_perm:[2,3,0,1] row_mask:0xf bank_mask:0xf
    v_add_f32_dpp v197, v197, v197 quad_perm:[2,3,0,1] row_mask:0xf bank_mask:0xf
    v_add_f32_dpp v198, v198, v198 quad_perm:[2,3,0,1] row_mask:0xf bank_mask:0xf
    v_add_f32_dpp v199, v199, v199 quad_perm:[2,3,0,1] row_mask:0xf bank_mask:0xf
    v_add_f32_dpp v196, v196, v196 row_half_mirror row_mask:0xf bank_mask:0xf
    v_add_f32_dpp v197, v197, v197 row_half_mirror row_mask:0xf bank_mask:0xf
    v_add_f32_dpp v198, v198, v198 row_half_mirror row_mask:0xf bank_mask:0xf
    buffer_load_dwordx4 v209, s[44:47], s82 offen offset:1024 lds
    v_add_f32_dpp v199, v199, v199 row_half_mirror row_mask:0xf bank_mask:0xf
    v_mul_f32 v196, 0x3b124925, v196
    v_mul_f32 v197, 0x3b124925, v197
    v_mul_f32 v198, 0x3b124925, v198
    v_mul_f32 v199, 0x3b124925, v199
    v_fma_f32 v198, -v196, v196, v198
    v_fma_f32 v199, -v197, v197, v199
    v_max_f32 v198, 0, v198
    v_max_f32 v199, 0, v199
    v_add_f32 v198, 0x3727c5ac, v198
    v_add_f32 v199, 0x3727c5ac, v199
    v_rsq_f32 v198, v198
    v_rsq_f32 v199, v199
    v_mul_f32 v112, 0x3db8aa3b, v198
    buffer_load_dwordx4 v210, s[44:47], s82 offen offset:2048 lds
    v_mul_f32 v113, 0x3db8aa3b, v198
    v_mul_f32 v116, 0x3db8aa3b, v199
    v_mul_f32 v117, 0x3db8aa3b, v199
    v_mul_f32_e64 v114, -v196, v112
    v_mul_f32_e64 v115, -v196, v112
    v_mul_f32_e64 v118, -v197, v116
    v_mul_f32_e64 v119, -v197, v116
    v_lshlrev_b32 v188, 16, v128
    v_and_b32 v189, 0xffff0000, v128
    v_pk_fma_f32 v[188:189], v[188:189], v[112:113], v[114:115]
    v_cvt_pk_bf16_f32 v128, v188, v189
    v_lshlrev_b32 v190, 16, v129
    v_and_b32 v191, 0xffff0000, v129
    v_pk_fma_f32 v[190:191], v[190:191], v[112:113], v[114:115]
    buffer_load_dwordx4 v211, s[44:47], s82 offen offset:3072 lds
    v_cvt_pk_bf16_f32 v129, v190, v191
    v_lshlrev_b32 v188, 16, v130
    v_and_b32 v189, 0xffff0000, v130
    v_pk_fma_f32 v[188:189], v[188:189], v[112:113], v[114:115]
    v_cvt_pk_bf16_f32 v130, v188, v189
    v_lshlrev_b32 v190, 16, v131
    v_and_b32 v191, 0xffff0000, v131
    v_pk_fma_f32 v[190:191], v[190:191], v[112:113], v[114:115]
    v_cvt_pk_bf16_f32 v131, v190, v191
    ds_write_b128 v242, v[128:131] offset:0
    v_lshlrev_b32 v188, 16, v156
    v_and_b32 v189, 0xffff0000, v156
    v_pk_fma_f32 v[188:189], v[188:189], v[116:117], v[118:119]
    v_cvt_pk_bf16_f32 v156, v188, v189
    s_add_u32 m0, s81, 16384
    s_mov_b32 s82, 114688
    buffer_load_dwordx4 v208, s[44:47], s82 offen offset:0 lds
    v_lshlrev_b32 v190, 16, v157
    v_and_b32 v191, 0xffff0000, v157
    v_pk_fma_f32 v[190:191], v[190:191], v[116:117], v[118:119]
    v_cvt_pk_bf16_f32 v157, v190, v191
    v_lshlrev_b32 v188, 16, v158
    v_and_b32 v189, 0xffff0000, v158
    v_pk_fma_f32 v[188:189], v[188:189], v[116:117], v[118:119]
    v_cvt_pk_bf16_f32 v158, v188, v189
    v_lshlrev_b32 v190, 16, v159
    v_and_b32 v191, 0xffff0000, v159
    v_pk_fma_f32 v[190:191], v[190:191], v[116:117], v[118:119]
    v_cvt_pk_bf16_f32 v159, v190, v191
    ds_write_b128 v200, v[156:159] offset:0
    v_lshlrev_b32 v188, 16, v132
    buffer_load_dwordx4 v209, s[44:47], s82 offen offset:1024 lds
    v_and_b32 v189, 0xffff0000, v132
    v_pk_fma_f32 v[188:189], v[188:189], v[112:113], v[114:115]
    v_cvt_pk_bf16_f32 v132, v188, v189
    v_lshlrev_b32 v190, 16, v133
    v_and_b32 v191, 0xffff0000, v133
    v_pk_fma_f32 v[190:191], v[190:191], v[112:113], v[114:115]
    v_cvt_pk_bf16_f32 v133, v190, v191
    v_lshlrev_b32 v188, 16, v134
    v_and_b32 v189, 0xffff0000, v134
    v_pk_fma_f32 v[188:189], v[188:189], v[112:113], v[114:115]
    v_cvt_pk_bf16_f32 v134, v188, v189
    v_lshlrev_b32 v190, 16, v135
    v_and_b32 v191, 0xffff0000, v135
    v_pk_fma_f32 v[190:191], v[190:191], v[112:113], v[114:115]
    buffer_load_dwordx4 v210, s[44:47], s82 offen offset:2048 lds
    v_cvt_pk_bf16_f32 v135, v190, v191
    ds_write_b128 v242, v[132:135] offset:8192
    v_lshlrev_b32 v188, 16, v160
    v_and_b32 v189, 0xffff0000, v160
    v_pk_fma_f32 v[188:189], v[188:189], v[116:117], v[118:119]
    v_cvt_pk_bf16_f32 v160, v188, v189
    v_lshlrev_b32 v190, 16, v161
    v_and_b32 v191, 0xffff0000, v161
    v_pk_fma_f32 v[190:191], v[190:191], v[116:117], v[118:119]
    v_cvt_pk_bf16_f32 v161, v190, v191
    v_lshlrev_b32 v188, 16, v162
    v_and_b32 v189, 0xffff0000, v162
    v_pk_fma_f32 v[188:189], v[188:189], v[116:117], v[118:119]
    v_cvt_pk_bf16_f32 v162, v188, v189
    buffer_load_dwordx4 v211, s[44:47], s82 offen offset:3072 lds
    v_lshlrev_b32 v190, 16, v163
    v_and_b32 v191, 0xffff0000, v163
    v_pk_fma_f32 v[190:191], v[190:191], v[116:117], v[118:119]
    v_cvt_pk_bf16_f32 v163, v190, v191
    ds_write_b128 v200, v[160:163] offset:8192
    v_lshlrev_b32 v188, 16, v136
    v_and_b32 v189, 0xffff0000, v136
    v_pk_fma_f32 v[188:189], v[188:189], v[112:113], v[114:115]
    v_cvt_pk_bf16_f32 v136, v188, v189
    v_lshlrev_b32 v190, 16, v137
    v_and_b32 v191, 0xffff0000, v137
    v_pk_fma_f32 v[190:191], v[190:191], v[112:113], v[114:115]
    v_cvt_pk_bf16_f32 v137, v190, v191
    v_lshlrev_b32 v188, 16, v138
    s_add_u32 m0, s81, 32768
    s_mov_b32 s82, 229376
    buffer_load_dwordx4 v208, s[44:47], s82 offen offset:0 lds
    v_and_b32 v189, 0xffff0000, v138
    v_pk_fma_f32 v[188:189], v[188:189], v[112:113], v[114:115]
    v_cvt_pk_bf16_f32 v138, v188, v189
    v_lshlrev_b32 v190, 16, v139
    v_and_b32 v191, 0xffff0000, v139
    v_pk_fma_f32 v[190:191], v[190:191], v[112:113], v[114:115]
    v_cvt_pk_bf16_f32 v139, v190, v191
    ds_write_b128 v242, v[136:139] offset:16384
    v_lshlrev_b32 v188, 16, v164
    v_and_b32 v189, 0xffff0000, v164
    v_pk_fma_f32 v[188:189], v[188:189], v[116:117], v[118:119]
    v_cvt_pk_bf16_f32 v164, v188, v189
    v_lshlrev_b32 v190, 16, v165
    v_and_b32 v191, 0xffff0000, v165
    buffer_load_dwordx4 v209, s[44:47], s82 offen offset:1024 lds
    v_pk_fma_f32 v[190:191], v[190:191], v[116:117], v[118:119]
    v_cvt_pk_bf16_f32 v165, v190, v191
    v_lshlrev_b32 v188, 16, v166
    v_and_b32 v189, 0xffff0000, v166
    v_pk_fma_f32 v[188:189], v[188:189], v[116:117], v[118:119]
    v_cvt_pk_bf16_f32 v166, v188, v189
    v_lshlrev_b32 v190, 16, v167
    v_and_b32 v191, 0xffff0000, v167
    v_pk_fma_f32 v[190:191], v[190:191], v[116:117], v[118:119]
    v_cvt_pk_bf16_f32 v167, v190, v191
    ds_write_b128 v200, v[164:167] offset:16384
    v_lshlrev_b32 v188, 16, v140
    v_and_b32 v189, 0xffff0000, v140
    v_pk_fma_f32 v[188:189], v[188:189], v[112:113], v[114:115]
    buffer_load_dwordx4 v210, s[44:47], s82 offen offset:2048 lds
    v_cvt_pk_bf16_f32 v140, v188, v189
    v_lshlrev_b32 v190, 16, v141
    v_and_b32 v191, 0xffff0000, v141
    v_pk_fma_f32 v[190:191], v[190:191], v[112:113], v[114:115]
    v_cvt_pk_bf16_f32 v141, v190, v191
    v_lshlrev_b32 v188, 16, v142
    v_and_b32 v189, 0xffff0000, v142
    v_pk_fma_f32 v[188:189], v[188:189], v[112:113], v[114:115]
    v_cvt_pk_bf16_f32 v142, v188, v189
    v_lshlrev_b32 v190, 16, v143
    v_and_b32 v191, 0xffff0000, v143
    v_pk_fma_f32 v[190:191], v[190:191], v[112:113], v[114:115]
    v_cvt_pk_bf16_f32 v143, v190, v191
    ds_write_b128 v242, v[140:143] offset:24576
    buffer_load_dwordx4 v211, s[44:47], s82 offen offset:3072 lds
    v_lshlrev_b32 v188, 16, v168
    v_and_b32 v189, 0xffff0000, v168
    v_pk_fma_f32 v[188:189], v[188:189], v[116:117], v[118:119]
    v_cvt_pk_bf16_f32 v168, v188, v189
    v_lshlrev_b32 v190, 16, v169
    v_and_b32 v191, 0xffff0000, v169
    v_pk_fma_f32 v[190:191], v[190:191], v[116:117], v[118:119]
    v_cvt_pk_bf16_f32 v169, v190, v191
    v_lshlrev_b32 v188, 16, v170
    v_and_b32 v189, 0xffff0000, v170
    v_pk_fma_f32 v[188:189], v[188:189], v[116:117], v[118:119]
    v_cvt_pk_bf16_f32 v170, v188, v189
    v_lshlrev_b32 v190, 16, v171
    v_and_b32 v191, 0xffff0000, v171
    s_add_u32 m0, s81, 49152
    s_mov_b32 s82, 344064
    buffer_load_dwordx4 v208, s[44:47], s82 offen offset:0 lds
    v_pk_fma_f32 v[190:191], v[190:191], v[116:117], v[118:119]
    v_cvt_pk_bf16_f32 v171, v190, v191
    ds_write_b128 v200, v[168:171] offset:24576
    v_lshlrev_b32 v188, 16, v144
    v_and_b32 v189, 0xffff0000, v144
    v_pk_fma_f32 v[188:189], v[188:189], v[112:113], v[114:115]
    v_cvt_pk_bf16_f32 v144, v188, v189
    v_lshlrev_b32 v190, 16, v145
    v_and_b32 v191, 0xffff0000, v145
    v_pk_fma_f32 v[190:191], v[190:191], v[112:113], v[114:115]
    v_cvt_pk_bf16_f32 v145, v190, v191
    v_lshlrev_b32 v188, 16, v146
    v_and_b32 v189, 0xffff0000, v146
    v_pk_fma_f32 v[188:189], v[188:189], v[112:113], v[114:115]
    buffer_load_dwordx4 v209, s[44:47], s82 offen offset:1024 lds
    v_cvt_pk_bf16_f32 v146, v188, v189
    v_lshlrev_b32 v190, 16, v147
    v_and_b32 v191, 0xffff0000, v147
    v_pk_fma_f32 v[190:191], v[190:191], v[112:113], v[114:115]
    v_cvt_pk_bf16_f32 v147, v190, v191
    ds_write_b128 v242, v[144:147] offset:32768
    v_lshlrev_b32 v188, 16, v172
    v_and_b32 v189, 0xffff0000, v172
    v_pk_fma_f32 v[188:189], v[188:189], v[116:117], v[118:119]
    v_cvt_pk_bf16_f32 v172, v188, v189
    v_lshlrev_b32 v190, 16, v173
    v_and_b32 v191, 0xffff0000, v173
    v_pk_fma_f32 v[190:191], v[190:191], v[116:117], v[118:119]
    v_cvt_pk_bf16_f32 v173, v190, v191
    buffer_load_dwordx4 v210, s[44:47], s82 offen offset:2048 lds
    v_lshlrev_b32 v188, 16, v174
    v_and_b32 v189, 0xffff0000, v174
    v_pk_fma_f32 v[188:189], v[188:189], v[116:117], v[118:119]
    v_cvt_pk_bf16_f32 v174, v188, v189
    v_lshlrev_b32 v190, 16, v175
    v_and_b32 v191, 0xffff0000, v175
    v_pk_fma_f32 v[190:191], v[190:191], v[116:117], v[118:119]
    v_cvt_pk_bf16_f32 v175, v190, v191
    ds_write_b128 v200, v[172:175] offset:32768
    v_lshlrev_b32 v188, 16, v148
    v_and_b32 v189, 0xffff0000, v148
    v_pk_fma_f32 v[188:189], v[188:189], v[112:113], v[114:115]
    v_cvt_pk_bf16_f32 v148, v188, v189
    v_lshlrev_b32 v190, 16, v149
    buffer_load_dwordx4 v211, s[44:47], s82 offen offset:3072 lds
    v_and_b32 v191, 0xffff0000, v149
    v_pk_fma_f32 v[190:191], v[190:191], v[112:113], v[114:115]
    v_cvt_pk_bf16_f32 v149, v190, v191
    v_lshlrev_b32 v188, 16, v150
    v_and_b32 v189, 0xffff0000, v150
    v_pk_fma_f32 v[188:189], v[188:189], v[112:113], v[114:115]
    v_cvt_pk_bf16_f32 v150, v188, v189
    v_lshlrev_b32 v190, 16, v151
    v_and_b32 v191, 0xffff0000, v151
    v_pk_fma_f32 v[190:191], v[190:191], v[112:113], v[114:115]
    v_cvt_pk_bf16_f32 v151, v190, v191
    ds_write_b128 v242, v[148:151] offset:40960
    v_lshlrev_b32 v188, 16, v176
    v_and_b32 v189, 0xffff0000, v176
    v_pk_fma_f32 v[188:189], v[188:189], v[116:117], v[118:119]
    v_cvt_pk_bf16_f32 v176, v188, v189
    v_lshlrev_b32 v190, 16, v177
    v_and_b32 v191, 0xffff0000, v177
    v_pk_fma_f32 v[190:191], v[190:191], v[116:117], v[118:119]
    v_cvt_pk_bf16_f32 v177, v190, v191
    v_lshlrev_b32 v188, 16, v178
    v_and_b32 v189, 0xffff0000, v178
    v_pk_fma_f32 v[188:189], v[188:189], v[116:117], v[118:119]
    v_cvt_pk_bf16_f32 v178, v188, v189
    v_lshlrev_b32 v190, 16, v179
    v_and_b32 v191, 0xffff0000, v179
    v_pk_fma_f32 v[190:191], v[190:191], v[116:117], v[118:119]
    v_cvt_pk_bf16_f32 v179, v190, v191
    ds_write_b128 v200, v[176:179] offset:40960
    v_lshlrev_b32 v188, 16, v152
    v_and_b32 v189, 0xffff0000, v152
    v_pk_fma_f32 v[188:189], v[188:189], v[112:113], v[114:115]
    v_cvt_pk_bf16_f32 v152, v188, v189
    v_lshlrev_b32 v190, 16, v153
    v_and_b32 v191, 0xffff0000, v153
    v_pk_fma_f32 v[190:191], v[190:191], v[112:113], v[114:115]
    v_cvt_pk_bf16_f32 v153, v190, v191
    v_lshlrev_b32 v188, 16, v154
    v_and_b32 v189, 0xffff0000, v154
    v_pk_fma_f32 v[188:189], v[188:189], v[112:113], v[114:115]
    v_cvt_pk_bf16_f32 v154, v188, v189
    v_lshlrev_b32 v190, 16, v155
    v_and_b32 v191, 0xffff0000, v155
    v_pk_fma_f32 v[190:191], v[190:191], v[112:113], v[114:115]
    v_cvt_pk_bf16_f32 v155, v190, v191
    ds_write_b128 v242, v[152:155] offset:49152
    v_lshlrev_b32 v188, 16, v180
    v_and_b32 v189, 0xffff0000, v180
    v_pk_fma_f32 v[188:189], v[188:189], v[116:117], v[118:119]
    v_cvt_pk_bf16_f32 v180, v188, v189
    v_lshlrev_b32 v190, 16, v181
    v_and_b32 v191, 0xffff0000, v181
    v_pk_fma_f32 v[190:191], v[190:191], v[116:117], v[118:119]
    v_cvt_pk_bf16_f32 v181, v190, v191
    v_lshlrev_b32 v188, 16, v182
    v_and_b32 v189, 0xffff0000, v182
    v_pk_fma_f32 v[188:189], v[188:189], v[116:117], v[118:119]
    v_cvt_pk_bf16_f32 v182, v188, v189
    v_lshlrev_b32 v190, 16, v183
    v_and_b32 v191, 0xffff0000, v183
    v_pk_fma_f32 v[190:191], v[190:191], v[116:117], v[118:119]
    v_cvt_pk_bf16_f32 v183, v190, v191
    ds_write_b128 v200, v[180:183] offset:49152
    buffer_load_dword v252, v120, s[40:43], 0 offen
    buffer_load_dword v252, v121, s[44:47], 0 offen
    s_waitcnt lgkmcnt(0) vmcnt(10)
    s_barrier
    ds_read_b128 a[32:35], v243 offset:0
    ds_read_b128 a[36:39], v243 offset:1024
    ds_read_b128 a[40:43], v244 offset:0
    ds_read_b128 a[44:47], v244 offset:1024
    ds_read_b64_tr_b16 a[0:1], v232 offset:0
    ds_read_b64_tr_b16 a[2:3], v232 offset:512
    ds_read_b64_tr_b16 a[4:5], v232 offset:4096
    ds_read_b64_tr_b16 a[6:7], v232 offset:4608
    ds_read_b64_tr_b16 a[8:9], v232 offset:8192
    ds_read_b64_tr_b16 a[10:11], v232 offset:8704
    s_waitcnt lgkmcnt(4)
    v_mfma_f32_16x16x32_bf16 a[64:67], a[0:3], a[32:35], a[64:67]
    s_add_u32 m0, s81, 65536
    s_mov_b32 s82, 458752
    v_mfma_f32_16x16x32_bf16 a[68:71], a[0:3], a[36:39], a[68:71]
    buffer_load_dwordx4 v208, s[44:47], s82 offen offset:0 lds
    v_mfma_f32_16x16x32_bf16 a[72:75], a[0:3], a[40:43], a[72:75]
    ds_read_b64_tr_b16 a[12:13], v235 offset:12288
    v_mfma_f32_16x16x32_bf16 a[76:79], a[0:3], a[44:47], a[76:79]
    s_waitcnt lgkmcnt(3)
    ds_read_b64_tr_b16 a[14:15], v235 offset:12800
    v_mfma_f32_16x16x32_bf16 a[80:83], a[4:7], a[32:35], a[80:83]
    buffer_load_dwordx4 v209, s[44:47], s82 offen offset:1024 lds
    v_mfma_f32_16x16x32_bf16 a[84:87], a[4:7], a[36:39], a[84:87]
    ds_read_b64_tr_b16 a[16:17], v232 offset:16384
    ds_read_b64_tr_b16 a[18:19], v232 offset:16896
    v_mfma_f32_16x16x32_bf16 a[88:91], a[4:7], a[40:43], a[88:91]
    ds_read_b128 a[48:51], v243 offset:4096
    ds_read_b128 a[52:55], v243 offset:5120
    v_mfma_f32_16x16x32_bf16 a[92:95], a[4:7], a[44:47], a[92:95]
    s_waitcnt lgkmcnt(6)
    ds_read_b128 a[56:59], v244 offset:4096
    ds_read_b128 a[60:63], v244 offset:5120
    v_mfma_f32_16x16x32_bf16 a[96:99], a[8:11], a[32:35], a[96:99]
    buffer_load_dwordx4 v210, s[44:47], s82 offen offset:2048 lds
    v_mfma_f32_16x16x32_bf16 a[100:103], a[8:11], a[36:39], a[100:103]
    ds_read_b64_tr_b16 a[20:21], v232 offset:20480
    ds_read_b64_tr_b16 a[22:23], v232 offset:20992
    v_mfma_f32_16x16x32_bf16 a[104:107], a[8:11], a[40:43], a[104:107]
    buffer_load_dwordx4 v211, s[44:47], s82 offen offset:3072 lds
    v_mfma_f32_16x16x32_bf16 a[108:111], a[8:11], a[44:47], a[108:111]
    s_waitcnt lgkmcnt(8)
    s_add_u32 m0, s81, 81920
    s_mov_b32 s82, 573440
    v_mfma_f32_16x16x32_bf16 a[112:115], a[12:15], a[32:35], a[112:115]
    ds_read_b64_tr_b16 a[24:25], v232 offset:24576
    v_mfma_f32_16x16x32_bf16 a[116:119], a[12:15], a[36:39], a[116:119]
    s_waitcnt lgkmcnt(3)
    ds_read_b64_tr_b16 a[26:27], v232 offset:25088
    v_mfma_f32_16x16x32_bf16 a[64:67], a[16:19], a[48:51], a[64:67]
    s_waitcnt vmcnt(10)
    s_barrier
    v_mfma_f32_16x16x32_bf16 a[68:71], a[16:19], a[52:55], a[68:71]
    buffer_load_dwordx4 v208, s[44:47], s82 offen offset:0 lds
    v_mfma_f32_16x16x32_bf16 a[72:75], a[16:19], a[56:59], a[72:75]
    ds_read_b64_tr_b16 a[28:29], v235 offset:28672
    v_mfma_f32_16x16x32_bf16 a[76:79], a[16:19], a[60:63], a[76:79]
    s_waitcnt lgkmcnt(3)
    ds_read_b64_tr_b16 a[30:31], v235 offset:29184
    v_mfma_f32_16x16x32_bf16 a[80:83], a[20:23], a[48:51], a[80:83]
    ds_read_b64_tr_b16 a[0:1], v232 offset:32768
    ds_read_b64_tr_b16 a[2:3], v232 offset:33280
    v_mfma_f32_16x16x32_bf16 a[84:87], a[20:23], a[52:55], a[84:87]
    buffer_load_dwordx4 v209, s[44:47], s82 offen offset:1024 lds
    v_mfma_f32_16x16x32_bf16 a[88:91], a[20:23], a[56:59], a[88:91]
    ds_read_b128 a[32:35], v243 offset:8192
    ds_read_b128 a[36:39], v243 offset:9216
    v_mfma_f32_16x16x32_bf16 a[92:95], a[20:23], a[60:63], a[92:95]
    s_waitcnt lgkmcnt(6)
    ds_read_b128 a[40:43], v244 offset:8192
    ds_read_b128 a[44:47], v244 offset:9216
    v_mfma_f32_16x16x32_bf16 a[96:99], a[24:27], a[48:51], a[96:99]
    buffer_load_dwordx4 v210, s[44:47], s82 offen offset:2048 lds
    v_mfma_f32_16x16x32_bf16 a[100:103], a[24:27], a[52:55], a[100:103]
    ds_read_b64_tr_b16 a[4:5], v232 offset:36864
    ds_read_b64_tr_b16 a[6:7], v232 offset:37376
    v_mfma_f32_16x16x32_bf16 a[104:107], a[24:27], a[56:59], a[104:107]
    ds_read_b64_tr_b16 a[8:9], v232 offset:40960
    v_mfma_f32_16x16x32_bf16 a[108:111], a[24:27], a[60:63], a[108:111]
    s_waitcnt lgkmcnt(9)
    ds_read_b64_tr_b16 a[10:11], v232 offset:41472
    v_mfma_f32_16x16x32_bf16 a[112:115], a[28:31], a[48:51], a[112:115]
    buffer_load_dwordx4 v211, s[44:47], s82 offen offset:3072 lds
    v_mfma_f32_16x16x32_bf16 a[116:119], a[28:31], a[52:55], a[116:119]
    s_waitcnt lgkmcnt(4)
    s_add_u32 m0, s81, 0
    s_mov_b32 s82, 688128
    v_mfma_f32_16x16x32_bf16 a[64:67], a[0:3], a[32:35], a[64:67]
    s_waitcnt vmcnt(10)
    s_barrier
    s_mov_b32 s36, s26
    v_mfma_f32_16x16x32_bf16 a[68:71], a[0:3], a[36:39], a[68:71]
    buffer_load_dwordx4 v208, s[44:47], s82 offen offset:0 lds
    v_mfma_f32_16x16x32_bf16 a[72:75], a[0:3], a[40:43], a[72:75]
    s_mov_b32 s37, s27
    ds_read_b64_tr_b16 a[12:13], v235 offset:45056
    v_mfma_f32_16x16x32_bf16 a[76:79], a[0:3], a[44:47], a[76:79]
    s_waitcnt lgkmcnt(3)
    ds_read_b64_tr_b16 a[14:15], v235 offset:45568
    v_mfma_f32_16x16x32_bf16 a[80:83], a[4:7], a[32:35], a[80:83]
    s_mov_b32 s72, s30
    ds_read_b64_tr_b16 a[16:17], v232 offset:49152
    ds_read_b64_tr_b16 a[18:19], v232 offset:49664
    v_mfma_f32_16x16x32_bf16 a[84:87], a[4:7], a[36:39], a[84:87]
    buffer_load_dwordx4 v209, s[44:47], s82 offen offset:1024 lds
    v_mfma_f32_16x16x32_bf16 a[88:91], a[4:7], a[40:43], a[88:91]
    s_mov_b32 s73, s31
    ds_read_b128 a[48:51], v243 offset:12288
    ds_read_b128 a[52:55], v243 offset:13312
    v_mfma_f32_16x16x32_bf16 a[92:95], a[4:7], a[44:47], a[92:95]
    s_waitcnt lgkmcnt(6)
    ds_read_b128 a[56:59], v244 offset:12288
    ds_read_b128 a[60:63], v244 offset:13312
    v_mfma_f32_16x16x32_bf16 a[96:99], a[8:11], a[32:35], a[96:99]
    s_mov_b32 s74, 256
    ds_read_b64_tr_b16 a[20:21], v232 offset:53248
    ds_read_b64_tr_b16 a[22:23], v232 offset:53760
    v_mfma_f32_16x16x32_bf16 a[100:103], a[8:11], a[36:39], a[100:103]
    buffer_load_dwordx4 v210, s[44:47], s82 offen offset:2048 lds
    v_mfma_f32_16x16x32_bf16 a[104:107], a[8:11], a[40:43], a[104:107]
    s_mov_b32 s75, 0x20000
    ds_read_b64_tr_b16 a[24:25], v232 offset:57344
    v_mfma_f32_16x16x32_bf16 a[108:111], a[8:11], a[44:47], a[108:111]
    s_waitcnt lgkmcnt(9)
    ds_read_b64_tr_b16 a[26:27], v232 offset:57856
    v_mfma_f32_16x16x32_bf16 a[112:115], a[12:15], a[32:35], a[112:115]
    buffer_load_dwordx4 v211, s[44:47], s82 offen offset:3072 lds
    v_mfma_f32_16x16x32_bf16 a[116:119], a[12:15], a[36:39], a[116:119]
    s_waitcnt lgkmcnt(4)
    s_add_u32 m0, s81, 16384
    s_mov_b32 s82, 802816
    v_mfma_f32_16x16x32_bf16 a[64:67], a[16:19], a[48:51], a[64:67]
    s_waitcnt vmcnt(8)
    s_barrier
    s_lshl_b32 s86, s79, 14
    v_mfma_f32_16x16x32_bf16 a[68:71], a[16:19], a[52:55], a[68:71]
    buffer_load_dwordx4 v208, s[44:47], s82 offen offset:0 lds
    v_mfma_f32_16x16x32_bf16 a[72:75], a[16:19], a[56:59], a[72:75]
    s_add_u32 s86, s86, s81
    ds_read_b64_tr_b16 a[28:29], v235 offset:61440
    v_mfma_f32_16x16x32_bf16 a[76:79], a[16:19], a[60:63], a[76:79]
    s_waitcnt lgkmcnt(3)
    ds_read_b64_tr_b16 a[30:31], v235 offset:61952
    v_mfma_f32_16x16x32_bf16 a[80:83], a[20:23], a[48:51], a[80:83]
    s_lshl_b32 s87, s80, 3
    ds_read_b64_tr_b16 a[0:1], v233 offset:0
    ds_read_b64_tr_b16 a[2:3], v233 offset:512
    v_mfma_f32_16x16x32_bf16 a[84:87], a[20:23], a[52:55], a[84:87]
    buffer_load_dwordx4 v209, s[44:47], s82 offen offset:1024 lds
    v_mfma_f32_16x16x32_bf16 a[88:91], a[20:23], a[56:59], a[88:91]
    s_add_u32 s86, s86, s87
    ds_read_b128 a[32:35], v243 offset:16384
    ds_read_b128 a[36:39], v243 offset:17408
    v_lshl_add_u32 v255, v251, 8, s86
    v_mfma_f32_16x16x32_bf16 a[92:95], a[20:23], a[60:63], a[92:95]
    s_waitcnt lgkmcnt(6)
    ds_read_b128 a[40:43], v244 offset:16384
    ds_read_b128 a[44:47], v244 offset:17408
    v_mfma_f32_16x16x32_bf16 a[96:99], a[24:27], a[48:51], a[96:99]
    s_mov_b32 s38, 896
    ds_read_b64_tr_b16 a[4:5], v233 offset:4096
    ds_read_b64_tr_b16 a[6:7], v233 offset:4608
    v_mfma_f32_16x16x32_bf16 a[100:103], a[24:27], a[52:55], a[100:103]
    buffer_load_dwordx4 v210, s[44:47], s82 offen offset:2048 lds
    v_mfma_f32_16x16x32_bf16 a[104:107], a[24:27], a[56:59], a[104:107]
    s_or_b32 s34, s34, 1
    ds_read_b64_tr_b16 a[8:9], v233 offset:8192
    v_mov_b32 v199, s34
    v_mfma_f32_16x16x32_bf16 a[108:111], a[24:27], a[60:63], a[108:111]
    s_waitcnt lgkmcnt(9)
    ds_read_b64_tr_b16 a[10:11], v233 offset:8704
    v_mfma_f32_16x16x32_bf16 a[112:115], a[28:31], a[48:51], a[112:115]
    buffer_load_dwordx4 v211, s[44:47], s82 offen offset:3072 lds
    v_mfma_f32_16x16x32_bf16 a[116:119], a[28:31], a[52:55], a[116:119]
    s_waitcnt lgkmcnt(4)
    s_add_u32 m0, s81, 32768
    s_mov_b32 s82, 917504
    v_mfma_f32_16x16x32_bf16 a[64:67], a[0:3], a[32:35], a[64:67]
    s_waitcnt vmcnt(8)
    s_barrier
    s_mov_b32 s39, 0x20000
    v_mfma_f32_16x16x32_bf16 a[68:71], a[0:3], a[36:39], a[68:71]
    buffer_load_dwordx4 v208, s[44:47], s82 offen offset:0 lds
    v_mfma_f32_16x16x32_bf16 a[72:75], a[0:3], a[40:43], a[72:75]
    ds_read_b64_tr_b16 a[12:13], v236 offset:12288
    v_mfma_f32_16x16x32_bf16 a[76:79], a[0:3], a[44:47], a[76:79]
    s_waitcnt lgkmcnt(3)
    ds_read_b64_tr_b16 a[14:15], v236 offset:12800
    v_mfma_f32_16x16x32_bf16 a[80:83], a[4:7], a[32:35], a[80:83]
    ds_read_b64_tr_b16 a[16:17], v233 offset:16384
    ds_read_b64_tr_b16 a[18:19], v233 offset:16896
    v_mfma_f32_16x16x32_bf16 a[84:87], a[4:7], a[36:39], a[84:87]
    ds_read_b128 a[48:51], v243 offset:20480
    ds_read_b128 a[52:55], v243 offset:21504
    v_mfma_f32_16x16x32_bf16 a[88:91], a[4:7], a[40:43], a[88:91]
    buffer_load_dwordx4 v209, s[44:47], s82 offen offset:1024 lds
    v_mfma_f32_16x16x32_bf16 a[92:95], a[4:7], a[44:47], a[92:95]
    s_waitcnt lgkmcnt(6)
    ds_read_b128 a[56:59], v244 offset:20480
    ds_read_b128 a[60:63], v244 offset:21504
    v_mfma_f32_16x16x32_bf16 a[96:99], a[8:11], a[32:35], a[96:99]
    ds_read_b64_tr_b16 a[20:21], v233 offset:20480
    ds_read_b64_tr_b16 a[22:23], v233 offset:20992
    v_mfma_f32_16x16x32_bf16 a[100:103], a[8:11], a[36:39], a[100:103]
    buffer_load_dwordx4 v210, s[44:47], s82 offen offset:2048 lds
    v_mfma_f32_16x16x32_bf16 a[104:107], a[8:11], a[40:43], a[104:107]
    ds_read_b64_tr_b16 a[24:25], v233 offset:24576
    v_mfma_f32_16x16x32_bf16 a[108:111], a[8:11], a[44:47], a[108:111]
    s_waitcnt lgkmcnt(9)
    ds_read_b64_tr_b16 a[26:27], v233 offset:25088
    v_mfma_f32_16x16x32_bf16 a[112:115], a[12:15], a[32:35], a[112:115]
    buffer_load_dwordx4 v211, s[44:47], s82 offen offset:3072 lds
    v_mfma_f32_16x16x32_bf16 a[116:119], a[12:15], a[36:39], a[116:119]
    s_waitcnt lgkmcnt(4)
    s_add_u32 m0, s81, 49152
    s_mov_b32 s82, 1032192
    v_mfma_f32_16x16x32_bf16 a[64:67], a[16:19], a[48:51], a[64:67]
    s_waitcnt vmcnt(8)
    s_barrier
    v_mfma_f32_16x16x32_bf16 a[68:71], a[16:19], a[52:55], a[68:71]
    ds_read_b64_tr_b16 a[28:29], v236 offset:28672
    v_mfma_f32_16x16x32_bf16 a[72:75], a[16:19], a[56:59], a[72:75]
    ds_read_b64_tr_b16 a[30:31], v236 offset:29184
    v_mfma_f32_16x16x32_bf16 a[76:79], a[16:19], a[60:63], a[76:79]
    s_waitcnt lgkmcnt(4)
    buffer_load_dwordx4 v208, s[44:47], s82 offen offset:0 lds
    v_mfma_f32_16x16x32_bf16 a[80:83], a[20:23], a[48:51], a[80:83]
    ds_read_b64_tr_b16 a[0:1], v232 offset:0
    ds_read_b64_tr_b16 a[2:3], v232 offset:512
    v_mfma_f32_16x16x32_bf16 a[84:87], a[20:23], a[52:55], a[84:87]
    ds_read_b128 a[32:35], v243 offset:24576
    ds_read_b128 a[36:39], v243 offset:25600
    v_mfma_f32_16x16x32_bf16 a[88:91], a[20:23], a[56:59], a[88:91]
    buffer_load_dwordx4 v209, s[44:47], s82 offen offset:1024 lds
    v_mfma_f32_16x16x32_bf16 a[92:95], a[20:23], a[60:63], a[92:95]
    s_waitcnt lgkmcnt(6)
    ds_read_b128 a[40:43], v244 offset:24576
    ds_read_b128 a[44:47], v244 offset:25600
    v_mfma_f32_16x16x32_bf16 a[96:99], a[24:27], a[48:51], a[96:99]
    ds_read_b64_tr_b16 a[4:5], v232 offset:4096
    v_mfma_f32_16x16x32_bf16 a[100:103], a[24:27], a[52:55], a[100:103]
    ds_read_b64_tr_b16 a[6:7], v232 offset:4608
    v_mfma_f32_16x16x32_bf16 a[104:107], a[24:27], a[56:59], a[104:107]
    buffer_load_dwordx4 v210, s[44:47], s82 offen offset:2048 lds
    v_mfma_f32_16x16x32_bf16 a[108:111], a[24:27], a[60:63], a[108:111]
    s_waitcnt lgkmcnt(8)
    ds_read_b64_tr_b16 a[8:9], v232 offset:8192
    v_mfma_f32_16x16x32_bf16 a[112:115], a[28:31], a[48:51], a[112:115]
    ds_read_b64_tr_b16 a[10:11], v232 offset:8704
    v_mfma_f32_16x16x32_bf16 a[116:119], a[28:31], a[52:55], a[116:119]
    s_waitcnt lgkmcnt(4)
    buffer_load_dwordx4 v211, s[44:47], s82 offen offset:3072 lds
    v_mfma_f32_16x16x32_bf16 a[64:67], a[0:3], a[32:35], a[64:67]
    s_waitcnt vmcnt(8)
    s_barrier
    s_add_u32 m0, s81, 65536
    v_mfma_f32_16x16x32_bf16 a[68:71], a[0:3], a[36:39], a[68:71]
    s_mov_b32 s82, 1146880
    ds_read_b64_tr_b16 a[12:13], v235 offset:12288
    v_mfma_f32_16x16x32_bf16 a[72:75], a[0:3], a[40:43], a[72:75]
    ds_read_b64_tr_b16 a[14:15], v235 offset:12800
    v_mfma_f32_16x16x32_bf16 a[76:79], a[0:3], a[44:47], a[76:79]
    s_waitcnt lgkmcnt(4)
    buffer_load_dwordx4 v208, s[44:47], s82 offen offset:0 lds
    v_mfma_f32_16x16x32_bf16 a[80:83], a[4:7], a[32:35], a[80:83]
    ds_read_b64_tr_b16 a[16:17], v232 offset:16384
    ds_read_b64_tr_b16 a[18:19], v232 offset:16896
    v_mfma_f32_16x16x32_bf16 a[84:87], a[4:7], a[36:39], a[84:87]
    ds_read_b128 a[48:51], v243 offset:28672
    ds_read_b128 a[52:55], v243 offset:29696
    v_mfma_f32_16x16x32_bf16 a[88:91], a[4:7], a[40:43], a[88:91]
    buffer_load_dwordx4 v209, s[44:47], s82 offen offset:1024 lds
    v_mfma_f32_16x16x32_bf16 a[92:95], a[4:7], a[44:47], a[92:95]
    s_waitcnt lgkmcnt(6)
    ds_read_b128 a[56:59], v244 offset:28672
    ds_read_b128 a[60:63], v244 offset:29696
    v_mfma_f32_16x16x32_bf16 a[96:99], a[8:11], a[32:35], a[96:99]
    ds_read_b64_tr_b16 a[20:21], v232 offset:20480
    v_mfma_f32_16x16x32_bf16 a[100:103], a[8:11], a[36:39], a[100:103]
    ds_read_b64_tr_b16 a[22:23], v232 offset:20992
    v_mfma_f32_16x16x32_bf16 a[104:107], a[8:11], a[40:43], a[104:107]
    buffer_load_dwordx4 v210, s[44:47], s82 offen offset:2048 lds
    v_mfma_f32_16x16x32_bf16 a[108:111], a[8:11], a[44:47], a[108:111]
    s_waitcnt lgkmcnt(8)
    ds_read_b64_tr_b16 a[24:25], v232 offset:24576
    v_mfma_f32_16x16x32_bf16 a[112:115], a[12:15], a[32:35], a[112:115]
    ds_read_b64_tr_b16 a[26:27], v232 offset:25088
    v_mfma_f32_16x16x32_bf16 a[116:119], a[12:15], a[36:39], a[116:119]
    s_waitcnt lgkmcnt(4)
    ds_read_b64_tr_b16 a[28:29], v235 offset:28672
    v_mfma_f32_16x16x32_bf16 a[64:67], a[16:19], a[48:51], a[64:67]
    s_waitcnt vmcnt(7)
    s_barrier
    buffer_load_dwordx4 v211, s[44:47], s82 offen offset:3072 lds
    v_mfma_f32_16x16x32_bf16 a[68:71], a[16:19], a[52:55], a[68:71]
    s_add_u32 m0, s81, 81920
    s_mov_b32 s82, 1261568
    v_mfma_f32_16x16x32_bf16 a[72:75], a[16:19], a[56:59], a[72:75]
    ds_read_b64_tr_b16 a[30:31], v235 offset:29184
    v_mfma_f32_16x16x32_bf16 a[76:79], a[16:19], a[60:63], a[76:79]
    s_waitcnt lgkmcnt(4)
    buffer_load_dwordx4 v208, s[44:47], s82 offen offset:0 lds
    v_mfma_f32_16x16x32_bf16 a[80:83], a[20:23], a[48:51], a[80:83]
    ds_read_b64_tr_b16 a[0:1], v232 offset:32768
    ds_read_b64_tr_b16 a[2:3], v232 offset:33280
    v_mfma_f32_16x16x32_bf16 a[84:87], a[20:23], a[52:55], a[84:87]
    ds_read_b128 a[32:35], v243 offset:32768
    ds_read_b128 a[36:39], v243 offset:33792
    v_mfma_f32_16x16x32_bf16 a[88:91], a[20:23], a[56:59], a[88:91]
    ds_read_b128 a[40:43], v244 offset:32768
    ds_read_b128 a[44:47], v244 offset:33792
    v_mfma_f32_16x16x32_bf16 a[92:95], a[20:23], a[60:63], a[92:95]
    s_waitcnt lgkmcnt(8)
    buffer_load_dwordx4 v209, s[44:47], s82 offen offset:1024 lds
    v_mfma_f32_16x16x32_bf16 a[96:99], a[24:27], a[48:51], a[96:99]
    ds_read_b64_tr_b16 a[4:5], v232 offset:36864
    v_mfma_f32_16x16x32_bf16 a[100:103], a[24:27], a[52:55], a[100:103]
    ds_read_b64_tr_b16 a[6:7], v232 offset:37376
    v_mfma_f32_16x16x32_bf16 a[104:107], a[24:27], a[56:59], a[104:107]
    buffer_load_dwordx4 v210, s[44:47], s82 offen offset:2048 lds
    v_mfma_f32_16x16x32_bf16 a[108:111], a[24:27], a[60:63], a[108:111]
    s_waitcnt lgkmcnt(8)
    ds_read_b64_tr_b16 a[8:9], v232 offset:40960
    v_mfma_f32_16x16x32_bf16 a[112:115], a[28:31], a[48:51], a[112:115]
    buffer_store_dword v199, v255, s[72:75], 0 offen offset:4 sc1
    v_mfma_f32_16x16x32_bf16 a[116:119], a[28:31], a[52:55], a[116:119]
    s_waitcnt lgkmcnt(3)
    ds_read_b64_tr_b16 a[10:11], v232 offset:41472
    v_mfma_f32_16x16x32_bf16 a[64:67], a[0:3], a[32:35], a[64:67]
    s_waitcnt vmcnt(8)
    s_barrier
    buffer_load_dwordx4 v211, s[44:47], s82 offen offset:3072 lds
    v_mfma_f32_16x16x32_bf16 a[68:71], a[0:3], a[36:39], a[68:71]
    s_add_u32 m0, s81, 0
    ds_read_b64_tr_b16 a[12:13], v235 offset:45056
    v_mfma_f32_16x16x32_bf16 a[72:75], a[0:3], a[40:43], a[72:75]
    s_mov_b32 s82, 1376256
    ds_read_b64_tr_b16 a[14:15], v235 offset:45568
    v_mfma_f32_16x16x32_bf16 a[76:79], a[0:3], a[44:47], a[76:79]
    s_waitcnt lgkmcnt(4)
    ds_read_b64_tr_b16 a[16:17], v232 offset:49152
    ds_read_b64_tr_b16 a[18:19], v232 offset:49664
    v_mfma_f32_16x16x32_bf16 a[80:83], a[4:7], a[32:35], a[80:83]
    buffer_load_dwordx4 v208, s[44:47], s82 offen offset:0 lds
    v_mfma_f32_16x16x32_bf16 a[84:87], a[4:7], a[36:39], a[84:87]
    ds_read_b128 a[48:51], v243 offset:36864
    ds_read_b128 a[52:55], v243 offset:37888
    v_mfma_f32_16x16x32_bf16 a[88:91], a[4:7], a[40:43], a[88:91]
    ds_read_b128 a[56:59], v244 offset:36864
    ds_read_b128 a[60:63], v244 offset:37888
    v_mfma_f32_16x16x32_bf16 a[92:95], a[4:7], a[44:47], a[92:95]
    s_waitcnt lgkmcnt(8)
    buffer_load_dwordx4 v209, s[44:47], s82 offen offset:1024 lds
    v_mfma_f32_16x16x32_bf16 a[96:99], a[8:11], a[32:35], a[96:99]
    ds_read_b64_tr_b16 a[20:21], v232 offset:53248
    v_mfma_f32_16x16x32_bf16 a[100:103], a[8:11], a[36:39], a[100:103]
    ds_read_b64_tr_b16 a[22:23], v232 offset:53760
    v_mfma_f32_16x16x32_bf16 a[104:107], a[8:11], a[40:43], a[104:107]
    buffer_load_dwordx4 v210, s[44:47], s82 offen offset:2048 lds
    v_mfma_f32_16x16x32_bf16 a[108:111], a[8:11], a[44:47], a[108:111]
    s_waitcnt lgkmcnt(8)
    ds_read_b64_tr_b16 a[24:25], v232 offset:57344
    v_mfma_f32_16x16x32_bf16 a[112:115], a[12:15], a[32:35], a[112:115]
    ds_read_b64_tr_b16 a[26:27], v232 offset:57856
    v_mfma_f32_16x16x32_bf16 a[116:119], a[12:15], a[36:39], a[116:119]
    s_waitcnt lgkmcnt(4)
    ds_read_b64_tr_b16 a[28:29], v235 offset:61440
    v_mfma_f32_16x16x32_bf16 a[64:67], a[16:19], a[48:51], a[64:67]
    s_waitcnt vmcnt(8)
    s_barrier
    buffer_load_dwordx4 v211, s[44:47], s82 offen offset:3072 lds
    v_mfma_f32_16x16x32_bf16 a[68:71], a[16:19], a[52:55], a[68:71]
    s_add_u32 m0, s81, 16384
    ds_read_b64_tr_b16 a[30:31], v235 offset:61952
    v_mfma_f32_16x16x32_bf16 a[72:75], a[16:19], a[56:59], a[72:75]
    s_mov_b32 s82, 1490944
    ds_read_b64_tr_b16 a[0:1], v233 offset:0
    v_mfma_f32_16x16x32_bf16 a[76:79], a[16:19], a[60:63], a[76:79]
    s_waitcnt lgkmcnt(5)
    ds_read_b64_tr_b16 a[2:3], v233 offset:512
    v_mfma_f32_16x16x32_bf16 a[80:83], a[20:23], a[48:51], a[80:83]
    buffer_load_dwordx4 v208, s[44:47], s82 offen offset:0 lds
    v_mfma_f32_16x16x32_bf16 a[84:87], a[20:23], a[52:55], a[84:87]
    ds_read_b128 a[32:35], v243 offset:40960
    v_mfma_f32_16x16x32_bf16 a[88:91], a[20:23], a[56:59], a[88:91]
    ds_read_b128 a[36:39], v243 offset:41984
    v_mfma_f32_16x16x32_bf16 a[92:95], a[20:23], a[60:63], a[92:95]
    s_waitcnt lgkmcnt(6)
    ds_read_b128 a[40:43], v244 offset:40960
    ds_read_b128 a[44:47], v244 offset:41984
    v_mfma_f32_16x16x32_bf16 a[96:99], a[24:27], a[48:51], a[96:99]
    buffer_load_dwordx4 v209, s[44:47], s82 offen offset:1024 lds
    v_mfma_f32_16x16x32_bf16 a[100:103], a[24:27], a[52:55], a[100:103]
    ds_read_b64_tr_b16 a[4:5], v233 offset:4096
    ds_read_b64_tr_b16 a[6:7], v233 offset:4608
    v_mfma_f32_16x16x32_bf16 a[104:107], a[24:27], a[56:59], a[104:107]
    buffer_load_dwordx4 v210, s[44:47], s82 offen offset:2048 lds
    v_mfma_f32_16x16x32_bf16 a[108:111], a[24:27], a[60:63], a[108:111]
    s_waitcnt lgkmcnt(8)
    ds_read_b64_tr_b16 a[8:9], v233 offset:8192
    v_mfma_f32_16x16x32_bf16 a[112:115], a[28:31], a[48:51], a[112:115]
    ds_read_b64_tr_b16 a[10:11], v233 offset:8704
    v_mfma_f32_16x16x32_bf16 a[116:119], a[28:31], a[52:55], a[116:119]
    s_waitcnt lgkmcnt(4)
    ds_read_b64_tr_b16 a[12:13], v236 offset:12288
    v_mfma_f32_16x16x32_bf16 a[64:67], a[0:3], a[32:35], a[64:67]
    s_waitcnt vmcnt(7)
    s_barrier
    v_mfma_f32_16x16x32_bf16 a[68:71], a[0:3], a[36:39], a[68:71]
    buffer_load_dwordx4 v211, s[44:47], s82 offen offset:3072 lds
    v_mfma_f32_16x16x32_bf16 a[72:75], a[0:3], a[40:43], a[72:75]
    s_add_u32 m0, s84, 32768
    ds_read_b64_tr_b16 a[14:15], v236 offset:12800
    v_mfma_f32_16x16x32_bf16 a[76:79], a[0:3], a[44:47], a[76:79]
    s_waitcnt lgkmcnt(4)
    s_mov_b32 s82, 0
    v_mfma_f32_16x16x32_bf16 a[80:83], a[4:7], a[32:35], a[80:83]
    buffer_load_dwordx4 v204, s[40:43], s82 offen offset:0 lds
    v_mfma_f32_16x16x32_bf16 a[84:87], a[4:7], a[36:39], a[84:87]
    ds_read_b64_tr_b16 a[16:17], v233 offset:16384
    ds_read_b64_tr_b16 a[18:19], v233 offset:16896
    v_mfma_f32_16x16x32_bf16 a[88:91], a[4:7], a[40:43], a[88:91]
    ds_read_b128 a[48:51], v243 offset:45056
    ds_read_b128 a[52:55], v243 offset:46080
    v_mfma_f32_16x16x32_bf16 a[92:95], a[4:7], a[44:47], a[92:95]
    s_waitcnt lgkmcnt(6)
    ds_read_b128 a[56:59], v244 offset:45056
    ds_read_b128 a[60:63], v244 offset:46080
    v_mfma_f32_16x16x32_bf16 a[96:99], a[8:11], a[32:35], a[96:99]
    buffer_load_dwordx4 v205, s[40:43], s82 offen offset:1024 lds
    v_mfma_f32_16x16x32_bf16 a[100:103], a[8:11], a[36:39], a[100:103]
    ds_read_b64_tr_b16 a[20:21], v233 offset:20480
    ds_read_b64_tr_b16 a[22:23], v233 offset:20992
    v_mfma_f32_16x16x32_bf16 a[104:107], a[8:11], a[40:43], a[104:107]
    ds_read_b64_tr_b16 a[24:25], v233 offset:24576
    v_mfma_f32_16x16x32_bf16 a[108:111], a[8:11], a[44:47], a[108:111]
    s_waitcnt lgkmcnt(9)
    ds_read_b64_tr_b16 a[26:27], v233 offset:25088
    v_mfma_f32_16x16x32_bf16 a[112:115], a[12:15], a[32:35], a[112:115]
    buffer_load_dwordx4 v206, s[40:43], s82 offen offset:2048 lds
    v_mfma_f32_16x16x32_bf16 a[116:119], a[12:15], a[36:39], a[116:119]
    s_waitcnt lgkmcnt(4)
    ds_read_b64_tr_b16 a[28:29], v236 offset:28672
    v_mfma_f32_16x16x32_bf16 a[64:67], a[16:19], a[48:51], a[64:67]
    s_waitcnt vmcnt(7)
    s_barrier
    v_mfma_f32_16x16x32_bf16 a[68:71], a[16:19], a[52:55], a[68:71]
    buffer_load_dwordx4 v207, s[40:43], s82 offen offset:3072 lds
    v_mfma_f32_16x16x32_bf16 a[72:75], a[16:19], a[56:59], a[72:75]
    s_add_u32 m0, s84, 36864
    ds_read_b64_tr_b16 a[30:31], v236 offset:29184
    v_mfma_f32_16x16x32_bf16 a[76:79], a[16:19], a[60:63], a[76:79]
    s_waitcnt lgkmcnt(4)
    ds_read_b64_tr_b16 a[0:1], v232 offset:0
    v_mfma_f32_16x16x32_bf16 a[80:83], a[20:23], a[48:51], a[80:83]
    s_mov_b32 s82, 128
    ds_read_b64_tr_b16 a[2:3], v232 offset:512
    v_mfma_f32_16x16x32_bf16 a[84:87], a[20:23], a[52:55], a[84:87]
    buffer_load_dwordx4 v204, s[40:43], s82 offen offset:0 lds
    v_mfma_f32_16x16x32_bf16 a[88:91], a[20:23], a[56:59], a[88:91]
    ds_read_b128 a[32:35], v243 offset:49152
    ds_read_b128 a[36:39], v243 offset:50176
    v_mfma_f32_16x16x32_bf16 a[92:95], a[20:23], a[60:63], a[92:95]
    s_waitcnt lgkmcnt(6)
    ds_read_b128 a[40:43], v244 offset:49152
    ds_read_b128 a[44:47], v244 offset:50176
    v_mfma_f32_16x16x32_bf16 a[96:99], a[24:27], a[48:51], a[96:99]
    buffer_load_dwordx4 v205, s[40:43], s82 offen offset:1024 lds
    v_mfma_f32_16x16x32_bf16 a[100:103], a[24:27], a[52:55], a[100:103]
    ds_read_b64_tr_b16 a[4:5], v232 offset:4096
    ds_read_b64_tr_b16 a[6:7], v232 offset:4608
    v_mfma_f32_16x16x32_bf16 a[104:107], a[24:27], a[56:59], a[104:107]
    ds_read_b64_tr_b16 a[8:9], v232 offset:8192
    v_mfma_f32_16x16x32_bf16 a[108:111], a[24:27], a[60:63], a[108:111]
    s_waitcnt lgkmcnt(9)
    ds_read_b64_tr_b16 a[10:11], v232 offset:8704
    v_mfma_f32_16x16x32_bf16 a[112:115], a[28:31], a[48:51], a[112:115]
    buffer_load_dwordx4 v206, s[40:43], s82 offen offset:2048 lds
    v_mfma_f32_16x16x32_bf16 a[116:119], a[28:31], a[52:55], a[116:119]
    s_waitcnt lgkmcnt(4)
    ds_read_b64_tr_b16 a[12:13], v235 offset:12288
    v_mfma_f32_16x16x32_bf16 a[64:67], a[0:3], a[32:35], a[64:67]
    s_waitcnt vmcnt(7)
    s_barrier
    v_mfma_f32_16x16x32_bf16 a[68:71], a[0:3], a[36:39], a[68:71]
    buffer_load_dwordx4 v207, s[40:43], s82 offen offset:3072 lds
    v_mfma_f32_16x16x32_bf16 a[72:75], a[0:3], a[40:43], a[72:75]
    s_add_u32 m0, s84, 65536
    ds_read_b64_tr_b16 a[14:15], v235 offset:12800
    v_mfma_f32_16x16x32_bf16 a[76:79], a[0:3], a[44:47], a[76:79]
    s_waitcnt lgkmcnt(4)
    ds_read_b64_tr_b16 a[16:17], v232 offset:16384
    v_mfma_f32_16x16x32_bf16 a[80:83], a[4:7], a[32:35], a[80:83]
    s_mov_b32 s82, 262144
    ds_read_b64_tr_b16 a[18:19], v232 offset:16896
    v_mfma_f32_16x16x32_bf16 a[84:87], a[4:7], a[36:39], a[84:87]
    buffer_load_dwordx4 v204, s[40:43], s82 offen offset:0 lds
    v_mfma_f32_16x16x32_bf16 a[88:91], a[4:7], a[40:43], a[88:91]
    ds_read_b128 a[48:51], v243 offset:53248
    ds_read_b128 a[52:55], v243 offset:54272
    v_mfma_f32_16x16x32_bf16 a[92:95], a[4:7], a[44:47], a[92:95]
    s_waitcnt lgkmcnt(6)
    ds_read_b128 a[56:59], v244 offset:53248
    ds_read_b128 a[60:63], v244 offset:54272
    v_mfma_f32_16x16x32_bf16 a[96:99], a[8:11], a[32:35], a[96:99]
    ds_read_b64_tr_b16 a[20:21], v232 offset:20480
    ds_read_b64_tr_b16 a[22:23], v232 offset:20992
    v_mfma_f32_16x16x32_bf16 a[100:103], a[8:11], a[36:39], a[100:103]
    buffer_load_dwordx4 v205, s[40:43], s82 offen offset:1024 lds
    v_mfma_f32_16x16x32_bf16 a[104:107], a[8:11], a[40:43], a[104:107]
    ds_read_b64_tr_b16 a[24:25], v232 offset:24576
    v_mfma_f32_16x16x32_bf16 a[108:111], a[8:11], a[44:47], a[108:111]
    s_waitcnt lgkmcnt(9)
    ds_read_b64_tr_b16 a[26:27], v232 offset:25088
    v_mfma_f32_16x16x32_bf16 a[112:115], a[12:15], a[32:35], a[112:115]
    buffer_load_dwordx4 v206, s[40:43], s82 offen offset:2048 lds
    v_mfma_f32_16x16x32_bf16 a[116:119], a[12:15], a[36:39], a[116:119]
    s_waitcnt lgkmcnt(4)
    ds_read_b64_tr_b16 a[28:29], v235 offset:28672
    v_mfma_f32_16x16x32_bf16 a[64:67], a[16:19], a[48:51], a[64:67]
    s_waitcnt vmcnt(7)
    s_barrier
    v_mfma_f32_16x16x32_bf16 a[68:71], a[16:19], a[52:55], a[68:71]
    buffer_load_dwordx4 v207, s[40:43], s82 offen offset:3072 lds
    v_mfma_f32_16x16x32_bf16 a[72:75], a[16:19], a[56:59], a[72:75]
    s_add_u32 m0, s84, 69632
    ds_read_b64_tr_b16 a[30:31], v235 offset:29184
    v_mfma_f32_16x16x32_bf16 a[76:79], a[16:19], a[60:63], a[76:79]
    s_waitcnt lgkmcnt(4)
    ds_read_b64_tr_b16 a[0:1], v224 offset:32768
    v_mfma_f32_16x16x32_bf16 a[80:83], a[20:23], a[48:51], a[80:83]
    s_mov_b32 s82, 262272
    ds_read_b64_tr_b16 a[2:3], v224 offset:33280
    v_mfma_f32_16x16x32_bf16 a[84:87], a[20:23], a[52:55], a[84:87]
    ds_read_b128 a[32:35], v243 offset:0
    ds_read_b128 a[36:39], v243 offset:1024
    v_mfma_f32_16x16x32_bf16 a[88:91], a[20:23], a[56:59], a[88:91]
    buffer_load_dwordx4 v204, s[40:43], s82 offen offset:0 lds
    v_mfma_f32_16x16x32_bf16 a[92:95], a[20:23], a[60:63], a[92:95]
    s_waitcnt lgkmcnt(6)
    ds_read_b128 a[40:43], v244 offset:0
    ds_read_b128 a[44:47], v244 offset:1024
    v_mfma_f32_16x16x32_bf16 a[96:99], a[24:27], a[48:51], a[96:99]
    ds_read_b64_tr_b16 a[4:5], v226 offset:32768
    ds_read_b64_tr_b16 a[6:7], v226 offset:33280
    v_mfma_f32_16x16x32_bf16 a[100:103], a[24:27], a[52:55], a[100:103]
    buffer_load_dwordx4 v205, s[40:43], s82 offen offset:1024 lds
    v_mfma_f32_16x16x32_bf16 a[104:107], a[24:27], a[56:59], a[104:107]
    ds_read_b64_tr_b16 a[8:9], v228 offset:32768
    v_mfma_f32_16x16x32_bf16 a[108:111], a[24:27], a[60:63], a[108:111]
    s_waitcnt lgkmcnt(9)
    ds_read_b64_tr_b16 a[10:11], v228 offset:33280
    v_mfma_f32_16x16x32_bf16 a[112:115], a[28:31], a[48:51], a[112:115]
    buffer_load_dwordx4 v206, s[40:43], s82 offen offset:2048 lds
    v_mfma_f32_16x16x32_bf16 a[116:119], a[28:31], a[52:55], a[116:119]
    s_waitcnt lgkmcnt(4)
    ds_read_b64_tr_b16 a[12:13], v230 offset:32768
    v_mfma_f32_16x16x32_bf16 v[0:3], a[0:3], a[32:35], 0
    s_barrier
    ds_read_b64_tr_b16 a[14:15], v230 offset:33280
    v_mfma_f32_16x16x32_bf16 v[4:7], a[0:3], a[36:39], 0
    buffer_load_dwordx4 v207, s[40:43], s82 offen offset:3072 lds
    v_mfma_f32_16x16x32_bf16 v[8:11], a[0:3], a[40:43], 0
    s_waitcnt vmcnt(8)
    ds_read_b64_tr_b16 a[16:17], v224 offset:36864
    ds_read_b64_tr_b16 a[18:19], v224 offset:37376
    v_accvgpr_read_b32 v196, a64
    v_accvgpr_read_b32 v197, a65
    v_accvgpr_read_b32 v198, a66
    v_accvgpr_read_b32 v199, a67
    v_mul_f32 v200, v196, v196
    v_mul_f32 v201, v197, v197
    v_mul_f32 v202, v198, v198
    v_mul_f32 v203, v199, v199
    v_fma_f32 v200, v200, s85, v248
    v_fma_f32 v201, v201, s85, v248
    v_fma_f32 v202, v202, s85, v248
    v_fma_f32 v203, v203, s85, v248
    v_mul_f32 v200, v200, v196
    v_mul_f32 v201, v201, v197
    v_mul_f32 v202, v202, v198
    v_mul_f32 v203, v203, v199
    v_exp_f32 v200, v200
    v_exp_f32 v201, v201
    v_exp_f32 v202, v202
    v_exp_f32 v203, v203
    v_add_f32 v200, 1.0, v200
    v_add_f32 v201, 1.0, v201
    v_add_f32 v202, 1.0, v202
    v_add_f32 v203, 1.0, v203
    v_rcp_f32 v200, v200
    v_rcp_f32 v201, v201
    v_rcp_f32 v202, v202
    v_rcp_f32 v203, v203
    v_mul_f32 v196, v196, v200
    v_mul_f32 v197, v197, v201
    v_mul_f32 v198, v198, v202
    v_mul_f32 v199, v199, v203
    v_cvt_pk_bf16_f32 v200, v196, v197
    v_cvt_pk_bf16_f32 v201, v198, v199
    v_accvgpr_write_b32 a64, v200
    v_accvgpr_write_b32 a65, v201
    v_accvgpr_read_b32 v196, a68
    v_accvgpr_read_b32 v197, a69
    v_accvgpr_read_b32 v198, a70
    v_accvgpr_read_b32 v199, a71
    v_mul_f32 v200, v196, v196
    v_mul_f32 v201, v197, v197
    v_mul_f32 v202, v198, v198
    v_mul_f32 v203, v199, v199
    v_fma_f32 v200, v200, s85, v248
    v_fma_f32 v201, v201, s85, v248
    v_fma_f32 v202, v202, s85, v248
    v_fma_f32 v203, v203, s85, v248
    v_mul_f32 v200, v200, v196
    v_mul_f32 v201, v201, v197
    v_mul_f32 v202, v202, v198
    v_mul_f32 v203, v203, v199
    v_exp_f32 v200, v200
    v_exp_f32 v201, v201
    v_mfma_f32_16x16x32_bf16 v[12:15], a[0:3], a[44:47], 0
    s_waitcnt lgkmcnt(6)
    v_exp_f32 v202, v202
    v_mfma_f32_16x16x32_bf16 v[16:19], a[4:7], a[32:35], 0
    s_add_u32 m0, s84, 0
    v_exp_f32 v203, v203
    v_mfma_f32_16x16x32_bf16 v[20:23], a[4:7], a[36:39], 0
    s_mov_b32 s82, 524288
    v_add_f32 v200, 1.0, v200
    v_add_f32 v201, 1.0, v201
    v_mfma_f32_16x16x32_bf16 v[24:27], a[4:7], a[40:43], 0
    buffer_load_dwordx4 v204, s[40:43], s82 offen offset:0 lds
    v_mfma_f32_16x16x32_bf16 v[28:31], a[4:7], a[44:47], 0
    s_waitcnt lgkmcnt(4)
    v_add_f32 v202, 1.0, v202
    v_add_f32 v203, 1.0, v203
    v_mfma_f32_16x16x32_bf16 v[32:35], a[8:11], a[32:35], 0
    v_rcp_f32 v200, v200
    v_mfma_f32_16x16x32_bf16 v[36:39], a[8:11], a[36:39], 0
    v_rcp_f32 v201, v201
    v_mfma_f32_16x16x32_bf16 v[40:43], a[8:11], a[40:43], 0
    buffer_load_dwordx4 v205, s[40:43], s82 offen offset:1024 lds
    v_mfma_f32_16x16x32_bf16 v[44:47], a[8:11], a[44:47], 0
    s_waitcnt lgkmcnt(2)
    ds_read_b64_tr_b16 a[20:21], v226 offset:36864
    ds_read_b64_tr_b16 a[22:23], v226 offset:37376
    v_mfma_f32_16x16x32_bf16 v[48:51], a[12:15], a[32:35], 0
    v_rcp_f32 v202, v202
    v_mfma_f32_16x16x32_bf16 v[52:55], a[12:15], a[36:39], 0
    buffer_load_dwordx4 v206, s[40:43], s82 offen offset:2048 lds
    v_mfma_f32_16x16x32_bf16 v[56:59], a[12:15], a[40:43], 0
    v_rcp_f32 v203, v203
    v_mfma_f32_16x16x32_bf16 v[60:63], a[12:15], a[44:47], 0
    s_waitcnt lgkmcnt(2)
    ds_read_b64_tr_b16 a[24:25], v228 offset:36864
    ds_read_b64_tr_b16 a[26:27], v228 offset:37376
    v_mul_f32 v196, v196, v200
    v_mfma_f32_16x16x32_bf16 v[64:67], a[16:19], a[32:35], 0
    v_mul_f32 v197, v197, v201
    v_mul_f32 v198, v198, v202
    v_mfma_f32_16x16x32_bf16 v[68:71], a[16:19], a[36:39], 0
    buffer_load_dwordx4 v207, s[40:43], s82 offen offset:3072 lds
    v_mfma_f32_16x16x32_bf16 v[72:75], a[16:19], a[40:43], 0
    s_waitcnt vmcnt(8)
    s_add_u32 m0, s84, 4096
    v_mul_f32 v199, v199, v203
    v_mfma_f32_16x16x32_bf16 v[76:79], a[16:19], a[44:47], 0
    s_waitcnt lgkmcnt(2)
    ds_read_b64_tr_b16 a[28:29], v230 offset:36864
    ds_read_b64_tr_b16 a[30:31], v230 offset:37376
    v_cvt_pk_bf16_f32 v200, v196, v197
    v_mfma_f32_16x16x32_bf16 v[80:83], a[20:23], a[32:35], 0
    s_mov_b32 s82, 524416
    buffer_load_dwordx4 v204, s[40:43], s82 offen offset:0 lds
    v_mfma_f32_16x16x32_bf16 v[84:87], a[20:23], a[36:39], 0
    ds_read_b128 a[48:51], v243 offset:4096
    ds_read_b128 a[52:55], v243 offset:5120
    v_cvt_pk_bf16_f32 v201, v198, v199
    v_mfma_f32_16x16x32_bf16 v[88:91], a[20:23], a[40:43], 0
    ds_read_b128 a[56:59], v244 offset:4096
    ds_read_b128 a[60:63], v244 offset:5120
    v_accvgpr_write_b32 a68, v200
    v_mfma_f32_16x16x32_bf16 v[92:95], a[20:23], a[44:47], 0
    s_waitcnt lgkmcnt(6)
    ds_read_b64_tr_b16 a[0:1], v225 offset:0
    ds_read_b64_tr_b16 a[2:3], v225 offset:512
    v_accvgpr_write_b32 a69, v201
    v_mfma_f32_16x16x32_bf16 v[96:99], a[24:27], a[32:35], 0
    buffer_load_dwordx4 v205, s[40:43], s82 offen offset:1024 lds
    v_mfma_f32_16x16x32_bf16 v[100:103], a[24:27], a[36:39], 0
    ds_read_b64_tr_b16 a[4:5], v227 offset:0
    v_mfma_f32_16x16x32_bf16 v[104:107], a[24:27], a[40:43], 0
    ds_read_b64_tr_b16 a[6:7], v227 offset:512
    v_mfma_f32_16x16x32_bf16 v[108:111], a[24:27], a[44:47], 0
    s_waitcnt lgkmcnt(8)
    ds_read_b64_tr_b16 a[8:9], v229 offset:0
    v_mfma_f32_16x16x32_bf16 v[112:115], a[28:31], a[32:35], 0
    buffer_load_dwordx4 v206, s[40:43], s82 offen offset:2048 lds
    v_mfma_f32_16x16x32_bf16 v[116:119], a[28:31], a[36:39], 0
    ds_read_b64_tr_b16 a[10:11], v229 offset:512
    v_mfma_f32_16x16x32_bf16 v[120:123], a[28:31], a[40:43], 0
    buffer_load_dwordx4 v207, s[40:43], s82 offen offset:3072 lds
    ds_read_b64_tr_b16 a[12:13], v231 offset:0
    ds_read_b64_tr_b16 a[14:15], v231 offset:512
    v_mfma_f32_16x16x32_bf16 v[124:127], a[28:31], a[44:47], 0
    s_waitcnt lgkmcnt(6)
    v_accvgpr_read_b32 v196, a72
    v_accvgpr_read_b32 v197, a73
    v_accvgpr_read_b32 v198, a74
    v_accvgpr_read_b32 v199, a75
    v_mul_f32 v200, v196, v196
    v_mul_f32 v201, v197, v197
    v_mul_f32 v202, v198, v198
    v_mul_f32 v203, v199, v199
    v_fma_f32 v200, v200, s85, v248
    v_fma_f32 v201, v201, s85, v248
    v_fma_f32 v202, v202, s85, v248
    v_fma_f32 v203, v203, s85, v248
    v_mul_f32 v200, v200, v196
    v_mul_f32 v201, v201, v197
    v_mul_f32 v202, v202, v198
    v_mul_f32 v203, v203, v199
    v_exp_f32 v200, v200
    v_exp_f32 v201, v201
    v_exp_f32 v202, v202
    v_exp_f32 v203, v203
    v_mfma_f32_16x16x32_bf16 v[0:3], a[0:3], a[48:51], v[0:3]
    s_add_u32 m0, s84, 32768
    v_add_f32 v200, 1.0, v200
    v_add_f32 v201, 1.0, v201
    v_mfma_f32_16x16x32_bf16 v[4:7], a[0:3], a[52:55], v[4:7]
    s_mov_b32 s82, 786432
    v_add_f32 v202, 1.0, v202
    v_add_f32 v203, 1.0, v203
    v_mfma_f32_16x16x32_bf16 v[8:11], a[0:3], a[56:59], v[8:11]
    s_waitcnt vmcnt(8)
    v_rcp_f32 v200, v200
    v_mfma_f32_16x16x32_bf16 v[12:15], a[0:3], a[60:63], v[12:15]
    s_waitcnt lgkmcnt(4)
    buffer_load_dwordx4 v204, s[40:43], s82 offen offset:0 lds
    v_mfma_f32_16x16x32_bf16 v[16:19], a[4:7], a[48:51], v[16:19]
    v_rcp_f32 v201, v201
    v_mfma_f32_16x16x32_bf16 v[20:23], a[4:7], a[52:55], v[20:23]
    v_rcp_f32 v202, v202
    v_mfma_f32_16x16x32_bf16 v[24:27], a[4:7], a[56:59], v[24:27]
    buffer_load_dwordx4 v205, s[40:43], s82 offen offset:1024 lds
    v_mfma_f32_16x16x32_bf16 v[28:31], a[4:7], a[60:63], v[28:31]
    s_waitcnt lgkmcnt(2)
    ds_read_b64_tr_b16 a[16:17], v225 offset:4096
    ds_read_b64_tr_b16 a[18:19], v225 offset:4608
    v_add_u32 v235, 131072, v238
    v_mfma_f32_16x16x32_bf16 v[32:35], a[8:11], a[48:51], v[32:35]
    v_rcp_f32 v203, v203
    v_mfma_f32_16x16x32_bf16 v[36:39], a[8:11], a[52:55], v[36:39]
    ds_read_b64_tr_b16 a[20:21], v227 offset:4096
    v_mul_f32 v196, v196, v200
    v_mfma_f32_16x16x32_bf16 v[40:43], a[8:11], a[56:59], v[40:43]
    buffer_load_dwordx4 v206, s[40:43], s82 offen offset:2048 lds
    v_mfma_f32_16x16x32_bf16 v[44:47], a[8:11], a[60:63], v[44:47]
    s_waitcnt lgkmcnt(3)
    ds_read_b64_tr_b16 a[22:23], v227 offset:4608
    v_mul_f32 v197, v197, v201
    v_mfma_f32_16x16x32_bf16 v[48:51], a[12:15], a[48:51], v[48:51]
    v_mul_f32 v198, v198, v202
    v_mul_f32 v199, v199, v203
    v_mfma_f32_16x16x32_bf16 v[52:55], a[12:15], a[52:55], v[52:55]
    ds_read_b64_tr_b16 a[24:25], v229 offset:4096
    v_cvt_pk_bf16_f32 v200, v196, v197
    v_mfma_f32_16x16x32_bf16 v[56:59], a[12:15], a[56:59], v[56:59]
    buffer_load_dwordx4 v207, s[40:43], s82 offen offset:3072 lds
    v_mfma_f32_16x16x32_bf16 v[60:63], a[12:15], a[60:63], v[60:63]
    s_waitcnt lgkmcnt(3)
    ds_read_b64_tr_b16 a[26:27], v229 offset:4608
    v_cvt_pk_bf16_f32 v201, v198, v199
    v_mfma_f32_16x16x32_bf16 v[64:67], a[16:19], a[48:51], v[64:67]
    s_add_u32 m0, s84, 36864
    s_mov_b32 s82, 786560
    v_accvgpr_write_b32 a72, v200
    v_mfma_f32_16x16x32_bf16 v[68:71], a[16:19], a[52:55], v[68:71]
    buffer_load_dwordx4 v204, s[40:43], s82 offen offset:0 lds
    v_mfma_f32_16x16x32_bf16 v[72:75], a[16:19], a[56:59], v[72:75]
    s_waitcnt vmcnt(9)
    ds_read_b64_tr_b16 a[28:29], v231 offset:4096
    v_accvgpr_write_b32 a73, v201
    v_mfma_f32_16x16x32_bf16 v[76:79], a[16:19], a[60:63], v[76:79]
    s_waitcnt lgkmcnt(3)
    ds_read_b64_tr_b16 a[30:31], v231 offset:4608
    v_add_u32 v237, 131072, v240
    v_mfma_f32_16x16x32_bf16 v[80:83], a[20:23], a[48:51], v[80:83]
    ds_read_b128 a[32:35], v243 offset:8192
    ds_read_b128 a[36:39], v243 offset:9216
    v_mfma_f32_16x16x32_bf16 v[84:87], a[20:23], a[52:55], v[84:87]
    buffer_load_dwordx4 v205, s[40:43], s82 offen offset:1024 lds
    v_mfma_f32_16x16x32_bf16 v[88:91], a[20:23], a[56:59], v[88:91]
    ds_read_b128 a[40:43], v244 offset:8192
    ds_read_b128 a[44:47], v244 offset:9216
    v_mfma_f32_16x16x32_bf16 v[92:95], a[20:23], a[60:63], v[92:95]
    s_waitcnt lgkmcnt(6)
    ds_read_b64_tr_b16 a[0:1], v224 offset:0
    ds_read_b64_tr_b16 a[2:3], v224 offset:512
    v_mfma_f32_16x16x32_bf16 v[96:99], a[24:27], a[48:51], v[96:99]
    buffer_load_dwordx4 v206, s[40:43], s82 offen offset:2048 lds
    v_mfma_f32_16x16x32_bf16 v[100:103], a[24:27], a[52:55], v[100:103]
    ds_read_b64_tr_b16 a[4:5], v226 offset:0
    v_mfma_f32_16x16x32_bf16 v[104:107], a[24:27], a[56:59], v[104:107]
    ds_read_b64_tr_b16 a[6:7], v226 offset:512
    ds_read_b64_tr_b16 a[8:9], v228 offset:0
    v_mfma_f32_16x16x32_bf16 v[108:111], a[24:27], a[60:63], v[108:111]
    s_waitcnt lgkmcnt(9)
    buffer_load_dwordx4 v207, s[40:43], s82 offen offset:3072 lds
    v_mfma_f32_16x16x32_bf16 v[112:115], a[28:31], a[48:51], v[112:115]
    s_add_u32 m0, s84, 65536
    v_accvgpr_read_b32 v196, a76
    v_accvgpr_read_b32 v197, a77
    v_accvgpr_read_b32 v198, a78
    v_accvgpr_read_b32 v199, a79
    v_mul_f32 v200, v196, v196
    v_mul_f32 v201, v197, v197
    v_mul_f32 v202, v198, v198
    v_mul_f32 v203, v199, v199
    v_fma_f32 v200, v200, s85, v248
    v_fma_f32 v201, v201, s85, v248
    v_fma_f32 v202, v202, s85, v248
    v_fma_f32 v203, v203, s85, v248
    v_mul_f32 v200, v200, v196
    v_mul_f32 v201, v201, v197
    v_mul_f32 v202, v202, v198
    v_mul_f32 v203, v203, v199
    v_exp_f32 v200, v200
    v_exp_f32 v201, v201
    v_exp_f32 v202, v202
    v_exp_f32 v203, v203
    v_add_f32 v200, 1.0, v200
    v_add_f32 v201, 1.0, v201
    v_add_f32 v202, 1.0, v202
    v_add_f32 v203, 1.0, v203
    v_rcp_f32 v200, v200
    v_rcp_f32 v201, v201
    v_mfma_f32_16x16x32_bf16 v[116:119], a[28:31], a[52:55], v[116:119]
    s_mov_b32 s82, 1048576
    v_rcp_f32 v202, v202
    v_mfma_f32_16x16x32_bf16 v[120:123], a[28:31], a[56:59], v[120:123]
    v_rcp_f32 v203, v203
    v_mfma_f32_16x16x32_bf16 v[124:127], a[28:31], a[60:63], v[124:127]
    s_waitcnt lgkmcnt(3)
    ds_read_b64_tr_b16 a[10:11], v228 offset:512
    v_mul_f32 v196, v196, v200
    v_mfma_f32_16x16x32_bf16 v[0:3], a[0:3], a[32:35], v[0:3]
    buffer_load_dwordx4 v204, s[40:43], s82 offen offset:0 lds
    v_mfma_f32_16x16x32_bf16 v[4:7], a[0:3], a[36:39], v[4:7]
    v_mul_f32 v197, v197, v201
    v_mul_f32 v198, v198, v202
    v_mfma_f32_16x16x32_bf16 v[8:11], a[0:3], a[40:43], v[8:11]
    s_waitcnt vmcnt(9)
    s_barrier
    ds_read_b64_tr_b16 a[12:13], v230 offset:0
    ds_read_b64_tr_b16 a[14:15], v230 offset:512
    v_mul_f32 v199, v199, v203
    v_mfma_f32_16x16x32_bf16 v[12:15], a[0:3], a[44:47], v[12:15]
    s_waitcnt lgkmcnt(4)
    buffer_load_dwordx4 v205, s[40:43], s82 offen offset:1024 lds
    v_mfma_f32_16x16x32_bf16 v[16:19], a[4:7], a[32:35], v[16:19]
    v_cvt_pk_bf16_f32 v200, v196, v197
    v_cvt_pk_bf16_f32 v201, v198, v199
    v_mfma_f32_16x16x32_bf16 v[20:23], a[4:7], a[36:39], v[20:23]
    ds_read_b64_tr_b16 a[16:17], v224 offset:4096
    v_accvgpr_write_b32 a76, v200
    v_mfma_f32_16x16x32_bf16 v[24:27], a[4:7], a[40:43], v[24:27]
    ds_read_b64_tr_b16 a[18:19], v224 offset:4608
    v_accvgpr_write_b32 a77, v201
    v_mfma_f32_16x16x32_bf16 v[28:31], a[4:7], a[44:47], v[28:31]
    s_waitcnt lgkmcnt(4)
    buffer_load_dwordx4 v206, s[40:43], s82 offen offset:2048 lds
    v_mfma_f32_16x16x32_bf16 v[32:35], a[8:11], a[32:35], v[32:35]
    ds_read_b64_tr_b16 a[20:21], v226 offset:4096
    v_mov_b32 v195, 0x7f000000
    v_mfma_f32_16x16x32_bf16 v[36:39], a[8:11], a[36:39], v[36:39]
    s_mul_i32 s86, s89, 16
    v_add_u32 v255, s86, v251
    v_lshlrev_b32 v255, 7, v255
    v_mfma_f32_16x16x32_bf16 v[40:43], a[8:11], a[40:43], v[40:43]
    buffer_load_dwordx4 v207, s[40:43], s82 offen offset:3072 lds
    v_mfma_f32_16x16x32_bf16 v[44:47], a[8:11], a[44:47], v[44:47]
    s_waitcnt lgkmcnt(3)
    ds_read_b64_tr_b16 a[22:23], v226 offset:4608
    v_cmp_gt_u32 vcc, 16, v251
    v_mfma_f32_16x16x32_bf16 v[48:51], a[12:15], a[32:35], v[48:51]
    s_add_u32 m0, s84, 69632
    s_mov_b32 s82, 1048704
    v_cndmask_b32 v255, v195, v255, vcc
    v_mfma_f32_16x16x32_bf16 v[52:55], a[12:15], a[36:39], v[52:55]
    buffer_load_dword v252, v255, s[48:51], 0 offen
    v_mfma_f32_16x16x32_bf16 v[56:59], a[12:15], a[40:43], v[56:59]
    buffer_load_dwordx4 v204, s[40:43], s82 offen offset:0 lds
    v_mfma_f32_16x16x32_bf16 v[60:63], a[12:15], a[44:47], v[60:63]
    s_waitcnt lgkmcnt(2)
    ds_read_b64_tr_b16 a[24:25], v228 offset:4096
    ds_read_b64_tr_b16 a[26:27], v228 offset:4608
    v_mfma_f32_16x16x32_bf16 v[64:67], a[16:19], a[32:35], v[64:67]
    buffer_load_dword v252, v255, s[52:55], 0 offen
    v_mfma_f32_16x16x32_bf16 v[68:71], a[16:19], a[36:39], v[68:71]
    ds_read_b128 a[48:51], v243 offset:12288
    ds_read_b128 a[52:55], v243 offset:13312
    v_mfma_f32_16x16x32_bf16 v[72:75], a[16:19], a[40:43], v[72:75]
    s_waitcnt vmcnt(11)
    buffer_load_dwordx4 v205, s[40:43], s82 offen offset:1024 lds
    v_mfma_f32_16x16x32_bf16 v[76:79], a[16:19], a[44:47], v[76:79]
    s_waitcnt lgkmcnt(4)
    ds_read_b64_tr_b16 a[28:29], v230 offset:4096
    ds_read_b64_tr_b16 a[30:31], v230 offset:4608
    v_mfma_f32_16x16x32_bf16 v[80:83], a[20:23], a[32:35], v[80:83]
    ds_read_b128 a[56:59], v244 offset:12288
    ds_read_b128 a[60:63], v244 offset:13312
    v_mfma_f32_16x16x32_bf16 v[84:87], a[20:23], a[36:39], v[84:87]
    buffer_load_dwordx4 v206, s[40:43], s82 offen offset:2048 lds
    v_mfma_f32_16x16x32_bf16 v[88:91], a[20:23], a[40:43], v[88:91]
    ds_read_b64_tr_b16 a[0:1], v224 offset:32768
    ds_read_b64_tr_b16 a[2:3], v224 offset:33280
    v_mfma_f32_16x16x32_bf16 v[92:95], a[20:23], a[44:47], v[92:95]
    s_waitcnt lgkmcnt(8)
    ds_read_b64_tr_b16 a[4:5], v226 offset:32768
    ds_read_b64_tr_b16 a[6:7], v226 offset:33280
    v_mfma_f32_16x16x32_bf16 v[96:99], a[24:27], a[32:35], v[96:99]
    buffer_load_dwordx4 v207, s[40:43], s82 offen offset:3072 lds
    v_mfma_f32_16x16x32_bf16 v[100:103], a[24:27], a[36:39], v[100:103]
    s_add_u32 m0, s84, 0
    v_accvgpr_read_b32 v196, a80
    v_accvgpr_read_b32 v197, a81
    v_accvgpr_read_b32 v198, a82
    v_accvgpr_read_b32 v199, a83
    v_mul_f32 v200, v196, v196
    v_mul_f32 v201, v197, v197
    v_mul_f32 v202, v198, v198
    v_mul_f32 v203, v199, v199
    v_fma_f32 v200, v200, s85, v248
    v_fma_f32 v201, v201, s85, v248
    v_fma_f32 v202, v202, s85, v248
    v_fma_f32 v203, v203, s85, v248
    v_mul_f32 v200, v200, v196
    v_mul_f32 v201, v201, v197
    v_mul_f32 v202, v202, v198
    v_mul_f32 v203, v203, v199
    v_exp_f32 v200, v200
    v_exp_f32 v201, v201
    v_exp_f32 v202, v202
    v_mfma_f32_16x16x32_bf16 v[104:107], a[24:27], a[40:43], v[104:107]
    s_mov_b32 s82, 1310720
    v_exp_f32 v203, v203
    v_mfma_f32_16x16x32_bf16 v[108:111], a[24:27], a[44:47], v[108:111]
    s_waitcnt lgkmcnt(6)
    v_add_f32 v200, 1.0, v200
    v_add_f32 v201, 1.0, v201
    v_mfma_f32_16x16x32_bf16 v[112:115], a[28:31], a[32:35], v[112:115]
    buffer_load_dwordx4 v204, s[40:43], s82 offen offset:0 lds
    v_mfma_f32_16x16x32_bf16 v[116:119], a[28:31], a[36:39], v[116:119]
    v_add_f32 v202, 1.0, v202
    v_add_f32 v203, 1.0, v203
    v_mfma_f32_16x16x32_bf16 v[120:123], a[28:31], a[40:43], v[120:123]
    v_rcp_f32 v200, v200
    v_mfma_f32_16x16x32_bf16 v[124:127], a[28:31], a[44:47], v[124:127]
    s_waitcnt lgkmcnt(2)
    ds_read_b64_tr_b16 a[8:9], v228 offset:32768
    ds_read_b64_tr_b16 a[10:11], v228 offset:33280
    v_mfma_f32_16x16x32_bf16 v[0:3], a[0:3], a[48:51], v[0:3]
    buffer_load_dwordx4 v205, s[40:43], s82 offen offset:1024 lds
    v_mfma_f32_16x16x32_bf16 v[4:7], a[0:3], a[52:55], v[4:7]
    v_rcp_f32 v201, v201
    v_mfma_f32_16x16x32_bf16 v[8:11], a[0:3], a[56:59], v[8:11]
    s_waitcnt vmcnt(12)
    v_rcp_f32 v202, v202
    v_mfma_f32_16x16x32_bf16 v[12:15], a[0:3], a[60:63], v[12:15]
    s_waitcnt lgkmcnt(2)
    ds_read_b64_tr_b16 a[12:13], v230 offset:32768
    ds_read_b64_tr_b16 a[14:15], v230 offset:33280
    v_mfma_f32_16x16x32_bf16 v[16:19], a[4:7], a[48:51], v[16:19]
    buffer_load_dwordx4 v206, s[40:43], s82 offen offset:2048 lds
    v_mfma_f32_16x16x32_bf16 v[20:23], a[4:7], a[52:55], v[20:23]
    v_rcp_f32 v203, v203
    v_mfma_f32_16x16x32_bf16 v[24:27], a[4:7], a[56:59], v[24:27]
    ds_read_b64_tr_b16 a[16:17], v224 offset:36864
    ds_read_b64_tr_b16 a[18:19], v224 offset:37376
    v_mul_f32 v196, v196, v200
    v_mfma_f32_16x16x32_bf16 v[28:31], a[4:7], a[60:63], v[28:31]
    s_waitcnt lgkmcnt(4)
    buffer_load_dwordx4 v207, s[40:43], s82 offen offset:3072 lds
    v_mfma_f32_16x16x32_bf16 v[32:35], a[8:11], a[48:51], v[32:35]
    s_add_u32 m0, s84, 4096
    v_mul_f32 v197, v197, v201
    v_mul_f32 v198, v198, v202
    v_mfma_f32_16x16x32_bf16 v[36:39], a[8:11], a[52:55], v[36:39]
    s_mov_b32 s82, 1310848
    ds_read_b64_tr_b16 a[20:21], v226 offset:36864
    v_mul_f32 v199, v199, v203
    v_mfma_f32_16x16x32_bf16 v[40:43], a[8:11], a[56:59], v[40:43]
    ds_read_b64_tr_b16 a[22:23], v226 offset:37376
    v_cvt_pk_bf16_f32 v200, v196, v197
    v_mfma_f32_16x16x32_bf16 v[44:47], a[8:11], a[60:63], v[44:47]
    s_waitcnt lgkmcnt(4)
    buffer_load_dwordx4 v204, s[40:43], s82 offen offset:0 lds
    v_mfma_f32_16x16x32_bf16 v[48:51], a[12:15], a[48:51], v[48:51]
    v_cvt_pk_bf16_f32 v201, v198, v199
    v_accvgpr_write_b32 a80, v200
    v_mfma_f32_16x16x32_bf16 v[52:55], a[12:15], a[52:55], v[52:55]
    ds_read_b64_tr_b16 a[24:25], v228 offset:36864
    v_accvgpr_write_b32 a81, v201
    v_mfma_f32_16x16x32_bf16 v[56:59], a[12:15], a[56:59], v[56:59]
    ds_read_b64_tr_b16 a[26:27], v228 offset:37376
    v_mfma_f32_16x16x32_bf16 v[60:63], a[12:15], a[60:63], v[60:63]
    s_waitcnt lgkmcnt(4)
    buffer_load_dwordx4 v205, s[40:43], s82 offen offset:1024 lds
    v_mfma_f32_16x16x32_bf16 v[64:67], a[16:19], a[48:51], v[64:67]
    ds_read_b128 a[32:35], v243 offset:16384
    ds_read_b128 a[36:39], v243 offset:17408
    v_mfma_f32_16x16x32_bf16 v[68:71], a[16:19], a[52:55], v[68:71]
    ds_read_b128 a[40:43], v244 offset:16384
    ds_read_b128 a[44:47], v244 offset:17408
    v_mfma_f32_16x16x32_bf16 v[72:75], a[16:19], a[56:59], v[72:75]
    s_waitcnt vmcnt(12)
    buffer_load_dwordx4 v206, s[40:43], s82 offen offset:2048 lds
    v_mfma_f32_16x16x32_bf16 v[76:79], a[16:19], a[60:63], v[76:79]
    s_waitcnt lgkmcnt(6)
    ds_read_b64_tr_b16 a[28:29], v230 offset:36864
    ds_read_b64_tr_b16 a[30:31], v230 offset:37376
    v_mfma_f32_16x16x32_bf16 v[80:83], a[20:23], a[48:51], v[80:83]
    ds_read_b64_tr_b16 a[0:1], v225 offset:0
    ds_read_b64_tr_b16 a[2:3], v225 offset:512
    v_mfma_f32_16x16x32_bf16 v[84:87], a[20:23], a[52:55], v[84:87]
    buffer_load_dwordx4 v207, s[40:43], s82 offen offset:3072 lds
    v_mfma_f32_16x16x32_bf16 v[88:91], a[20:23], a[56:59], v[88:91]
    s_add_u32 m0, s84, 32768
    ds_read_b64_tr_b16 a[4:5], v227 offset:0
    ds_read_b64_tr_b16 a[6:7], v227 offset:512
    v_accvgpr_read_b32 v196, a84
    v_accvgpr_read_b32 v197, a85
    v_accvgpr_read_b32 v198, a86
    v_accvgpr_read_b32 v199, a87
    v_mul_f32 v200, v196, v196
    v_mul_f32 v201, v197, v197
    v_mul_f32 v202, v198, v198
    v_mul_f32 v203, v199, v199
    v_fma_f32 v200, v200, s85, v248
    v_fma_f32 v201, v201, s85, v248
    v_fma_f32 v202, v202, s85, v248
    v_fma_f32 v203, v203, s85, v248
    v_mul_f32 v200, v200, v196
    v_mul_f32 v201, v201, v197
    v_mul_f32 v202, v202, v198
    v_mul_f32 v203, v203, v199
    v_exp_f32 v200, v200
    v_exp_f32 v201, v201
    v_mfma_f32_16x16x32_bf16 v[92:95], a[20:23], a[60:63], v[92:95]
    s_waitcnt lgkmcnt(10)
    v_exp_f32 v202, v202
    v_mfma_f32_16x16x32_bf16 v[96:99], a[24:27], a[48:51], v[96:99]
    s_mov_b32 s82, 1572864
    v_exp_f32 v203, v203
    v_mfma_f32_16x16x32_bf16 v[100:103], a[24:27], a[52:55], v[100:103]
    buffer_load_dwordx4 v204, s[40:43], s82 offen offset:0 lds
    v_mfma_f32_16x16x32_bf16 v[104:107], a[24:27], a[56:59], v[104:107]
    v_add_f32 v200, 1.0, v200
    v_add_f32 v201, 1.0, v201
    v_mfma_f32_16x16x32_bf16 v[108:111], a[24:27], a[60:63], v[108:111]
    s_waitcnt lgkmcnt(4)
    v_add_f32 v202, 1.0, v202
    v_add_f32 v203, 1.0, v203
    v_mfma_f32_16x16x32_bf16 v[112:115], a[28:31], a[48:51], v[112:115]
    v_rcp_f32 v200, v200
    v_mfma_f32_16x16x32_bf16 v[116:119], a[28:31], a[52:55], v[116:119]
    buffer_load_dwordx4 v205, s[40:43], s82 offen offset:1024 lds
    v_mfma_f32_16x16x32_bf16 v[120:123], a[28:31], a[56:59], v[120:123]
    v_rcp_f32 v201, v201
    v_mfma_f32_16x16x32_bf16 v[124:127], a[28:31], a[60:63], v[124:127]
    s_waitcnt lgkmcnt(2)
    ds_read_b64_tr_b16 a[8:9], v229 offset:0
    ds_read_b64_tr_b16 a[10:11], v229 offset:512
    v_mfma_f32_16x16x32_bf16 v[0:3], a[0:3], a[32:35], v[0:3]
    v_rcp_f32 v202, v202
    v_mfma_f32_16x16x32_bf16 v[4:7], a[0:3], a[36:39], v[4:7]
    buffer_load_dwordx4 v206, s[40:43], s82 offen offset:2048 lds
    v_mfma_f32_16x16x32_bf16 v[8:11], a[0:3], a[40:43], v[8:11]
    s_waitcnt vmcnt(11)
    v_rcp_f32 v203, v203
    v_mfma_f32_16x16x32_bf16 v[12:15], a[0:3], a[44:47], v[12:15]
    s_waitcnt lgkmcnt(2)
    ds_read_b64_tr_b16 a[12:13], v231 offset:0
    ds_read_b64_tr_b16 a[14:15], v231 offset:512
    v_mul_f32 v196, v196, v200
    v_mfma_f32_16x16x32_bf16 v[16:19], a[4:7], a[32:35], v[16:19]
    buffer_load_dwordx4 v207, s[40:43], s82 offen offset:3072 lds
    v_mfma_f32_16x16x32_bf16 v[20:23], a[4:7], a[36:39], v[20:23]
    s_add_u32 m0, s84, 36864
    v_mul_f32 v197, v197, v201
    v_mul_f32 v198, v198, v202
    v_mfma_f32_16x16x32_bf16 v[24:27], a[4:7], a[40:43], v[24:27]
    s_mov_b32 s82, 1572992
    ds_read_b64_tr_b16 a[16:17], v225 offset:4096
    v_mul_f32 v199, v199, v203
    v_mfma_f32_16x16x32_bf16 v[28:31], a[4:7], a[44:47], v[28:31]
    s_waitcnt lgkmcnt(3)
    ds_read_b64_tr_b16 a[18:19], v225 offset:4608
    v_cvt_pk_bf16_f32 v200, v196, v197
    v_mfma_f32_16x16x32_bf16 v[32:35], a[8:11], a[32:35], v[32:35]
    buffer_load_dwordx4 v204, s[40:43], s82 offen offset:0 lds
    v_mfma_f32_16x16x32_bf16 v[36:39], a[8:11], a[36:39], v[36:39]
    ds_read_b64_tr_b16 a[20:21], v227 offset:4096
    v_cvt_pk_bf16_f32 v201, v198, v199
    v_mfma_f32_16x16x32_bf16 v[40:43], a[8:11], a[40:43], v[40:43]
    ds_read_b64_tr_b16 a[22:23], v227 offset:4608
    v_accvgpr_write_b32 a84, v200
    v_mfma_f32_16x16x32_bf16 v[44:47], a[8:11], a[44:47], v[44:47]
    s_waitcnt lgkmcnt(4)
    buffer_load_dwordx4 v205, s[40:43], s82 offen offset:1024 lds
    v_mfma_f32_16x16x32_bf16 v[48:51], a[12:15], a[32:35], v[48:51]
    ds_read_b128 a[48:51], v243 offset:20480
    v_accvgpr_write_b32 a85, v201
    v_mfma_f32_16x16x32_bf16 v[52:55], a[12:15], a[36:39], v[52:55]
    ds_read_b128 a[52:55], v243 offset:21504
    v_mfma_f32_16x16x32_bf16 v[56:59], a[12:15], a[40:43], v[56:59]
    ds_read_b64_tr_b16 a[24:25], v229 offset:4096
    ds_read_b64_tr_b16 a[26:27], v229 offset:4608
    v_mfma_f32_16x16x32_bf16 v[60:63], a[12:15], a[44:47], v[60:63]
    s_waitcnt lgkmcnt(6)
    buffer_load_dwordx4 v206, s[40:43], s82 offen offset:2048 lds
    v_mfma_f32_16x16x32_bf16 v[64:67], a[16:19], a[32:35], v[64:67]
    ds_read_b128 a[56:59], v244 offset:20480
    ds_read_b128 a[60:63], v244 offset:21504
    v_mfma_f32_16x16x32_bf16 v[68:71], a[16:19], a[36:39], v[68:71]
    ds_read_b64_tr_b16 a[28:29], v231 offset:4096
    ds_read_b64_tr_b16 a[30:31], v231 offset:4608
    v_mfma_f32_16x16x32_bf16 v[72:75], a[16:19], a[40:43], v[72:75]
    s_waitcnt vmcnt(11)
    buffer_load_dwordx4 v207, s[40:43], s82 offen offset:3072 lds
    ds_read_b64_tr_b16 a[0:1], v224 offset:0
    ds_read_b64_tr_b16 a[2:3], v224 offset:512
    v_mfma_f32_16x16x32_bf16 v[76:79], a[16:19], a[44:47], v[76:79]
    s_waitcnt lgkmcnt(10)
    v_accvgpr_read_b32 v196, a88
    v_accvgpr_read_b32 v197, a89
    v_accvgpr_read_b32 v198, a90
    v_accvgpr_read_b32 v199, a91
    v_mul_f32 v200, v196, v196
    v_mul_f32 v201, v197, v197
    v_mul_f32 v202, v198, v198
    v_mul_f32 v203, v199, v199
    v_fma_f32 v200, v200, s85, v248
    v_fma_f32 v201, v201, s85, v248
    v_fma_f32 v202, v202, s85, v248
    v_fma_f32 v203, v203, s85, v248
    v_mul_f32 v200, v200, v196
    v_mul_f32 v201, v201, v197
    v_mul_f32 v202, v202, v198
    v_mul_f32 v203, v203, v199
    v_exp_f32 v200, v200
    v_exp_f32 v201, v201
    v_exp_f32 v202, v202
    v_mfma_f32_16x16x32_bf16 v[80:83], a[20:23], a[32:35], v[80:83]
    s_add_u32 m0, s84, 65536
    v_exp_f32 v203, v203
    v_mfma_f32_16x16x32_bf16 v[84:87], a[20:23], a[36:39], v[84:87]
    s_mov_b32 s82, 1835008
    v_add_f32 v200, 1.0, v200
    v_add_f32 v201, 1.0, v201
    v_mfma_f32_16x16x32_bf16 v[88:91], a[20:23], a[40:43], v[88:91]
    buffer_load_dwordx4 v204, s[40:43], s82 offen offset:0 lds
    v_mfma_f32_16x16x32_bf16 v[92:95], a[20:23], a[44:47], v[92:95]
    s_waitcnt lgkmcnt(6)
    v_add_f32 v202, 1.0, v202
    v_add_f32 v203, 1.0, v203
    v_mfma_f32_16x16x32_bf16 v[96:99], a[24:27], a[32:35], v[96:99]
    v_rcp_f32 v200, v200
    v_mfma_f32_16x16x32_bf16 v[100:103], a[24:27], a[36:39], v[100:103]
    v_rcp_f32 v201, v201
    v_mfma_f32_16x16x32_bf16 v[104:107], a[24:27], a[40:43], v[104:107]
    buffer_load_dwordx4 v205, s[40:43], s82 offen offset:1024 lds
    v_mfma_f32_16x16x32_bf16 v[108:111], a[24:27], a[44:47], v[108:111]
    s_waitcnt lgkmcnt(2)
    ds_read_b64_tr_b16 a[4:5], v226 offset:0
    ds_read_b64_tr_b16 a[6:7], v226 offset:512
    v_mfma_f32_16x16x32_bf16 v[112:115], a[28:31], a[32:35], v[112:115]
    v_rcp_f32 v202, v202
    v_mfma_f32_16x16x32_bf16 v[116:119], a[28:31], a[36:39], v[116:119]
    buffer_load_dwordx4 v206, s[40:43], s82 offen offset:2048 lds
    v_mfma_f32_16x16x32_bf16 v[120:123], a[28:31], a[40:43], v[120:123]
    v_rcp_f32 v203, v203
    v_mfma_f32_16x16x32_bf16 v[124:127], a[28:31], a[44:47], v[124:127]
    s_waitcnt lgkmcnt(2)
    ds_read_b64_tr_b16 a[8:9], v228 offset:0
    ds_read_b64_tr_b16 a[10:11], v228 offset:512
    v_mul_f32 v196, v196, v200
    v_mfma_f32_16x16x32_bf16 v[0:3], a[0:3], a[48:51], v[0:3]
    v_mul_f32 v197, v197, v201
    v_mul_f32 v198, v198, v202
    v_mfma_f32_16x16x32_bf16 v[4:7], a[0:3], a[52:55], v[4:7]
    buffer_load_dwordx4 v207, s[40:43], s82 offen offset:3072 lds
    v_mfma_f32_16x16x32_bf16 v[8:11], a[0:3], a[56:59], v[8:11]
    s_waitcnt vmcnt(12)
    ds_read_b64_tr_b16 a[12:13], v230 offset:0
    v_mul_f32 v199, v199, v203
    v_mfma_f32_16x16x32_bf16 v[12:15], a[0:3], a[60:63], v[12:15]
    s_waitcnt lgkmcnt(3)
    ds_read_b64_tr_b16 a[14:15], v230 offset:512
    v_cvt_pk_bf16_f32 v200, v196, v197
    v_mfma_f32_16x16x32_bf16 v[16:19], a[4:7], a[48:51], v[16:19]
    s_add_u32 m0, s84, 69632
    s_mov_b32 s82, 1835136
    v_cvt_pk_bf16_f32 v201, v198, v199
    v_mfma_f32_16x16x32_bf16 v[20:23], a[4:7], a[52:55], v[20:23]
    buffer_load_dwordx4 v204, s[40:43], s82 offen offset:0 lds
    v_mfma_f32_16x16x32_bf16 v[24:27], a[4:7], a[56:59], v[24:27]
    v_accvgpr_write_b32 a88, v200
    v_accvgpr_write_b32 a89, v201
    v_mfma_f32_16x16x32_bf16 v[28:31], a[4:7], a[60:63], v[28:31]
    s_waitcnt lgkmcnt(2)
    ds_read_b64_tr_b16 a[16:17], v224 offset:4096
    ds_read_b64_tr_b16 a[18:19], v224 offset:4608
    v_mfma_f32_16x16x32_bf16 v[32:35], a[8:11], a[48:51], v[32:35]
    buffer_load_dwordx4 v205, s[40:43], s82 offen offset:1024 lds
    v_mfma_f32_16x16x32_bf16 v[36:39], a[8:11], a[52:55], v[36:39]
    ds_read_b128 a[32:35], v243 offset:24576
    ds_read_b128 a[36:39], v243 offset:25600
    v_mfma_f32_16x16x32_bf16 v[40:43], a[8:11], a[56:59], v[40:43]
    ds_read_b128 a[40:43], v244 offset:24576
    ds_read_b128 a[44:47], v244 offset:25600
    v_mfma_f32_16x16x32_bf16 v[44:47], a[8:11], a[60:63], v[44:47]
    s_waitcnt lgkmcnt(6)
    ds_read_b64_tr_b16 a[20:21], v226 offset:4096
    ds_read_b64_tr_b16 a[22:23], v226 offset:4608
    v_mfma_f32_16x16x32_bf16 v[48:51], a[12:15], a[48:51], v[48:51]
    buffer_load_dwordx4 v206, s[40:43], s82 offen offset:2048 lds
    v_mfma_f32_16x16x32_bf16 v[52:55], a[12:15], a[52:55], v[52:55]
    ds_read_b64_tr_b16 a[24:25], v228 offset:4096
    ds_read_b64_tr_b16 a[26:27], v228 offset:4608
    v_mfma_f32_16x16x32_bf16 v[56:59], a[12:15], a[56:59], v[56:59]
    ds_read_b64_tr_b16 a[28:29], v230 offset:4096
    ds_read_b64_tr_b16 a[30:31], v230 offset:4608
    v_mfma_f32_16x16x32_bf16 v[60:63], a[12:15], a[60:63], v[60:63]
    s_waitcnt lgkmcnt(10)
    buffer_load_dwordx4 v207, s[40:43], s82 offen offset:3072 lds
    v_mfma_f32_16x16x32_bf16 v[64:67], a[16:19], a[48:51], v[64:67]
    s_add_u32 m0, s84, 0
    v_accvgpr_read_b32 v196, a92
    v_accvgpr_read_b32 v197, a93
    v_accvgpr_read_b32 v198, a94
    v_accvgpr_read_b32 v199, a95
    v_mul_f32 v200, v196, v196
    v_mul_f32 v201, v197, v197
    v_mul_f32 v202, v198, v198
    v_mul_f32 v203, v199, v199
    v_fma_f32 v200, v200, s85, v248
    v_fma_f32 v201, v201, s85, v248
    v_fma_f32 v202, v202, s85, v248
    v_fma_f32 v203, v203, s85, v248
    v_mul_f32 v200, v200, v196
    v_mul_f32 v201, v201, v197
    v_mul_f32 v202, v202, v198
    v_mul_f32 v203, v203, v199
    v_exp_f32 v200, v200
    v_exp_f32 v201, v201
    v_exp_f32 v202, v202
    v_mfma_f32_16x16x32_bf16 v[68:71], a[16:19], a[52:55], v[68:71]
    s_mov_b32 s82, 2097152
    v_exp_f32 v203, v203
    v_mfma_f32_16x16x32_bf16 v[72:75], a[16:19], a[56:59], v[72:75]
    s_waitcnt vmcnt(12)
    v_add_f32 v200, 1.0, v200
    v_add_f32 v201, 1.0, v201
    v_mfma_f32_16x16x32_bf16 v[76:79], a[16:19], a[60:63], v[76:79]
    s_waitcnt lgkmcnt(4)
    buffer_load_dwordx4 v204, s[40:43], s82 offen offset:0 lds
    v_mfma_f32_16x16x32_bf16 v[80:83], a[20:23], a[48:51], v[80:83]
    v_add_f32 v202, 1.0, v202
    v_add_f32 v203, 1.0, v203
    v_mfma_f32_16x16x32_bf16 v[84:87], a[20:23], a[52:55], v[84:87]
    v_rcp_f32 v200, v200
    v_mfma_f32_16x16x32_bf16 v[88:91], a[20:23], a[56:59], v[88:91]
    ds_read_b64_tr_b16 a[0:1], v224 offset:32768
    ds_read_b64_tr_b16 a[2:3], v224 offset:33280
    v_mfma_f32_16x16x32_bf16 v[92:95], a[20:23], a[60:63], v[92:95]
    s_waitcnt lgkmcnt(4)
    buffer_load_dwordx4 v205, s[40:43], s82 offen offset:1024 lds
    v_mfma_f32_16x16x32_bf16 v[96:99], a[24:27], a[48:51], v[96:99]
    v_rcp_f32 v201, v201
    v_mfma_f32_16x16x32_bf16 v[100:103], a[24:27], a[52:55], v[100:103]
    v_rcp_f32 v202, v202
    v_mfma_f32_16x16x32_bf16 v[104:107], a[24:27], a[56:59], v[104:107]
    buffer_load_dwordx4 v206, s[40:43], s82 offen offset:2048 lds
    v_mfma_f32_16x16x32_bf16 v[108:111], a[24:27], a[60:63], v[108:111]
    s_waitcnt lgkmcnt(2)
    ds_read_b64_tr_b16 a[4:5], v226 offset:32768
    ds_read_b64_tr_b16 a[6:7], v226 offset:33280
    v_mfma_f32_16x16x32_bf16 v[112:115], a[28:31], a[48:51], v[112:115]
    v_rcp_f32 v203, v203
    v_mfma_f32_16x16x32_bf16 v[116:119], a[28:31], a[52:55], v[116:119]
    v_mul_f32 v196, v196, v200
    v_mul_f32 v197, v197, v201
    v_mfma_f32_16x16x32_bf16 v[120:123], a[28:31], a[56:59], v[120:123]
    buffer_load_dwordx4 v207, s[40:43], s82 offen offset:3072 lds
    v_mfma_f32_16x16x32_bf16 v[124:127], a[28:31], a[60:63], v[124:127]
    s_waitcnt lgkmcnt(2)
    ds_read_b64_tr_b16 a[8:9], v228 offset:32768
    ds_read_b64_tr_b16 a[10:11], v228 offset:33280
    v_mul_f32 v198, v198, v202
    v_mfma_f32_16x16x32_bf16 v[0:3], a[0:3], a[32:35], v[0:3]
    s_add_u32 m0, s84, 4096
    s_mov_b32 s82, 2097280
    v_mul_f32 v199, v199, v203
    v_mfma_f32_16x16x32_bf16 v[4:7], a[0:3], a[36:39], v[4:7]
    buffer_load_dwordx4 v204, s[40:43], s82 offen offset:0 lds
    v_mfma_f32_16x16x32_bf16 v[8:11], a[0:3], a[40:43], v[8:11]
    s_waitcnt vmcnt(13)
    s_barrier
    v_cvt_pk_bf16_f32 v200, v196, v197
    v_cvt_pk_bf16_f32 v201, v198, v199
    v_mfma_f32_16x16x32_bf16 v[12:15], a[0:3], a[44:47], v[12:15]
    s_waitcnt lgkmcnt(2)
    ds_read_b64_tr_b16 a[12:13], v230 offset:32768
    ds_read_b64_tr_b16 a[14:15], v230 offset:33280
    v_accvgpr_write_b32 a92, v200
    v_mfma_f32_16x16x32_bf16 v[16:19], a[4:7], a[32:35], v[16:19]
    ds_read_b64_tr_b16 a[16:17], v224 offset:36864
    v_accvgpr_write_b32 a93, v201
    v_mfma_f32_16x16x32_bf16 v[20:23], a[4:7], a[36:39], v[20:23]
    buffer_load_dwordx4 v205, s[40:43], s82 offen offset:1024 lds
    v_mfma_f32_16x16x32_bf16 v[24:27], a[4:7], a[40:43], v[24:27]
    ds_read_b64_tr_b16 a[18:19], v224 offset:37376
    v_mfma_f32_16x16x32_bf16 v[28:31], a[4:7], a[44:47], v[28:31]
    s_waitcnt lgkmcnt(4)
    ds_read_b128 a[48:51], v243 offset:28672
    ds_read_b128 a[52:55], v243 offset:29696
    v_mfma_f32_16x16x32_bf16 v[32:35], a[8:11], a[32:35], v[32:35]
    ds_read_b128 a[56:59], v244 offset:28672
    ds_read_b128 a[60:63], v244 offset:29696
    v_mfma_f32_16x16x32_bf16 v[36:39], a[8:11], a[36:39], v[36:39]
    buffer_load_dwordx4 v206, s[40:43], s82 offen offset:2048 lds
    v_mfma_f32_16x16x32_bf16 v[40:43], a[8:11], a[40:43], v[40:43]
    ds_read_b64_tr_b16 a[20:21], v226 offset:36864
    ds_read_b64_tr_b16 a[22:23], v226 offset:37376
    v_mfma_f32_16x16x32_bf16 v[44:47], a[8:11], a[44:47], v[44:47]
    s_waitcnt lgkmcnt(8)
    ds_read_b64_tr_b16 a[24:25], v228 offset:36864
    ds_read_b64_tr_b16 a[26:27], v228 offset:37376
    v_mfma_f32_16x16x32_bf16 v[48:51], a[12:15], a[32:35], v[48:51]
    buffer_load_dwordx4 v207, s[40:43], s82 offen offset:3072 lds
    v_mfma_f32_16x16x32_bf16 v[52:55], a[12:15], a[36:39], v[52:55]
    s_add_u32 m0, s84, 32768
    v_accvgpr_read_b32 v196, a96
    v_accvgpr_read_b32 v197, a97
    v_accvgpr_read_b32 v198, a98
    v_accvgpr_read_b32 v199, a99
    v_mul_f32 v200, v196, v196
    v_mul_f32 v201, v197, v197
    v_mul_f32 v202, v198, v198
    v_mul_f32 v203, v199, v199
    v_fma_f32 v200, v200, s85, v248
    v_fma_f32 v201, v201, s85, v248
    v_fma_f32 v202, v202, s85, v248
    v_fma_f32 v203, v203, s85, v248
    v_mul_f32 v200, v200, v196
    v_mul_f32 v201, v201, v197
    v_mul_f32 v202, v202, v198
    v_mul_f32 v203, v203, v199
    v_exp_f32 v200, v200
    v_exp_f32 v201, v201
    v_exp_f32 v202, v202
    v_mfma_f32_16x16x32_bf16 v[56:59], a[12:15], a[40:43], v[56:59]
    s_mov_b32 s82, 2359296
    v_exp_f32 v203, v203
    v_mfma_f32_16x16x32_bf16 v[60:63], a[12:15], a[44:47], v[60:63]
    s_waitcnt lgkmcnt(8)
    v_add_f32 v200, 1.0, v200
    v_add_f32 v201, 1.0, v201
    v_mfma_f32_16x16x32_bf16 v[64:67], a[16:19], a[32:35], v[64:67]
    buffer_load_dwordx4 v204, s[40:43], s82 offen offset:0 lds
    v_mfma_f32_16x16x32_bf16 v[68:71], a[16:19], a[36:39], v[68:71]
    v_add_f32 v202, 1.0, v202
    v_add_f32 v203, 1.0, v203
    v_mfma_f32_16x16x32_bf16 v[72:75], a[16:19], a[40:43], v[72:75]
    s_waitcnt vmcnt(13)
    ds_read_b64_tr_b16 a[28:29], v230 offset:36864
    ds_read_b64_tr_b16 a[30:31], v230 offset:37376
    v_mfma_f32_16x16x32_bf16 v[76:79], a[16:19], a[44:47], v[76:79]
    s_waitcnt lgkmcnt(4)
    buffer_load_dwordx4 v205, s[40:43], s82 offen offset:1024 lds
    v_mfma_f32_16x16x32_bf16 v[80:83], a[20:23], a[32:35], v[80:83]
    v_rcp_f32 v200, v200
    v_mfma_f32_16x16x32_bf16 v[84:87], a[20:23], a[36:39], v[84:87]
    v_rcp_f32 v201, v201
    v_mfma_f32_16x16x32_bf16 v[88:91], a[20:23], a[40:43], v[88:91]
    ds_read_b64_tr_b16 a[0:1], v225 offset:0
    ds_read_b64_tr_b16 a[2:3], v225 offset:512
    v_mfma_f32_16x16x32_bf16 v[92:95], a[20:23], a[44:47], v[92:95]
    s_waitcnt lgkmcnt(4)
    buffer_load_dwordx4 v206, s[40:43], s82 offen offset:2048 lds
    v_mfma_f32_16x16x32_bf16 v[96:99], a[24:27], a[32:35], v[96:99]
    v_rcp_f32 v202, v202
    v_mfma_f32_16x16x32_bf16 v[100:103], a[24:27], a[36:39], v[100:103]
    v_rcp_f32 v203, v203
    v_mfma_f32_16x16x32_bf16 v[104:107], a[24:27], a[40:43], v[104:107]
    ds_read_b64_tr_b16 a[4:5], v227 offset:0
    ds_read_b64_tr_b16 a[6:7], v227 offset:512
    v_mul_f32 v196, v196, v200
    v_mfma_f32_16x16x32_bf16 v[108:111], a[24:27], a[44:47], v[108:111]
    s_waitcnt lgkmcnt(4)
    buffer_load_dwordx4 v207, s[40:43], s82 offen offset:3072 lds
    v_mfma_f32_16x16x32_bf16 v[112:115], a[28:31], a[32:35], v[112:115]
    s_add_u32 m0, s84, 36864
    v_mul_f32 v197, v197, v201
    v_mul_f32 v198, v198, v202
    v_mfma_f32_16x16x32_bf16 v[116:119], a[28:31], a[36:39], v[116:119]
    s_mov_b32 s82, 2359424
    ds_read_b64_tr_b16 a[8:9], v229 offset:0
    v_mul_f32 v199, v199, v203
    v_mfma_f32_16x16x32_bf16 v[120:123], a[28:31], a[40:43], v[120:123]
    buffer_load_dwordx4 v204, s[40:43], s82 offen offset:0 lds
    v_mfma_f32_16x16x32_bf16 v[124:127], a[28:31], a[44:47], v[124:127]
    s_waitcnt lgkmcnt(3)
    ds_read_b64_tr_b16 a[10:11], v229 offset:512
    v_cvt_pk_bf16_f32 v200, v196, v197
    v_mfma_f32_16x16x32_bf16 v[0:3], a[0:3], a[48:51], v[0:3]
    v_cvt_pk_bf16_f32 v201, v198, v199
    v_accvgpr_write_b32 a96, v200
    v_mfma_f32_16x16x32_bf16 v[4:7], a[0:3], a[52:55], v[4:7]
    ds_read_b64_tr_b16 a[12:13], v231 offset:0
    v_accvgpr_write_b32 a97, v201
    v_mfma_f32_16x16x32_bf16 v[8:11], a[0:3], a[56:59], v[8:11]
    s_waitcnt vmcnt(13)
    buffer_load_dwordx4 v205, s[40:43], s82 offen offset:1024 lds
    v_mfma_f32_16x16x32_bf16 v[12:15], a[0:3], a[60:63], v[12:15]
    s_waitcnt lgkmcnt(3)
    ds_read_b64_tr_b16 a[14:15], v231 offset:512
    v_mfma_f32_16x16x32_bf16 v[16:19], a[4:7], a[48:51], v[16:19]
    ds_read_b64_tr_b16 a[16:17], v225 offset:4096
    ds_read_b64_tr_b16 a[18:19], v225 offset:4608
    v_mfma_f32_16x16x32_bf16 v[20:23], a[4:7], a[52:55], v[20:23]
    buffer_load_dwordx4 v206, s[40:43], s82 offen offset:2048 lds
    v_mfma_f32_16x16x32_bf16 v[24:27], a[4:7], a[56:59], v[24:27]
    ds_read_b128 a[32:35], v243 offset:32768
    ds_read_b128 a[36:39], v243 offset:33792
    v_mfma_f32_16x16x32_bf16 v[28:31], a[4:7], a[60:63], v[28:31]
    s_waitcnt lgkmcnt(6)
    ds_read_b128 a[40:43], v244 offset:32768
    ds_read_b128 a[44:47], v244 offset:33792
    v_mfma_f32_16x16x32_bf16 v[32:35], a[8:11], a[48:51], v[32:35]
    ds_read_b64_tr_b16 a[20:21], v227 offset:4096
    ds_read_b64_tr_b16 a[22:23], v227 offset:4608
    v_mfma_f32_16x16x32_bf16 v[36:39], a[8:11], a[52:55], v[36:39]
    buffer_load_dwordx4 v207, s[40:43], s82 offen offset:3072 lds
    v_mfma_f32_16x16x32_bf16 v[40:43], a[8:11], a[56:59], v[40:43]
    s_add_u32 m0, s84, 65536
    ds_read_b64_tr_b16 a[24:25], v229 offset:4096
    ds_read_b64_tr_b16 a[26:27], v229 offset:4608
    v_accvgpr_read_b32 v196, a100
    v_accvgpr_read_b32 v197, a101
    v_accvgpr_read_b32 v198, a102
    v_accvgpr_read_b32 v199, a103
    v_mul_f32 v200, v196, v196
    v_mul_f32 v201, v197, v197
    v_mul_f32 v202, v198, v198
    v_mul_f32 v203, v199, v199
    v_fma_f32 v200, v200, s85, v248
    v_fma_f32 v201, v201, s85, v248
    v_fma_f32 v202, v202, s85, v248
    v_fma_f32 v203, v203, s85, v248
    v_mul_f32 v200, v200, v196
    v_mul_f32 v201, v201, v197
    v_mul_f32 v202, v202, v198
    v_mul_f32 v203, v203, v199
    v_exp_f32 v200, v200
    v_exp_f32 v201, v201
    v_mfma_f32_16x16x32_bf16 v[44:47], a[8:11], a[60:63], v[44:47]
    s_waitcnt lgkmcnt(10)
    v_exp_f32 v202, v202
    v_mfma_f32_16x16x32_bf16 v[48:51], a[12:15], a[48:51], v[48:51]
    s_mov_b32 s82, 2621440
    v_exp_f32 v203, v203
    v_mfma_f32_16x16x32_bf16 v[52:55], a[12:15], a[52:55], v[52:55]
    buffer_load_dwordx4 v204, s[40:43], s82 offen offset:0 lds
    v_mfma_f32_16x16x32_bf16 v[56:59], a[12:15], a[56:59], v[56:59]
    v_add_f32 v200, 1.0, v200
    v_add_f32 v201, 1.0, v201
    v_mfma_f32_16x16x32_bf16 v[60:63], a[12:15], a[60:63], v[60:63]
    s_waitcnt lgkmcnt(8)
    v_add_f32 v202, 1.0, v202
    v_add_f32 v203, 1.0, v203
    v_mfma_f32_16x16x32_bf16 v[64:67], a[16:19], a[48:51], v[64:67]
    buffer_load_dwordx4 v205, s[40:43], s82 offen offset:1024 lds
    v_mfma_f32_16x16x32_bf16 v[68:71], a[16:19], a[52:55], v[68:71]
    v_rcp_f32 v200, v200
    v_mfma_f32_16x16x32_bf16 v[72:75], a[16:19], a[56:59], v[72:75]
    s_waitcnt vmcnt(14)
    v_rcp_f32 v201, v201
    v_mfma_f32_16x16x32_bf16 v[76:79], a[16:19], a[60:63], v[76:79]
    s_waitcnt lgkmcnt(2)
    ds_read_b64_tr_b16 a[28:29], v231 offset:4096
    ds_read_b64_tr_b16 a[30:31], v231 offset:4608
    v_mfma_f32_16x16x32_bf16 v[80:83], a[20:23], a[48:51], v[80:83]
    buffer_load_dwordx4 v206, s[40:43], s82 offen offset:2048 lds
    v_mfma_f32_16x16x32_bf16 v[84:87], a[20:23], a[52:55], v[84:87]
    v_rcp_f32 v202, v202
    v_mfma_f32_16x16x32_bf16 v[88:91], a[20:23], a[56:59], v[88:91]
    ds_read_b64_tr_b16 a[0:1], v224 offset:0
    ds_read_b64_tr_b16 a[2:3], v224 offset:512
    v_mfma_f32_16x16x32_bf16 v[92:95], a[20:23], a[60:63], v[92:95]
    s_waitcnt lgkmcnt(4)
    buffer_load_dwordx4 v207, s[40:43], s82 offen offset:3072 lds
    v_mfma_f32_16x16x32_bf16 v[96:99], a[24:27], a[48:51], v[96:99]
    s_add_u32 m0, s84, 69632
    v_rcp_f32 v203, v203
    v_mfma_f32_16x16x32_bf16 v[100:103], a[24:27], a[52:55], v[100:103]
    s_mov_b32 s82, 2621568
    v_mul_f32 v196, v196, v200
    v_mul_f32 v197, v197, v201
    v_mfma_f32_16x16x32_bf16 v[104:107], a[24:27], a[56:59], v[104:107]
    v_mul_f32 v198, v198, v202
    v_mul_f32 v199, v199, v203
    v_mfma_f32_16x16x32_bf16 v[108:111], a[24:27], a[60:63], v[108:111]
    s_waitcnt lgkmcnt(2)
    ds_read_b64_tr_b16 a[4:5], v226 offset:0
    ds_read_b64_tr_b16 a[6:7], v226 offset:512
    v_cvt_pk_bf16_f32 v200, v196, v197
    v_mfma_f32_16x16x32_bf16 v[112:115], a[28:31], a[48:51], v[112:115]
    v_cvt_pk_bf16_f32 v201, v198, v199
    v_accvgpr_write_b32 a100, v200
    v_mfma_f32_16x16x32_bf16 v[116:119], a[28:31], a[52:55], v[116:119]
    buffer_load_dwordx4 v204, s[40:43], s82 offen offset:0 lds
    v_mfma_f32_16x16x32_bf16 v[120:123], a[28:31], a[56:59], v[120:123]
    ds_read_b64_tr_b16 a[8:9], v228 offset:0
    v_accvgpr_write_b32 a101, v201
    v_mfma_f32_16x16x32_bf16 v[124:127], a[28:31], a[60:63], v[124:127]
    s_waitcnt lgkmcnt(3)
    ds_read_b64_tr_b16 a[10:11], v228 offset:512
    v_mfma_f32_16x16x32_bf16 v[0:3], a[0:3], a[32:35], v[0:3]
    buffer_load_dwordx4 v205, s[40:43], s82 offen offset:1024 lds
    v_mfma_f32_16x16x32_bf16 v[4:7], a[0:3], a[36:39], v[4:7]
    ds_read_b64_tr_b16 a[12:13], v230 offset:0
    ds_read_b64_tr_b16 a[14:15], v230 offset:512
    v_mfma_f32_16x16x32_bf16 v[8:11], a[0:3], a[40:43], v[8:11]
    s_waitcnt vmcnt(14)
    ds_read_b64_tr_b16 a[16:17], v224 offset:4096
    ds_read_b64_tr_b16 a[18:19], v224 offset:4608
    v_mfma_f32_16x16x32_bf16 v[12:15], a[0:3], a[44:47], v[12:15]
    s_waitcnt lgkmcnt(6)
    buffer_load_dwordx4 v206, s[40:43], s82 offen offset:2048 lds
    v_mfma_f32_16x16x32_bf16 v[16:19], a[4:7], a[32:35], v[16:19]
    ds_read_b128 a[48:51], v243 offset:36864
    ds_read_b128 a[52:55], v243 offset:37888
    v_mfma_f32_16x16x32_bf16 v[20:23], a[4:7], a[36:39], v[20:23]
    ds_read_b128 a[56:59], v244 offset:36864
    ds_read_b128 a[60:63], v244 offset:37888
    v_mfma_f32_16x16x32_bf16 v[24:27], a[4:7], a[40:43], v[24:27]
    buffer_load_dwordx4 v207, s[40:43], s82 offen offset:3072 lds
    ds_read_b64_tr_b16 a[20:21], v226 offset:4096
    ds_read_b64_tr_b16 a[22:23], v226 offset:4608
    v_mfma_f32_16x16x32_bf16 v[28:31], a[4:7], a[44:47], v[28:31]
    s_waitcnt lgkmcnt(10)
    v_accvgpr_read_b32 v196, a104
    v_accvgpr_read_b32 v197, a105
    v_accvgpr_read_b32 v198, a106
    v_accvgpr_read_b32 v199, a107
    v_mul_f32 v200, v196, v196
    v_mul_f32 v201, v197, v197
    v_mul_f32 v202, v198, v198
    v_mul_f32 v203, v199, v199
    v_fma_f32 v200, v200, s85, v248
    v_fma_f32 v201, v201, s85, v248
    v_fma_f32 v202, v202, s85, v248
    v_fma_f32 v203, v203, s85, v248
    v_mul_f32 v200, v200, v196
    v_mul_f32 v201, v201, v197
    v_mul_f32 v202, v202, v198
    v_mul_f32 v203, v203, v199
    v_exp_f32 v200, v200
    v_exp_f32 v201, v201
    v_mfma_f32_16x16x32_bf16 v[32:35], a[8:11], a[32:35], v[32:35]
    s_add_u32 m0, s84, 0
    v_exp_f32 v202, v202
    v_mfma_f32_16x16x32_bf16 v[36:39], a[8:11], a[36:39], v[36:39]
    s_mov_b32 s82, 2883584
    v_exp_f32 v203, v203
    v_mfma_f32_16x16x32_bf16 v[40:43], a[8:11], a[40:43], v[40:43]
    v_add_f32 v200, 1.0, v200
    v_add_f32 v201, 1.0, v201
    v_mfma_f32_16x16x32_bf16 v[44:47], a[8:11], a[44:47], v[44:47]
    s_waitcnt lgkmcnt(8)
    v_add_f32 v202, 1.0, v202
    v_add_f32 v203, 1.0, v203
    v_mfma_f32_16x16x32_bf16 v[48:51], a[12:15], a[32:35], v[48:51]
    v_rcp_f32 v200, v200
    v_mfma_f32_16x16x32_bf16 v[52:55], a[12:15], a[36:39], v[52:55]
    buffer_load_dwordx4 v204, s[40:43], s82 offen offset:0 lds
    v_mfma_f32_16x16x32_bf16 v[56:59], a[12:15], a[40:43], v[56:59]
    v_rcp_f32 v201, v201
    v_mfma_f32_16x16x32_bf16 v[60:63], a[12:15], a[44:47], v[60:63]
    s_waitcnt lgkmcnt(6)
    ds_read_b64_tr_b16 a[24:25], v228 offset:4096
    ds_read_b64_tr_b16 a[26:27], v228 offset:4608
    v_mfma_f32_16x16x32_bf16 v[64:67], a[16:19], a[32:35], v[64:67]
    buffer_load_dwordx4 v205, s[40:43], s82 offen offset:1024 lds
    v_mfma_f32_16x16x32_bf16 v[68:71], a[16:19], a[36:39], v[68:71]
    v_rcp_f32 v202, v202
    v_mfma_f32_16x16x32_bf16 v[72:75], a[16:19], a[40:43], v[72:75]
    s_waitcnt vmcnt(14)
    v_rcp_f32 v203, v203
    v_mfma_f32_16x16x32_bf16 v[76:79], a[16:19], a[44:47], v[76:79]
    s_waitcnt lgkmcnt(2)
    ds_read_b64_tr_b16 a[28:29], v230 offset:4096
    ds_read_b64_tr_b16 a[30:31], v230 offset:4608
    v_mul_f32 v196, v196, v200
    v_mfma_f32_16x16x32_bf16 v[80:83], a[20:23], a[32:35], v[80:83]
    buffer_load_dwordx4 v206, s[40:43], s82 offen offset:2048 lds
    v_mfma_f32_16x16x32_bf16 v[84:87], a[20:23], a[36:39], v[84:87]
    ds_read_b64_tr_b16 a[0:1], v224 offset:32768
    v_mul_f32 v197, v197, v201
    v_mfma_f32_16x16x32_bf16 v[88:91], a[20:23], a[40:43], v[88:91]
    ds_read_b64_tr_b16 a[2:3], v224 offset:33280
    v_mul_f32 v198, v198, v202
    v_mfma_f32_16x16x32_bf16 v[92:95], a[20:23], a[44:47], v[92:95]
    s_waitcnt lgkmcnt(4)
    buffer_load_dwordx4 v207, s[40:43], s82 offen offset:3072 lds
    v_mfma_f32_16x16x32_bf16 v[96:99], a[24:27], a[32:35], v[96:99]
    s_add_u32 m0, s84, 4096
    v_mul_f32 v199, v199, v203
    v_cvt_pk_bf16_f32 v200, v196, v197
    v_mfma_f32_16x16x32_bf16 v[100:103], a[24:27], a[36:39], v[100:103]
    s_mov_b32 s82, 2883712
    v_cvt_pk_bf16_f32 v201, v198, v199
    v_accvgpr_write_b32 a104, v200
    v_mfma_f32_16x16x32_bf16 v[104:107], a[24:27], a[40:43], v[104:107]
    ds_read_b64_tr_b16 a[4:5], v226 offset:32768
    v_accvgpr_write_b32 a105, v201
    v_mfma_f32_16x16x32_bf16 v[108:111], a[24:27], a[44:47], v[108:111]
    s_waitcnt lgkmcnt(3)
    ds_read_b64_tr_b16 a[6:7], v226 offset:33280
    v_mfma_f32_16x16x32_bf16 v[112:115], a[28:31], a[32:35], v[112:115]
    ds_read_b64_tr_b16 a[8:9], v228 offset:32768
    ds_read_b64_tr_b16 a[10:11], v228 offset:33280
    v_mfma_f32_16x16x32_bf16 v[116:119], a[28:31], a[36:39], v[116:119]
    buffer_load_dwordx4 v204, s[40:43], s82 offen offset:0 lds
    v_mfma_f32_16x16x32_bf16 v[120:123], a[28:31], a[40:43], v[120:123]
    ds_read_b64_tr_b16 a[12:13], v230 offset:32768
    ds_read_b64_tr_b16 a[14:15], v230 offset:33280
    v_mfma_f32_16x16x32_bf16 v[124:127], a[28:31], a[44:47], v[124:127]
    s_waitcnt lgkmcnt(6)
    buffer_load_dwordx4 v205, s[40:43], s82 offen offset:1024 lds
    v_mfma_f32_16x16x32_bf16 v[0:3], a[0:3], a[48:51], v[0:3]
    v_mov_b32 v195, 0x7f000000
    v_mfma_f32_16x16x32_bf16 v[4:7], a[0:3], a[52:55], v[4:7]
    s_mul_i32 s86, s89, 13
    v_add_u32 v255, s86, v251
    v_lshlrev_b32 v255, 7, v255
    v_cmp_gt_u32 vcc, 13, v251
    s_nop 1
    v_cndmask_b32 v255, v195, v255, vcc
    v_mfma_f32_16x16x32_bf16 v[8:11], a[0:3], a[56:59], v[8:11]
    s_waitcnt vmcnt(14)
    buffer_load_dword v252, v255, s[60:63], 0 offen
    ds_read_b64_tr_b16 a[16:17], v224 offset:36864
    ds_read_b64_tr_b16 a[18:19], v224 offset:37376
    v_mfma_f32_16x16x32_bf16 v[12:15], a[0:3], a[60:63], v[12:15]
    s_waitcnt lgkmcnt(6)
    buffer_load_dwordx4 v206, s[40:43], s82 offen offset:2048 lds
    v_mfma_f32_16x16x32_bf16 v[16:19], a[4:7], a[48:51], v[16:19]
    v_accvgpr_read_b32 v196, a108
    v_accvgpr_read_b32 v197, a109
    v_accvgpr_read_b32 v198, a110
    v_accvgpr_read_b32 v199, a111
    v_mul_f32 v200, v196, v196
    v_mul_f32 v201, v197, v197
    v_mul_f32 v202, v198, v198
    v_mul_f32 v203, v199, v199
    v_fma_f32 v200, v200, s85, v248
    v_fma_f32 v201, v201, s85, v248
    v_fma_f32 v202, v202, s85, v248
    v_fma_f32 v203, v203, s85, v248
    v_mul_f32 v200, v200, v196
    v_mul_f32 v201, v201, v197
    v_mul_f32 v202, v202, v198
    v_mul_f32 v203, v203, v199
    v_exp_f32 v200, v200
    v_exp_f32 v201, v201
    v_mfma_f32_16x16x32_bf16 v[20:23], a[4:7], a[52:55], v[20:23]
    v_exp_f32 v202, v202
    v_mfma_f32_16x16x32_bf16 v[24:27], a[4:7], a[56:59], v[24:27]
    v_exp_f32 v203, v203
    v_mfma_f32_16x16x32_bf16 v[28:31], a[4:7], a[60:63], v[28:31]
    s_waitcnt lgkmcnt(4)
    buffer_load_dwordx4 v207, s[40:43], s82 offen offset:3072 lds
    v_mfma_f32_16x16x32_bf16 v[32:35], a[8:11], a[48:51], v[32:35]
    s_add_u32 m0, s84, 32768
    v_add_f32 v200, 1.0, v200
    v_add_f32 v201, 1.0, v201
    v_mfma_f32_16x16x32_bf16 v[36:39], a[8:11], a[52:55], v[36:39]
    s_mov_b32 s82, 3145728
    v_add_f32 v202, 1.0, v202
    v_add_f32 v203, 1.0, v203
    v_mfma_f32_16x16x32_bf16 v[40:43], a[8:11], a[56:59], v[40:43]
    v_rcp_f32 v200, v200
    v_mfma_f32_16x16x32_bf16 v[44:47], a[8:11], a[60:63], v[44:47]
    s_waitcnt lgkmcnt(2)
    ds_read_b64_tr_b16 a[20:21], v226 offset:36864
    ds_read_b64_tr_b16 a[22:23], v226 offset:37376
    v_mfma_f32_16x16x32_bf16 v[48:51], a[12:15], a[48:51], v[48:51]
    v_rcp_f32 v201, v201
    v_mfma_f32_16x16x32_bf16 v[52:55], a[12:15], a[52:55], v[52:55]
    buffer_load_dwordx4 v204, s[40:43], s82 offen offset:0 lds
    v_mfma_f32_16x16x32_bf16 v[56:59], a[12:15], a[56:59], v[56:59]
    v_rcp_f32 v202, v202
    v_mfma_f32_16x16x32_bf16 v[60:63], a[12:15], a[60:63], v[60:63]
    s_waitcnt lgkmcnt(2)
    ds_read_b64_tr_b16 a[24:25], v228 offset:36864
    ds_read_b64_tr_b16 a[26:27], v228 offset:37376
    v_mfma_f32_16x16x32_bf16 v[64:67], a[16:19], a[48:51], v[64:67]
    buffer_load_dwordx4 v205, s[40:43], s82 offen offset:1024 lds
    v_mfma_f32_16x16x32_bf16 v[68:71], a[16:19], a[52:55], v[68:71]
    v_rcp_f32 v203, v203
    v_mfma_f32_16x16x32_bf16 v[72:75], a[16:19], a[56:59], v[72:75]
    s_waitcnt vmcnt(15)
    ds_read_b128 a[32:35], v243 offset:40960
    ds_read_b128 a[36:39], v243 offset:41984
    v_mul_f32 v196, v196, v200
    v_mfma_f32_16x16x32_bf16 v[76:79], a[16:19], a[60:63], v[76:79]
    s_waitcnt lgkmcnt(4)
    ds_read_b64_tr_b16 a[28:29], v230 offset:36864
    ds_read_b64_tr_b16 a[30:31], v230 offset:37376
    v_mul_f32 v197, v197, v201
    v_mfma_f32_16x16x32_bf16 v[80:83], a[20:23], a[48:51], v[80:83]
    buffer_load_dwordx4 v206, s[40:43], s82 offen offset:2048 lds
    v_mfma_f32_16x16x32_bf16 v[84:87], a[20:23], a[52:55], v[84:87]
    ds_read_b128 a[40:43], v244 offset:40960
    ds_read_b128 a[44:47], v244 offset:41984
    v_mul_f32 v198, v198, v202
    v_mfma_f32_16x16x32_bf16 v[88:91], a[20:23], a[56:59], v[88:91]
    ds_read_b64_tr_b16 a[0:1], v225 offset:0
    ds_read_b64_tr_b16 a[2:3], v225 offset:512
    v_mul_f32 v199, v199, v203
    v_mfma_f32_16x16x32_bf16 v[92:95], a[20:23], a[60:63], v[92:95]
    s_waitcnt lgkmcnt(8)
    buffer_load_dwordx4 v207, s[40:43], s82 offen offset:3072 lds
    v_mfma_f32_16x16x32_bf16 v[96:99], a[24:27], a[48:51], v[96:99]
    s_add_u32 m0, s84, 36864
    v_cvt_pk_bf16_f32 v200, v196, v197
    v_cvt_pk_bf16_f32 v201, v198, v199
    v_mfma_f32_16x16x32_bf16 v[100:103], a[24:27], a[52:55], v[100:103]
    s_mov_b32 s82, 3145856
    ds_read_b64_tr_b16 a[4:5], v227 offset:0
    v_accvgpr_write_b32 a108, v200
    v_mfma_f32_16x16x32_bf16 v[104:107], a[24:27], a[56:59], v[104:107]
    ds_read_b64_tr_b16 a[6:7], v227 offset:512
    v_accvgpr_write_b32 a109, v201
    v_mfma_f32_16x16x32_bf16 v[108:111], a[24:27], a[60:63], v[108:111]
    s_waitcnt lgkmcnt(6)
    ds_read_b64_tr_b16 a[8:9], v229 offset:0
    v_mfma_f32_16x16x32_bf16 v[112:115], a[28:31], a[48:51], v[112:115]
    buffer_load_dwordx4 v204, s[40:43], s82 offen offset:0 lds
    v_mfma_f32_16x16x32_bf16 v[116:119], a[28:31], a[52:55], v[116:119]
    ds_read_b64_tr_b16 a[10:11], v229 offset:512
    v_mfma_f32_16x16x32_bf16 v[120:123], a[28:31], a[56:59], v[120:123]
    ds_read_b64_tr_b16 a[12:13], v231 offset:0
    v_mfma_f32_16x16x32_bf16 v[124:127], a[28:31], a[60:63], v[124:127]
    s_waitcnt lgkmcnt(5)
    ds_read_b64_tr_b16 a[14:15], v231 offset:512
    v_mfma_f32_16x16x32_bf16 v[0:3], a[0:3], a[32:35], v[0:3]
    buffer_load_dwordx4 v205, s[40:43], s82 offen offset:1024 lds
    v_mfma_f32_16x16x32_bf16 v[4:7], a[0:3], a[36:39], v[4:7]
    v_accvgpr_read_b32 v196, a112
    v_accvgpr_read_b32 v197, a113
    v_accvgpr_read_b32 v198, a114
    v_accvgpr_read_b32 v199, a115
    v_mul_f32 v200, v196, v196
    v_mul_f32 v201, v197, v197
    v_mul_f32 v202, v198, v198
    v_mul_f32 v203, v199, v199
    v_fma_f32 v200, v200, s85, v248
    v_fma_f32 v201, v201, s85, v248
    v_fma_f32 v202, v202, s85, v248
    v_fma_f32 v203, v203, s85, v248
    v_mfma_f32_16x16x32_bf16 v[8:11], a[0:3], a[40:43], v[8:11]
    s_waitcnt vmcnt(15)
    s_barrier
    v_mul_f32 v200, v200, v196
    v_mul_f32 v201, v201, v197
    v_mfma_f32_16x16x32_bf16 v[12:15], a[0:3], a[44:47], v[12:15]
    s_waitcnt lgkmcnt(4)
    v_mul_f32 v202, v202, v198
    v_mul_f32 v203, v203, v199
    v_mfma_f32_16x16x32_bf16 v[16:19], a[4:7], a[32:35], v[16:19]
    buffer_load_dwordx4 v206, s[40:43], s82 offen offset:2048 lds
    v_mfma_f32_16x16x32_bf16 v[20:23], a[4:7], a[36:39], v[20:23]
    v_exp_f32 v200, v200
    v_mfma_f32_16x16x32_bf16 v[24:27], a[4:7], a[40:43], v[24:27]
    ds_read_b64_tr_b16 a[16:17], v225 offset:4096
    ds_read_b64_tr_b16 a[18:19], v225 offset:4608
    v_mfma_f32_16x16x32_bf16 v[28:31], a[4:7], a[44:47], v[28:31]
    s_waitcnt lgkmcnt(4)
    buffer_load_dwordx4 v207, s[40:43], s82 offen offset:3072 lds
    v_mfma_f32_16x16x32_bf16 v[32:35], a[8:11], a[32:35], v[32:35]
    s_add_u32 m0, s84, 65536
    v_exp_f32 v201, v201
    v_mfma_f32_16x16x32_bf16 v[36:39], a[8:11], a[36:39], v[36:39]
    s_mov_b32 s82, 3407872
    v_exp_f32 v202, v202
    v_mfma_f32_16x16x32_bf16 v[40:43], a[8:11], a[40:43], v[40:43]
    v_exp_f32 v203, v203
    v_mfma_f32_16x16x32_bf16 v[44:47], a[8:11], a[44:47], v[44:47]
    s_waitcnt lgkmcnt(2)
    ds_read_b64_tr_b16 a[20:21], v227 offset:4096
    ds_read_b64_tr_b16 a[22:23], v227 offset:4608
    v_add_f32 v200, 1.0, v200
    v_mfma_f32_16x16x32_bf16 v[48:51], a[12:15], a[32:35], v[48:51]
    v_add_f32 v201, 1.0, v201
    v_add_f32 v202, 1.0, v202
    v_mfma_f32_16x16x32_bf16 v[52:55], a[12:15], a[36:39], v[52:55]
    buffer_load_dwordx4 v204, s[40:43], s82 offen offset:0 lds
    v_mfma_f32_16x16x32_bf16 v[56:59], a[12:15], a[40:43], v[56:59]
    ds_read_b64_tr_b16 a[24:25], v229 offset:4096
    v_add_f32 v203, 1.0, v203
    v_mfma_f32_16x16x32_bf16 v[60:63], a[12:15], a[44:47], v[60:63]
    s_waitcnt lgkmcnt(3)
    ds_read_b64_tr_b16 a[26:27], v229 offset:4608
    v_mfma_f32_16x16x32_bf16 v[64:67], a[16:19], a[32:35], v[64:67]
    buffer_load_dwordx4 v205, s[40:43], s82 offen offset:1024 lds
    v_mfma_f32_16x16x32_bf16 v[68:71], a[16:19], a[36:39], v[68:71]
    v_rcp_f32 v200, v200
    v_mfma_f32_16x16x32_bf16 v[72:75], a[16:19], a[40:43], v[72:75]
    s_waitcnt vmcnt(15)
    ds_read_b128 a[48:51], v243 offset:45056
    ds_read_b128 a[52:55], v243 offset:46080
    v_mfma_f32_16x16x32_bf16 v[76:79], a[16:19], a[44:47], v[76:79]
    s_waitcnt lgkmcnt(4)
    ds_read_b64_tr_b16 a[28:29], v231 offset:4096
    ds_read_b64_tr_b16 a[30:31], v231 offset:4608
    v_mfma_f32_16x16x32_bf16 v[80:83], a[20:23], a[32:35], v[80:83]
    buffer_load_dwordx4 v206, s[40:43], s82 offen offset:2048 lds
    v_mfma_f32_16x16x32_bf16 v[84:87], a[20:23], a[36:39], v[84:87]
    ds_read_b128 a[56:59], v244 offset:45056
    ds_read_b128 a[60:63], v244 offset:46080
    v_mfma_f32_16x16x32_bf16 v[88:91], a[20:23], a[40:43], v[88:91]
    ds_read_b64_tr_b16 a[0:1], v224 offset:0
    ds_read_b64_tr_b16 a[2:3], v224 offset:512
    v_mfma_f32_16x16x32_bf16 v[92:95], a[20:23], a[44:47], v[92:95]
    s_waitcnt lgkmcnt(8)
    buffer_load_dwordx4 v207, s[40:43], s82 offen offset:3072 lds
    v_mfma_f32_16x16x32_bf16 v[96:99], a[24:27], a[32:35], v[96:99]
    s_add_u32 m0, s84, 69632
    v_rcp_f32 v201, v201
    v_mfma_f32_16x16x32_bf16 v[100:103], a[24:27], a[36:39], v[100:103]
    s_mov_b32 s82, 3408000
    v_rcp_f32 v202, v202
    v_mfma_f32_16x16x32_bf16 v[104:107], a[24:27], a[40:43], v[104:107]
    v_rcp_f32 v203, v203
    v_mfma_f32_16x16x32_bf16 v[108:111], a[24:27], a[44:47], v[108:111]
    s_waitcnt lgkmcnt(4)
    ds_read_b64_tr_b16 a[4:5], v226 offset:0
    ds_read_b64_tr_b16 a[6:7], v226 offset:512
    v_mul_f32 v196, v196, v200
    v_mfma_f32_16x16x32_bf16 v[112:115], a[28:31], a[32:35], v[112:115]
    v_mul_f32 v197, v197, v201
    v_mul_f32 v198, v198, v202
    v_mfma_f32_16x16x32_bf16 v[116:119], a[28:31], a[36:39], v[116:119]
    buffer_load_dwordx4 v204, s[40:43], s82 offen offset:0 lds
    v_mfma_f32_16x16x32_bf16 v[120:123], a[28:31], a[40:43], v[120:123]
    ds_read_b64_tr_b16 a[8:9], v228 offset:0
    v_mul_f32 v199, v199, v203
    v_mfma_f32_16x16x32_bf16 v[124:127], a[28:31], a[44:47], v[124:127]
    s_waitcnt lgkmcnt(3)
    ds_read_b64_tr_b16 a[10:11], v228 offset:512
    v_cvt_pk_bf16_f32 v200, v196, v197
    v_mfma_f32_16x16x32_bf16 v[0:3], a[0:3], a[48:51], v[0:3]
    buffer_load_dwordx4 v205, s[40:43], s82 offen offset:1024 lds
    v_mfma_f32_16x16x32_bf16 v[4:7], a[0:3], a[52:55], v[4:7]
    v_cvt_pk_bf16_f32 v201, v198, v199
    v_accvgpr_write_b32 a112, v200
    v_mfma_f32_16x16x32_bf16 v[8:11], a[0:3], a[56:59], v[8:11]
    s_waitcnt vmcnt(14)
    ds_read_b64_tr_b16 a[12:13], v230 offset:0
    v_accvgpr_write_b32 a113, v201
    v_mfma_f32_16x16x32_bf16 v[12:15], a[0:3], a[60:63], v[12:15]
    s_waitcnt lgkmcnt(3)
    ds_read_b64_tr_b16 a[14:15], v230 offset:512
    v_accvgpr_read_b32 v196, a116
    v_mfma_f32_16x16x32_bf16 v[16:19], a[4:7], a[48:51], v[16:19]
    buffer_load_dwordx4 v206, s[40:43], s82 offen offset:2048 lds
    v_mfma_f32_16x16x32_bf16 v[20:23], a[4:7], a[52:55], v[20:23]
    ds_read_b64_tr_b16 a[16:17], v224 offset:4096
    v_accvgpr_read_b32 v197, a117
    v_mfma_f32_16x16x32_bf16 v[24:27], a[4:7], a[56:59], v[24:27]
    ds_read_b64_tr_b16 a[18:19], v224 offset:4608
    v_accvgpr_read_b32 v198, a118
    v_mfma_f32_16x16x32_bf16 v[28:31], a[4:7], a[60:63], v[28:31]
    s_waitcnt lgkmcnt(4)
    buffer_load_dwordx4 v207, s[40:43], s82 offen offset:3072 lds
    v_mfma_f32_16x16x32_bf16 v[32:35], a[8:11], a[48:51], v[32:35]
    s_add_u32 m0, s81, 98304
    v_accvgpr_read_b32 v199, a119
    v_mul_f32 v200, v196, v196
    v_mfma_f32_16x16x32_bf16 v[36:39], a[8:11], a[52:55], v[36:39]
    s_mov_b32 s82, 0
    ds_read_b64_tr_b16 a[20:21], v226 offset:4096
    v_mul_f32 v201, v197, v197
    v_mfma_f32_16x16x32_bf16 v[40:43], a[8:11], a[56:59], v[40:43]
    s_lshl_b32 s87, s77, 12
    ds_read_b64_tr_b16 a[22:23], v226 offset:4608
    v_mul_f32 v202, v198, v198
    v_mfma_f32_16x16x32_bf16 v[44:47], a[8:11], a[60:63], v[44:47]
    s_waitcnt lgkmcnt(4)
    buffer_load_dwordx4 v212, s[48:51], s82 offen offset:0 lds
    v_mfma_f32_16x16x32_bf16 v[48:51], a[12:15], a[48:51], v[48:51]
    s_add_u32 s86, s84, s87
    v_mul_f32 v203, v199, v199
    v_fma_f32 v200, v200, s85, v248
    v_mfma_f32_16x16x32_bf16 v[52:55], a[12:15], a[52:55], v[52:55]
    s_add_u32 s86, s86, 32768
    ds_read_b64_tr_b16 a[24:25], v228 offset:4096
    v_fma_f32 v201, v201, s85, v248
    v_mfma_f32_16x16x32_bf16 v[56:59], a[12:15], a[56:59], v[56:59]
    ds_read_b64_tr_b16 a[26:27], v228 offset:4608
    v_fma_f32 v202, v202, s85, v248
    v_mfma_f32_16x16x32_bf16 v[60:63], a[12:15], a[60:63], v[60:63]
    s_waitcnt lgkmcnt(4)
    buffer_load_dwordx4 v213, s[48:51], s82 offen offset:1024 lds
    v_mfma_f32_16x16x32_bf16 v[64:67], a[16:19], a[48:51], v[64:67]
    v_fma_f32 v203, v203, s85, v248
    v_mul_f32 v200, v200, v196
    v_mfma_f32_16x16x32_bf16 v[68:71], a[16:19], a[52:55], v[68:71]
    ds_read_b64_tr_b16 a[28:29], v230 offset:4096
    v_mul_f32 v201, v201, v197
    v_mfma_f32_16x16x32_bf16 v[72:75], a[16:19], a[56:59], v[72:75]
    s_waitcnt vmcnt(14)
    buffer_load_dwordx4 v214, s[48:51], s82 offen offset:2048 lds
    v_mfma_f32_16x16x32_bf16 v[76:79], a[16:19], a[60:63], v[76:79]
    s_waitcnt lgkmcnt(3)
    ds_read_b64_tr_b16 a[30:31], v230 offset:4608
    v_mul_f32 v202, v202, v198
    v_mfma_f32_16x16x32_bf16 v[80:83], a[20:23], a[48:51], v[80:83]
    ds_read_b128 a[32:35], v243 offset:49152
    ds_read_b128 a[36:39], v243 offset:50176
    v_mul_f32 v203, v203, v199
    v_mfma_f32_16x16x32_bf16 v[84:87], a[20:23], a[52:55], v[84:87]
    ds_read_b128 a[40:43], v244 offset:49152
    ds_read_b128 a[44:47], v244 offset:50176
    v_add_u32 v204, s86, v253
    v_mfma_f32_16x16x32_bf16 v[88:91], a[20:23], a[56:59], v[88:91]
    buffer_load_dwordx4 v215, s[48:51], s82 offen offset:3072 lds
    v_mfma_f32_16x16x32_bf16 v[92:95], a[20:23], a[60:63], v[92:95]
    s_waitcnt lgkmcnt(6)
    ds_read_b64_tr_b16 a[0:1], v224 offset:32768
    ds_read_b64_tr_b16 a[2:3], v224 offset:33280
    v_xor_b32 v205, 4096, v204
    v_mfma_f32_16x16x32_bf16 v[96:99], a[24:27], a[48:51], v[96:99]
    s_add_u32 m0, s81, 114688
    s_mov_b32 s82, 16384
    s_lshl_b32 s86, s77, 14
    v_mfma_f32_16x16x32_bf16 v[100:103], a[24:27], a[52:55], v[100:103]
    buffer_load_dwordx4 v212, s[48:51], s82 offen offset:0 lds
    v_mfma_f32_16x16x32_bf16 v[104:107], a[24:27], a[56:59], v[104:107]
    s_lshl_b32 s87, s78, 12
    v_exp_f32 v200, v200
    v_mfma_f32_16x16x32_bf16 v[108:111], a[24:27], a[60:63], v[108:111]
    s_waitcnt lgkmcnt(6)
    ds_read_b64_tr_b16 a[4:5], v226 offset:32768
    ds_read_b64_tr_b16 a[6:7], v226 offset:33280
    v_mfma_f32_16x16x32_bf16 v[112:115], a[28:31], a[48:51], v[112:115]
    s_add_u32 s86, s86, s87
    v_exp_f32 v201, v201
    v_mfma_f32_16x16x32_bf16 v[116:119], a[28:31], a[52:55], v[116:119]
    buffer_load_dwordx4 v213, s[48:51], s82 offen offset:1024 lds
    v_mfma_f32_16x16x32_bf16 v[120:123], a[28:31], a[56:59], v[120:123]
    s_add_u32 s86, s86, 32768
    v_exp_f32 v202, v202
    v_mfma_f32_16x16x32_bf16 v[124:127], a[28:31], a[60:63], v[124:127]
    s_waitcnt lgkmcnt(2)
    ds_read_b64_tr_b16 a[8:9], v228 offset:32768
    ds_read_b64_tr_b16 a[10:11], v228 offset:33280
    v_add_u32 v206, s86, v253
    v_mfma_f32_16x16x32_bf16 v[0:3], a[0:3], a[32:35], v[0:3]
    s_lshl_b32 s86, s78, 12
    v_exp_f32 v203, v203
    v_mfma_f32_16x16x32_bf16 v[4:7], a[0:3], a[36:39], v[4:7]
    buffer_load_dwordx4 v214, s[48:51], s82 offen offset:2048 lds
    v_mfma_f32_16x16x32_bf16 v[8:11], a[0:3], a[40:43], v[8:11]
    s_waitcnt vmcnt(15)
    v_add_f32 v200, 1.0, v200
    v_add_f32 v201, 1.0, v201
    v_mfma_f32_16x16x32_bf16 v[12:15], a[0:3], a[44:47], v[12:15]
    s_waitcnt lgkmcnt(2)
    ds_read_b64_tr_b16 a[12:13], v230 offset:32768
    ds_read_b64_tr_b16 a[14:15], v230 offset:33280
    v_add_f32 v202, 1.0, v202
    v_mfma_f32_16x16x32_bf16 v[16:19], a[4:7], a[32:35], v[16:19]
    buffer_load_dwordx4 v215, s[48:51], s82 offen offset:3072 lds
    v_mfma_f32_16x16x32_bf16 v[20:23], a[4:7], a[36:39], v[20:23]
    s_mul_i32 s87, s77, 2056
    ds_read_b64_tr_b16 a[16:17], v224 offset:36864
    v_add_f32 v203, 1.0, v203
    v_mfma_f32_16x16x32_bf16 v[24:27], a[4:7], a[40:43], v[24:27]
    s_add_u32 s86, s86, s87
    v_rcp_f32 v200, v200
    v_mfma_f32_16x16x32_bf16 v[28:31], a[4:7], a[44:47], v[28:31]
    s_waitcnt lgkmcnt(3)
    ds_read_b64_tr_b16 a[18:19], v224 offset:37376
    v_add_u32 v207, s86, v245
    v_mfma_f32_16x16x32_bf16 v[32:35], a[8:11], a[32:35], v[32:35]
    v_rcp_f32 v201, v201
    v_mfma_f32_16x16x32_bf16 v[36:39], a[8:11], a[36:39], v[36:39]
    v_rcp_f32 v202, v202
    v_mfma_f32_16x16x32_bf16 v[40:43], a[8:11], a[40:43], v[40:43]
    ds_read_b64_tr_b16 a[20:21], v226 offset:36864
    v_xor_b32 v208, 2048, v207
    v_mfma_f32_16x16x32_bf16 v[44:47], a[8:11], a[44:47], v[44:47]
    s_waitcnt lgkmcnt(3)
    ds_read_b64_tr_b16 a[22:23], v226 offset:37376
    v_mfma_f32_16x16x32_bf16 v[48:51], a[12:15], a[32:35], v[48:51]
    s_lshl_b32 s86, s78, 3
    v_rcp_f32 v203, v203
    v_mfma_f32_16x16x32_bf16 v[52:55], a[12:15], a[36:39], v[52:55]
    s_lshl_b32 s87, s77, 11
    v_mul_f32 v196, v196, v200
    v_mul_f32 v197, v197, v201
    v_mfma_f32_16x16x32_bf16 v[56:59], a[12:15], a[40:43], v[56:59]
    s_add_u32 s86, s86, s87
    ds_read_b64_tr_b16 a[24:25], v228 offset:36864
    v_mul_f32 v198, v198, v202
    v_mfma_f32_16x16x32_bf16 v[60:63], a[12:15], a[44:47], v[60:63]
    s_waitcnt lgkmcnt(3)
    ds_read_b64_tr_b16 a[26:27], v228 offset:37376
    v_mul_f32 v199, v199, v203
    v_mfma_f32_16x16x32_bf16 v[64:67], a[16:19], a[32:35], v[64:67]
    s_add_u32 s86, s86, 24576
    v_cvt_pk_bf16_f32 v200, v196, v197
    v_cvt_pk_bf16_f32 v201, v198, v199
    v_mfma_f32_16x16x32_bf16 v[68:71], a[16:19], a[36:39], v[68:71]
    v_accvgpr_write_b32 a116, v200
    v_accvgpr_write_b32 a117, v201
    v_mfma_f32_16x16x32_bf16 v[72:75], a[16:19], a[40:43], v[72:75]
    s_waitcnt vmcnt(12)
    ds_read_b64_tr_b16 a[28:29], v230 offset:36864
    v_add_u32 v209, s86, v245
    v_mfma_f32_16x16x32_bf16 v[76:79], a[16:19], a[44:47], v[76:79]
    s_waitcnt lgkmcnt(3)
    ds_read_b64_tr_b16 a[30:31], v230 offset:37376
    v_mfma_f32_16x16x32_bf16 v[80:83], a[20:23], a[32:35], v[80:83]
    s_lshl_b32 s86, s76, 14
    ds_read_b128 a[48:51], v243 offset:53248
    v_mfma_f32_16x16x32_bf16 v[84:87], a[20:23], a[36:39], v[84:87]
    s_add_u32 s86, s86, 98304
    ds_read_b128 a[52:55], v243 offset:54272
    v_add_u32 v210, s86, v253
    v_mfma_f32_16x16x32_bf16 v[88:91], a[20:23], a[40:43], v[88:91]
    s_lshl_b32 s86, s80, 2
    ds_read_b128 a[56:59], v244 offset:53248
    ds_read_b128 a[60:63], v244 offset:54272
    v_mfma_f32_16x16x32_bf16 v[92:95], a[20:23], a[44:47], v[92:95]
    s_waitcnt lgkmcnt(6)
    ds_read_b64_tr_b16 a[0:1], v225 offset:0
    ds_read_b64_tr_b16 a[2:3], v225 offset:512
    v_mfma_f32_16x16x32_bf16 v[96:99], a[24:27], a[32:35], v[96:99]
    s_add_u32 s86, s86, s76
    ds_read_b64_tr_b16 a[4:5], v227 offset:0
    v_mfma_f32_16x16x32_bf16 v[100:103], a[24:27], a[36:39], v[100:103]
    s_mul_i32 s86, s86, 14336
    ds_read_b64_tr_b16 a[6:7], v227 offset:512
    v_add_u32 v211, s86, v253
    v_mfma_f32_16x16x32_bf16 v[104:107], a[24:27], a[40:43], v[104:107]
    ds_read_b64_tr_b16 a[8:9], v229 offset:0
    v_mfma_f32_16x16x32_bf16 v[108:111], a[24:27], a[44:47], v[108:111]
    s_waitcnt lgkmcnt(9)
    ds_read_b64_tr_b16 a[10:11], v229 offset:512
    v_mfma_f32_16x16x32_bf16 v[112:115], a[28:31], a[32:35], v[112:115]
    v_mfma_f32_16x16x32_bf16 v[116:119], a[28:31], a[36:39], v[116:119]
    v_mfma_f32_16x16x32_bf16 v[120:123], a[28:31], a[40:43], v[120:123]
    ds_read_b64_tr_b16 a[12:13], v231 offset:0
    v_mfma_f32_16x16x32_bf16 v[124:127], a[28:31], a[44:47], v[124:127]
    s_waitcnt lgkmcnt(5)
    ds_read_b64_tr_b16 a[14:15], v231 offset:512
    v_mfma_f32_16x16x32_bf16 v[0:3], a[0:3], a[48:51], v[0:3]
    v_mfma_f32_16x16x32_bf16 v[4:7], a[0:3], a[52:55], v[4:7]
    v_mfma_f32_16x16x32_bf16 v[8:11], a[0:3], a[56:59], v[8:11]
    s_waitcnt vmcnt(8)
    ds_read_b64_tr_b16 a[16:17], v225 offset:4096
    v_mfma_f32_16x16x32_bf16 v[12:15], a[0:3], a[60:63], v[12:15]
    s_waitcnt lgkmcnt(5)
    ds_read_b64_tr_b16 a[18:19], v225 offset:4608
    v_mfma_f32_16x16x32_bf16 v[16:19], a[4:7], a[48:51], v[16:19]
    v_mfma_f32_16x16x32_bf16 v[20:23], a[4:7], a[52:55], v[20:23]
    v_mfma_f32_16x16x32_bf16 v[24:27], a[4:7], a[56:59], v[24:27]
    ds_read_b64_tr_b16 a[20:21], v227 offset:4096
    v_mfma_f32_16x16x32_bf16 v[28:31], a[4:7], a[60:63], v[28:31]
    s_waitcnt lgkmcnt(5)
    ds_read_b64_tr_b16 a[22:23], v227 offset:4608
    v_mfma_f32_16x16x32_bf16 v[32:35], a[8:11], a[48:51], v[32:35]
    v_cvt_pk_bf16_f32 v188, v0, v1
    v_cvt_pk_bf16_f32 v189, v2, v3
    v_cvt_pk_bf16_f32 v190, v16, v17
    v_cvt_pk_bf16_f32 v191, v18, v19
    v_cvt_pk_bf16_f32 v192, v4, v5
    v_cvt_pk_bf16_f32 v193, v6, v7
    v_mfma_f32_16x16x32_bf16 v[36:39], a[8:11], a[52:55], v[36:39]
    ds_write_b128 v204, v[188:191] offset:0
    v_cvt_pk_bf16_f32 v194, v20, v21
    v_cvt_pk_bf16_f32 v195, v22, v23
    v_cvt_pk_bf16_f32 v188, v8, v9
    v_cvt_pk_bf16_f32 v189, v10, v11
    v_mfma_f32_16x16x32_bf16 v[40:43], a[8:11], a[56:59], v[40:43]
    ds_write_b128 v204, v[192:195] offset:2048
    v_cvt_pk_bf16_f32 v190, v24, v25
    v_cvt_pk_bf16_f32 v191, v26, v27
    v_mfma_f32_16x16x32_bf16 v[44:47], a[8:11], a[60:63], v[44:47]
    s_waitcnt lgkmcnt(6)
    v_cvt_pk_bf16_f32 v192, v12, v13
    v_cvt_pk_bf16_f32 v193, v14, v15
    v_mfma_f32_16x16x32_bf16 v[48:51], a[12:15], a[48:51], v[48:51]
    ds_write_b128 v205, v[188:191] offset:0
    v_mfma_f32_16x16x32_bf16 v[52:55], a[12:15], a[52:55], v[52:55]
    v_cvt_pk_bf16_f32 v194, v28, v29
    v_cvt_pk_bf16_f32 v195, v30, v31
    v_mfma_f32_16x16x32_bf16 v[56:59], a[12:15], a[56:59], v[56:59]
    ds_read_b64_tr_b16 a[24:25], v229 offset:4096
    ds_read_b64_tr_b16 a[26:27], v229 offset:4608
    v_mfma_f32_16x16x32_bf16 v[60:63], a[12:15], a[60:63], v[60:63]
    s_waitcnt lgkmcnt(7)
    ds_read_b64_tr_b16 a[28:29], v231 offset:4096
    ds_read_b64_tr_b16 a[30:31], v231 offset:4608
    v_mfma_f32_16x16x32_bf16 v[64:67], a[16:19], a[48:51], v[64:67]
    v_cvt_pk_bf16_f32 v188, v32, v33
    v_cvt_pk_bf16_f32 v189, v34, v35
    v_mfma_f32_16x16x32_bf16 v[68:71], a[16:19], a[52:55], v[68:71]
    ds_write_b128 v205, v[192:195] offset:2048
    v_cvt_pk_bf16_f32 v190, v48, v49
    v_cvt_pk_bf16_f32 v191, v50, v51
    v_cvt_pk_bf16_f32 v192, v36, v37
    v_cvt_pk_bf16_f32 v193, v38, v39
    v_mfma_f32_16x16x32_bf16 v[72:75], a[16:19], a[56:59], v[72:75]
    ds_write_b128 v204, v[188:191] offset:1024
    v_cvt_pk_bf16_f32 v194, v52, v53
    v_cvt_pk_bf16_f32 v195, v54, v55
    v_cvt_pk_bf16_f32 v188, v40, v41
    v_cvt_pk_bf16_f32 v189, v42, v43
    v_mfma_f32_16x16x32_bf16 v[76:79], a[16:19], a[60:63], v[76:79]
    s_waitcnt lgkmcnt(9) vmcnt(4)
    s_barrier
    ds_write_b128 v204, v[192:195] offset:3072
    v_cvt_pk_bf16_f32 v190, v56, v57
    v_cvt_pk_bf16_f32 v191, v58, v59
    v_cvt_pk_bf16_f32 v192, v44, v45
    v_cvt_pk_bf16_f32 v193, v46, v47
    v_mfma_f32_16x16x32_bf16 v[80:83], a[20:23], a[48:51], v[80:83]
    ds_write_b128 v205, v[188:191] offset:1024
    v_mfma_f32_16x16x32_bf16 v[84:87], a[20:23], a[52:55], v[84:87]
    v_cvt_pk_bf16_f32 v194, v60, v61
    v_cvt_pk_bf16_f32 v195, v62, v63
    v_mfma_f32_16x16x32_bf16 v[88:91], a[20:23], a[56:59], v[88:91]
    ds_read_b128 a[0:3], v239 offset:32768
    v_xor_b32 v224, 0, v249
    v_mfma_f32_16x16x32_bf16 v[92:95], a[20:23], a[60:63], v[92:95]
    s_waitcnt lgkmcnt(7)
    ds_read_b128 a[4:7], v239 offset:34816
    ds_read_b128 a[8:11], v241 offset:32768
    v_add_u32 v225, 65536, v224
    v_mfma_f32_16x16x32_bf16 v[96:99], a[24:27], a[48:51], v[96:99]
    v_cvt_pk_bf16_f32 v188, v64, v65
    v_cvt_pk_bf16_f32 v189, v66, v67
    v_mfma_f32_16x16x32_bf16 v[100:103], a[24:27], a[52:55], v[100:103]
    ds_write_b128 v205, v[192:195] offset:3072
    v_cvt_pk_bf16_f32 v190, v80, v81
    v_cvt_pk_bf16_f32 v191, v82, v83
    v_mfma_f32_16x16x32_bf16 v[104:107], a[24:27], a[56:59], v[104:107]
    s_add_u32 m0, s81, 0
    v_cvt_pk_bf16_f32 v192, v68, v69
    v_cvt_pk_bf16_f32 v193, v70, v71
    v_mfma_f32_16x16x32_bf16 v[108:111], a[24:27], a[60:63], v[108:111]
    s_waitcnt lgkmcnt(8)
    ds_read_b128 a[12:15], v241 offset:34816
    ds_read_b128 a[16:19], v239 offset:36864
    v_xor_b32 v226, 32, v249
    v_mfma_f32_16x16x32_bf16 v[112:115], a[28:31], a[48:51], v[112:115]
    s_mov_b32 s82, 0
    ds_write_b128 v204, v[188:191] offset:32768
    v_cvt_pk_bf16_f32 v194, v84, v85
    v_cvt_pk_bf16_f32 v195, v86, v87
    v_cvt_pk_bf16_f32 v188, v72, v73
    v_cvt_pk_bf16_f32 v189, v74, v75
    v_mfma_f32_16x16x32_bf16 v[116:119], a[28:31], a[52:55], v[116:119]
    ds_write_b128 v204, v[192:195] offset:34816
    v_cvt_pk_bf16_f32 v190, v88, v89
    v_cvt_pk_bf16_f32 v191, v90, v91
    v_cvt_pk_bf16_f32 v192, v76, v77
    v_cvt_pk_bf16_f32 v193, v78, v79
    v_mfma_f32_16x16x32_bf16 v[120:123], a[28:31], a[56:59], v[120:123]
    ds_write_b128 v205, v[188:191] offset:32768
    v_cvt_pk_bf16_f32 v194, v92, v93
    v_cvt_pk_bf16_f32 v195, v94, v95
    v_mfma_f32_16x16x32_bf16 v[124:127], a[28:31], a[60:63], v[124:127]
    v_cvt_pk_bf16_f32 v188, v96, v97
    v_cvt_pk_bf16_f32 v189, v98, v99
    ds_write_b128 v205, v[192:195] offset:34816
    v_cvt_pk_bf16_f32 v190, v112, v113
    v_cvt_pk_bf16_f32 v191, v114, v115
    v_cvt_pk_bf16_f32 v192, v100, v101
    v_cvt_pk_bf16_f32 v193, v102, v103
    ds_write_b128 v204, v[188:191] offset:33792
    v_cvt_pk_bf16_f32 v194, v116, v117
    v_cvt_pk_bf16_f32 v195, v118, v119
    v_cvt_pk_bf16_f32 v188, v104, v105
    v_cvt_pk_bf16_f32 v189, v106, v107
    ds_write_b128 v204, v[192:195] offset:35840
    v_cvt_pk_bf16_f32 v190, v120, v121
    v_cvt_pk_bf16_f32 v191, v122, v123
    v_cvt_pk_bf16_f32 v192, v108, v109
    v_cvt_pk_bf16_f32 v193, v110, v111
    ds_write_b128 v205, v[188:191] offset:33792
    v_cvt_pk_bf16_f32 v194, v124, v125
    v_cvt_pk_bf16_f32 v195, v126, v127
    ds_write_b128 v205, v[192:195] offset:35840
    s_nop 0
    s_waitcnt lgkmcnt(0)
    s_barrier
    ds_read_b128 a[120:123], v206 offset:0
    ds_read_b128 a[124:127], v206 offset:2048
    ds_read_b128 a[128:131], v206 offset:1024
    ds_read_b128 a[132:135], v206 offset:3072
    ds_read_b128 a[136:139], v206 offset:32768
    ds_read_b128 a[140:143], v206 offset:34816
    v_add_u32 v227, 65536, v226
    s_waitcnt lgkmcnt(4)
    v_mfma_f32_16x16x32_bf16 v[128:131], a[0:3], a[120:123], 0
    buffer_load_dwordx4 v216, s[52:55], s82 offen offset:0 lds
    v_mfma_f32_16x16x32_bf16 v[132:135], a[0:3], a[124:127], 0
    ds_read_b128 a[20:23], v239 offset:38912
    ds_read_b128 a[24:27], v241 offset:36864
    v_xor_b32 v228, 64, v249
    v_mfma_f32_16x16x32_bf16 v[136:139], a[4:7], a[120:123], 0
    ds_read_b128 a[144:147], v206 offset:33792
    ds_read_b128 a[148:151], v206 offset:35840
    v_add_u32 v229, 65536, v228
    v_mfma_f32_16x16x32_bf16 v[140:143], a[4:7], a[124:127], 0
    s_waitcnt lgkmcnt(6)
    ds_read_b128 a[152:155], v206 offset:8192
    ds_read_b128 a[156:159], v206 offset:10240
    v_xor_b32 v230, 96, v249
    v_mfma_f32_16x16x32_bf16 v[128:131], a[8:11], a[128:131], v[128:131]
    ds_read_b128 a[160:163], v206 offset:9216
    ds_read_b128 a[164:167], v206 offset:11264
    v_add_u32 v231, 65536, v230
    v_mfma_f32_16x16x32_bf16 v[132:135], a[8:11], a[132:135], v[132:135]
    ds_read_b128 a[28:31], v241 offset:38912
    ds_read_b128 a[0:3], v239 offset:40960
    v_sub_u32 v232, v232, v250
    v_mfma_f32_16x16x32_bf16 v[136:139], a[12:15], a[128:131], v[136:139]
    buffer_load_dwordx4 v217, s[52:55], s82 offen offset:1024 lds
    v_mfma_f32_16x16x32_bf16 v[140:143], a[12:15], a[132:135], v[140:143]
    s_waitcnt lgkmcnt(9)
    ds_write_b64 v207, a[64:65] offset:0
    ds_write_b64 v207, a[68:69] offset:1024
    ds_write_b64 v208, a[72:73] offset:0
    ds_write_b64 v208, a[76:77] offset:1024
    ds_write_b64 v207, a[80:81] offset:8192
    v_mfma_f32_16x16x32_bf16 v[128:131], a[16:19], a[136:139], v[128:131]
    ds_read_b128 a[4:7], v239 offset:43008
    ds_read_b128 a[8:11], v241 offset:40960
    v_sub_u32 v233, v233, v250
    v_mfma_f32_16x16x32_bf16 v[132:135], a[16:19], a[140:143], v[132:135]
    ds_write_b64 v207, a[84:85] offset:9216
    v_mfma_f32_16x16x32_bf16 v[136:139], a[20:23], a[136:139], v[136:139]
    ds_write_b64 v208, a[88:89] offset:8192
    v_mfma_f32_16x16x32_bf16 v[140:143], a[20:23], a[140:143], v[140:143]
    s_waitcnt lgkmcnt(10)
    ds_write_b64 v208, a[92:93] offset:9216
    v_mfma_f32_16x16x32_bf16 v[128:131], a[24:27], a[144:147], v[128:131]
    ds_write_b64 v207, a[96:97] offset:16384
    v_mfma_f32_16x16x32_bf16 v[132:135], a[24:27], a[148:151], v[132:135]
    ds_read_b128 a[168:171], v206 offset:40960
    ds_read_b128 a[12:15], v241 offset:43008
    v_sub_u32 v234, v234, v250
    v_mfma_f32_16x16x32_bf16 v[136:139], a[28:31], a[144:147], v[136:139]
    buffer_load_dwordx4 v218, s[52:55], s82 offen offset:2048 lds
    v_mfma_f32_16x16x32_bf16 v[140:143], a[28:31], a[148:151], v[140:143]
    s_waitcnt lgkmcnt(7)
    ds_read_b128 a[172:175], v206 offset:43008
    ds_read_b128 a[16:19], v239 offset:45056
    v_mfma_f32_16x16x32_bf16 v[128:131], a[0:3], a[152:155], v[128:131]
    ds_write_b64 v207, a[100:101] offset:17408
    v_mfma_f32_16x16x32_bf16 v[132:135], a[0:3], a[156:159], v[132:135]
    ds_read_b128 a[176:179], v206 offset:41984
    ds_read_b128 a[20:23], v239 offset:47104
    v_mfma_f32_16x16x32_bf16 v[136:139], a[4:7], a[152:155], v[136:139]
    s_waitcnt vmcnt(3)
    s_barrier
    ds_write_b64 v208, a[104:105] offset:16384
    v_mfma_f32_16x16x32_bf16 v[140:143], a[4:7], a[156:159], v[140:143]
    s_waitcnt lgkmcnt(6)
    ds_read_b128 a[180:183], v206 offset:44032
    ds_read_b128 a[24:27], v241 offset:45056
    v_mfma_f32_16x16x32_bf16 v[128:131], a[8:11], a[160:163], v[128:131]
    ds_read_b128 a[28:31], v241 offset:47104
    v_mfma_f32_16x16x32_bf16 v[132:135], a[8:11], a[164:167], v[132:135]
    buffer_load_dwordx4 v219, s[52:55], s82 offen offset:3072 lds
    v_mfma_f32_16x16x32_bf16 v[136:139], a[12:15], a[160:163], v[136:139]
    s_add_u32 m0, s81, 16384
    ds_read_b128 a[0:3], v239 offset:49152
    v_mfma_f32_16x16x32_bf16 v[140:143], a[12:15], a[164:167], v[140:143]
    s_waitcnt lgkmcnt(5)
    ds_write_b64 v208, a[108:109] offset:17408
    v_mfma_f32_16x16x32_bf16 v[128:131], a[16:19], a[168:171], v[128:131]
    s_mov_b32 s82, 32768
    ds_read_b128 a[4:7], v239 offset:51200
    v_mfma_f32_16x16x32_bf16 v[132:135], a[16:19], a[172:175], v[132:135]
    ds_write_b64 v209, a[112:113] offset:0
    v_mfma_f32_16x16x32_bf16 v[136:139], a[20:23], a[168:171], v[136:139]
    ds_read_b128 a[8:11], v241 offset:49152
    v_mfma_f32_16x16x32_bf16 v[140:143], a[20:23], a[172:175], v[140:143]
    s_waitcnt lgkmcnt(5)
    ds_read_b128 a[12:15], v241 offset:51200
    v_mfma_f32_16x16x32_bf16 v[128:131], a[24:27], a[176:179], v[128:131]
    buffer_load_dwordx4 v212, s[48:51], s82 offen offset:0 lds
    v_mfma_f32_16x16x32_bf16 v[132:135], a[24:27], a[180:183], v[132:135]
    ds_read_b128 a[16:19], v239 offset:53248
    v_mfma_f32_16x16x32_bf16 v[136:139], a[28:31], a[176:179], v[136:139]
    ds_write_b64 v209, a[116:117] offset:1024
    v_mfma_f32_16x16x32_bf16 v[140:143], a[28:31], a[180:183], v[140:143]
    s_waitcnt lgkmcnt(5)
    ds_read_b128 a[20:23], v239 offset:55296
    v_mfma_f32_16x16x32_bf16 v[144:147], a[0:3], a[120:123], 0
    ds_read_b128 a[24:27], v241 offset:53248
    v_mfma_f32_16x16x32_bf16 v[148:151], a[0:3], a[124:127], 0
    ds_read_b128 a[28:31], v241 offset:55296
    v_mfma_f32_16x16x32_bf16 v[152:155], a[4:7], a[120:123], 0
    buffer_load_dwordx4 v213, s[48:51], s82 offen offset:1024 lds
    ds_read_b128 a[0:3], v239 offset:57344
    v_max3_f32 v196, v128, v129, v130
    v_max3_f32 v196, v196, v131, v136
    v_max3_f32 v196, v196, v137, v138
    v_max_f32 v196, v196, v139
    v_max3_f32 v198, v132, v133, v134
    v_max3_f32 v198, v198, v135, v140
    v_max3_f32 v198, v198, v141, v142
    v_max_f32 v198, v198, v143
    v_mov_b32 v197, v196
    v_mov_b32 v199, v198
    s_nop 0
    v_permlane32_swap_b32 v196, v197
    v_permlane32_swap_b32 v198, v199
    v_max_f32 v196, v196, v197
    v_max_f32 v198, v198, v199
    v_mov_b32 v197, v196
    v_mov_b32 v199, v198
    s_nop 0
    v_permlane16_swap_b32 v196, v197
    v_permlane16_swap_b32 v198, v199
    v_max_f32 v196, v196, v197
    v_max_f32 v198, v198, v199
    v_sub_f32 v176, 0xc2cc0000, v196
    v_sub_f32 v177, 0xc2cc0000, v196
    v_sub_f32 v178, 0xc2cc0000, v196
    v_sub_f32 v179, 0xc2cc0000, v196
    v_sub_f32 v180, 0xc2cc0000, v198
    v_sub_f32 v181, 0xc2cc0000, v198
    v_sub_f32 v182, 0xc2cc0000, v198
    v_sub_f32 v183, 0xc2cc0000, v198
    v_add_f32 v128, v128, v176
    v_add_f32 v129, v129, v176
    v_add_f32 v130, v130, v176
    v_add_f32 v131, v131, v176
    v_add_f32 v132, v132, v180
    v_add_f32 v133, v133, v180
    v_add_f32 v134, v134, v180
    v_add_f32 v135, v135, v180
    v_add_f32 v136, v136, v176
    v_add_f32 v137, v137, v176
    v_add_f32 v138, v138, v176
    v_add_f32 v139, v139, v176
    v_add_f32 v140, v140, v180
    v_add_f32 v141, v141, v180
    v_add_f32 v142, v142, v180
    v_add_f32 v143, v143, v180
    v_exp_f32 v128, v128
    v_exp_f32 v129, v129
    v_exp_f32 v130, v130
    v_exp_f32 v131, v131
    v_exp_f32 v132, v132
    v_exp_f32 v133, v133
    v_exp_f32 v134, v134
    v_exp_f32 v135, v135
    v_mfma_f32_16x16x32_bf16 v[156:159], a[4:7], a[124:127], 0
    s_waitcnt lgkmcnt(6)
    v_exp_f32 v136, v136
    v_mfma_f32_16x16x32_bf16 v[144:147], a[8:11], a[128:131], v[144:147]
    v_exp_f32 v137, v137
    v_mfma_f32_16x16x32_bf16 v[148:151], a[8:11], a[132:135], v[148:151]
    v_exp_f32 v138, v138
    v_mfma_f32_16x16x32_bf16 v[152:155], a[12:15], a[128:131], v[152:155]
    v_exp_f32 v139, v139
    v_mfma_f32_16x16x32_bf16 v[156:159], a[12:15], a[132:135], v[156:159]
    s_waitcnt lgkmcnt(3)
    v_exp_f32 v140, v140
    v_mfma_f32_16x16x32_bf16 v[144:147], a[16:19], a[136:139], v[144:147]
    buffer_load_dwordx4 v214, s[48:51], s82 offen offset:2048 lds
    v_mfma_f32_16x16x32_bf16 v[148:151], a[16:19], a[140:143], v[148:151]
    ds_read_b128 a[4:7], v239 offset:59392
    v_add_u32 v204, 131072, v224
    v_mfma_f32_16x16x32_bf16 v[152:155], a[20:23], a[136:139], v[152:155]
    v_exp_f32 v141, v141
    v_mfma_f32_16x16x32_bf16 v[156:159], a[20:23], a[140:143], v[156:159]
    s_waitcnt lgkmcnt(2)
    ds_read_b128 a[8:11], v241 offset:57344
    v_add_u32 v205, 131072, v226
    v_mfma_f32_16x16x32_bf16 v[144:147], a[24:27], a[144:147], v[144:147]
    ds_read_b128 a[12:15], v241 offset:59392
    v_add_u32 v254, 131072, v228
    v_mfma_f32_16x16x32_bf16 v[148:151], a[24:27], a[148:151], v[148:151]
    buffer_load_dwordx4 v215, s[48:51], s82 offen offset:3072 lds
    v_mfma_f32_16x16x32_bf16 v[152:155], a[28:31], a[144:147], v[152:155]
    s_add_u32 m0, s81, 32768
    v_exp_f32 v142, v142
    v_mfma_f32_16x16x32_bf16 v[156:159], a[28:31], a[148:151], v[156:159]
    s_waitcnt lgkmcnt(2)
    ds_read_b128 a[16:19], v239 offset:61440
    v_add_u32 v236, 131072, v230
    v_mfma_f32_16x16x32_bf16 v[144:147], a[0:3], a[152:155], v[144:147]
    s_mov_b32 s82, 16384
    ds_read_b128 a[20:23], v239 offset:63488
    v_mfma_f32_16x16x32_bf16 v[148:151], a[0:3], a[156:159], v[148:151]
    v_exp_f32 v143, v143
    v_mfma_f32_16x16x32_bf16 v[152:155], a[4:7], a[152:155], v[152:155]
    ds_read_b128 a[24:27], v241 offset:61440
    v_cvt_pk_bf16_f32 v160, v128, v129
    v_mfma_f32_16x16x32_bf16 v[156:159], a[4:7], a[156:159], v[156:159]
    s_waitcnt lgkmcnt(3)
    ds_read_b128 a[28:31], v241 offset:63488
    v_cvt_pk_bf16_f32 v161, v130, v131
    v_mfma_f32_16x16x32_bf16 v[144:147], a[8:11], a[160:163], v[144:147]
    s_waitcnt vmcnt(4)
    s_barrier
    v_cvt_pk_bf16_f32 v162, v136, v137
    v_mfma_f32_16x16x32_bf16 v[148:151], a[8:11], a[164:167], v[148:151]
    buffer_load_dwordx4 v216, s[52:55], s82 offen offset:0 lds
    v_mfma_f32_16x16x32_bf16 v[152:155], a[12:15], a[160:163], v[152:155]
    v_cvt_pk_bf16_f32 v163, v138, v139
    v_cvt_pk_bf16_f32 v164, v132, v133
    v_mfma_f32_16x16x32_bf16 v[156:159], a[12:15], a[164:167], v[156:159]
    s_waitcnt lgkmcnt(2)
    v_cvt_pk_bf16_f32 v165, v134, v135
    v_cvt_pk_bf16_f32 v166, v140, v141
    v_mfma_f32_16x16x32_bf16 v[144:147], a[16:19], a[168:171], v[144:147]
    ds_read_b64_tr_b16 a[0:1], v224 offset:0
    v_cvt_pk_bf16_f32 v167, v142, v143
    v_mfma_f32_16x16x32_bf16 v[148:151], a[16:19], a[172:175], v[148:151]
    ds_read_b64_tr_b16 a[2:3], v224 offset:2048
    v_mfma_f32_16x16x32_bf16 v[152:155], a[20:23], a[168:171], v[152:155]
    buffer_load_dwordx4 v217, s[52:55], s82 offen offset:1024 lds
    v_mfma_f32_16x16x32_bf16 v[156:159], a[20:23], a[172:175], v[156:159]
    s_waitcnt lgkmcnt(2)
    ds_read_b64_tr_b16 a[4:5], v226 offset:0
    ds_read_b64_tr_b16 a[6:7], v226 offset:2048
    v_mfma_f32_16x16x32_bf16 v[144:147], a[24:27], a[176:179], v[144:147]
    ds_read_b64_tr_b16 a[8:9], v228 offset:0
    ds_read_b64_tr_b16 a[10:11], v228 offset:2048
    v_mfma_f32_16x16x32_bf16 v[148:151], a[24:27], a[180:183], v[148:151]
    ds_read_b64_tr_b16 a[12:13], v230 offset:0
    ds_read_b64_tr_b16 a[14:15], v230 offset:2048
    v_mfma_f32_16x16x32_bf16 v[152:155], a[28:31], a[176:179], v[152:155]
    ds_read_b64_tr_b16 a[16:17], v224 offset:4096
    ds_read_b64_tr_b16 a[18:19], v224 offset:6144
    v_mfma_f32_16x16x32_bf16 v[156:159], a[28:31], a[180:183], v[156:159]
    buffer_load_dwordx4 v218, s[52:55], s82 offen offset:2048 lds
    v_mfma_f32_16x16x32_bf16 v[168:171], v[184:187], v[160:163], 0
    ds_read_b64_tr_b16 a[20:21], v226 offset:4096
    ds_read_b64_tr_b16 a[22:23], v226 offset:6144
    v_mfma_f32_16x16x32_bf16 v[172:175], v[184:187], v[164:167], 0
    s_waitcnt lgkmcnt(8)
    ds_read_b64_tr_b16 a[24:25], v228 offset:4096
    ds_read_b64_tr_b16 a[26:27], v228 offset:6144
    v_mfma_f32_16x16x32_bf16 v[0:3], a[0:3], v[160:163], 0
    ds_read_b64_tr_b16 a[28:29], v230 offset:4096
    ds_read_b64_tr_b16 a[30:31], v230 offset:6144
    v_add_f32 v144, v144, v176
    v_add_f32 v145, v145, v176
    v_add_f32 v146, v146, v176
    v_add_f32 v147, v147, v176
    v_add_f32 v148, v148, v180
    v_add_f32 v149, v149, v180
    v_add_f32 v150, v150, v180
    v_add_f32 v151, v151, v180
    v_add_f32 v152, v152, v176
    v_add_f32 v153, v153, v176
    v_add_f32 v154, v154, v176
    v_add_f32 v155, v155, v176
    v_add_f32 v156, v156, v180
    v_add_f32 v157, v157, v180
    v_mfma_f32_16x16x32_bf16 v[4:7], a[0:3], v[164:167], 0
    v_add_f32 v158, v158, v180
    v_add_f32 v159, v159, v180
    v_mfma_f32_16x16x32_bf16 v[8:11], a[4:7], v[160:163], 0
    buffer_load_dwordx4 v219, s[52:55], s82 offen offset:3072 lds
    v_mfma_f32_16x16x32_bf16 v[12:15], a[4:7], v[164:167], 0
    s_waitcnt lgkmcnt(8)
    v_exp_f32 v144, v144
    v_mfma_f32_16x16x32_bf16 v[16:19], a[8:11], v[160:163], 0
    s_add_u32 m0, s81, 49152
    v_exp_f32 v145, v145
    v_mfma_f32_16x16x32_bf16 v[20:23], a[8:11], v[164:167], 0
    s_mov_b32 s82, 49152
    v_exp_f32 v146, v146
    v_mfma_f32_16x16x32_bf16 v[24:27], a[12:15], v[160:163], 0
    ds_read_b64_tr_b16 a[0:1], v224 offset:8192
    ds_read_b64_tr_b16 a[2:3], v224 offset:10240
    v_mfma_f32_16x16x32_bf16 v[28:31], a[12:15], v[164:167], 0
    s_waitcnt lgkmcnt(6)
    buffer_load_dwordx4 v212, s[48:51], s82 offen offset:0 lds
    v_mfma_f32_16x16x32_bf16 v[32:35], a[16:19], v[160:163], 0
    v_exp_f32 v147, v147
    v_mfma_f32_16x16x32_bf16 v[36:39], a[16:19], v[164:167], 0
    ds_read_b64_tr_b16 a[4:5], v226 offset:8192
    ds_read_b64_tr_b16 a[6:7], v226 offset:10240
    v_mfma_f32_16x16x32_bf16 v[40:43], a[20:23], v[160:163], 0
    v_exp_f32 v148, v148
    v_mfma_f32_16x16x32_bf16 v[44:47], a[20:23], v[164:167], 0
    s_waitcnt lgkmcnt(4)
    ds_read_b64_tr_b16 a[8:9], v228 offset:8192
    ds_read_b64_tr_b16 a[10:11], v228 offset:10240
    v_mfma_f32_16x16x32_bf16 v[48:51], a[24:27], v[160:163], 0
    buffer_load_dwordx4 v213, s[48:51], s82 offen offset:1024 lds
    v_mfma_f32_16x16x32_bf16 v[52:55], a[24:27], v[164:167], 0
    ds_read_b64_tr_b16 a[12:13], v230 offset:8192
    ds_read_b64_tr_b16 a[14:15], v230 offset:10240
    v_mfma_f32_16x16x32_bf16 v[56:59], a[28:31], v[160:163], 0
    v_exp_f32 v149, v149
    v_mfma_f32_16x16x32_bf16 v[60:63], a[28:31], v[164:167], 0
    s_waitcnt lgkmcnt(4)
    ds_read_b64_tr_b16 a[16:17], v224 offset:12288
    ds_read_b64_tr_b16 a[18:19], v224 offset:14336
    v_mfma_f32_16x16x32_bf16 v[64:67], a[0:3], v[160:163], 0
    ds_read_b64_tr_b16 a[20:21], v226 offset:12288
    ds_read_b64_tr_b16 a[22:23], v226 offset:14336
    v_mfma_f32_16x16x32_bf16 v[68:71], a[0:3], v[164:167], 0
    buffer_load_dwordx4 v214, s[48:51], s82 offen offset:2048 lds
    v_mfma_f32_16x16x32_bf16 v[72:75], a[4:7], v[160:163], 0
    s_waitcnt vmcnt(7)
    s_barrier
    v_exp_f32 v150, v150
    v_mfma_f32_16x16x32_bf16 v[76:79], a[4:7], v[164:167], 0
    s_waitcnt lgkmcnt(4)
    ds_read_b64_tr_b16 a[24:25], v228 offset:12288
    ds_read_b64_tr_b16 a[26:27], v228 offset:14336
    v_mfma_f32_16x16x32_bf16 v[80:83], a[8:11], v[160:163], 0
    v_exp_f32 v151, v151
    v_mfma_f32_16x16x32_bf16 v[84:87], a[8:11], v[164:167], 0
    ds_read_b64_tr_b16 a[28:29], v230 offset:12288
    ds_read_b64_tr_b16 a[30:31], v230 offset:14336
    v_mfma_f32_16x16x32_bf16 v[88:91], a[12:15], v[160:163], 0
    buffer_load_dwordx4 v215, s[48:51], s82 offen offset:3072 lds
    v_mfma_f32_16x16x32_bf16 v[92:95], a[12:15], v[164:167], 0
    s_waitcnt lgkmcnt(4)
    ds_read_b128 a[0:3], v238 offset:16384
    v_mfma_f32_16x16x32_bf16 v[96:99], a[16:19], v[160:163], 0
    s_add_u32 m0, s81, 65536
    v_exp_f32 v152, v152
    v_mfma_f32_16x16x32_bf16 v[100:103], a[16:19], v[164:167], 0
    s_mov_b32 s82, 32768
    ds_read_b128 a[4:7], v238 offset:18432
    v_mfma_f32_16x16x32_bf16 v[104:107], a[20:23], v[160:163], 0
    ds_read_b128 a[8:11], v240 offset:16384
    v_mfma_f32_16x16x32_bf16 v[108:111], a[20:23], v[164:167], 0
    s_waitcnt lgkmcnt(3)
    buffer_load_dwordx4 v216, s[52:55], s82 offen offset:0 lds
    v_mfma_f32_16x16x32_bf16 v[112:115], a[24:27], v[160:163], 0
    v_exp_f32 v153, v153
    v_mfma_f32_16x16x32_bf16 v[116:119], a[24:27], v[164:167], 0
    ds_read_b128 a[12:15], v240 offset:18432
    v_mfma_f32_16x16x32_bf16 v[120:123], a[28:31], v[160:163], 0
    v_exp_f32 v154, v154
    v_mfma_f32_16x16x32_bf16 v[124:127], a[28:31], v[164:167], 0
    s_waitcnt lgkmcnt(2)
    ds_read_b128 a[16:19], v238 offset:20480
    v_mfma_f32_16x16x32_bf16 v[128:131], a[0:3], a[120:123], v[176:179]
    buffer_load_dwordx4 v217, s[52:55], s82 offen offset:1024 lds
    v_mfma_f32_16x16x32_bf16 v[132:135], a[0:3], a[124:127], v[180:183]
    ds_read_b128 a[20:23], v238 offset:22528
    v_mfma_f32_16x16x32_bf16 v[136:139], a[4:7], a[120:123], v[176:179]
    v_exp_f32 v155, v155
    v_mfma_f32_16x16x32_bf16 v[140:143], a[4:7], a[124:127], v[180:183]
    s_waitcnt lgkmcnt(2)
    ds_read_b128 a[24:27], v240 offset:20480
    v_mfma_f32_16x16x32_bf16 v[128:131], a[8:11], a[128:131], v[128:131]
    ds_read_b128 a[28:31], v240 offset:22528
    v_mfma_f32_16x16x32_bf16 v[132:135], a[8:11], a[132:135], v[132:135]
    buffer_load_dwordx4 v218, s[52:55], s82 offen offset:2048 lds
    v_mfma_f32_16x16x32_bf16 v[136:139], a[12:15], a[128:131], v[136:139]
    v_exp_f32 v156, v156
    v_mfma_f32_16x16x32_bf16 v[140:143], a[12:15], a[132:135], v[140:143]
    s_waitcnt lgkmcnt(2)
    ds_read_b128 a[0:3], v238 offset:24576
    v_mfma_f32_16x16x32_bf16 v[128:131], a[16:19], a[136:139], v[128:131]
    v_exp_f32 v157, v157
    v_mfma_f32_16x16x32_bf16 v[132:135], a[16:19], a[140:143], v[132:135]
    ds_read_b128 a[4:7], v238 offset:26624
    v_mfma_f32_16x16x32_bf16 v[136:139], a[20:23], a[136:139], v[136:139]
    buffer_load_dwordx4 v219, s[52:55], s82 offen offset:3072 lds
    v_mfma_f32_16x16x32_bf16 v[140:143], a[20:23], a[140:143], v[140:143]
    s_waitcnt lgkmcnt(2)
    ds_read_b128 a[8:11], v240 offset:24576
    v_mfma_f32_16x16x32_bf16 v[128:131], a[24:27], a[144:147], v[128:131]
    s_add_u32 m0, s81, 81920
    v_exp_f32 v158, v158
    v_mfma_f32_16x16x32_bf16 v[132:135], a[24:27], a[148:151], v[132:135]
    s_mov_b32 s82, 0
    ds_read_b128 a[12:15], v240 offset:26624
    v_mfma_f32_16x16x32_bf16 v[136:139], a[28:31], a[144:147], v[136:139]
    ds_read_b128 a[16:19], v238 offset:28672
    v_mfma_f32_16x16x32_bf16 v[140:143], a[28:31], a[148:151], v[140:143]
    s_waitcnt lgkmcnt(3)
    buffer_load_dwordx4 v220, s[60:63], s82 offen offset:0 lds
    v_mfma_f32_16x16x32_bf16 v[128:131], a[0:3], a[152:155], v[128:131]
    v_exp_f32 v159, v159
    v_mfma_f32_16x16x32_bf16 v[132:135], a[0:3], a[156:159], v[132:135]
    ds_read_b128 a[20:23], v238 offset:30720
    v_cvt_pk_bf16_f32 v160, v144, v145
    v_mfma_f32_16x16x32_bf16 v[136:139], a[4:7], a[152:155], v[136:139]
    v_cvt_pk_bf16_f32 v161, v146, v147
    v_cvt_pk_bf16_f32 v162, v152, v153
    v_mfma_f32_16x16x32_bf16 v[140:143], a[4:7], a[156:159], v[140:143]
    s_waitcnt lgkmcnt(2)
    ds_read_b128 a[24:27], v240 offset:28672
    v_cvt_pk_bf16_f32 v163, v154, v155
    v_mfma_f32_16x16x32_bf16 v[128:131], a[8:11], a[160:163], v[128:131]
    s_waitcnt vmcnt(9)
    s_barrier
    buffer_load_dwordx4 v221, s[60:63], s82 offen offset:1024 lds
    v_mfma_f32_16x16x32_bf16 v[132:135], a[8:11], a[164:167], v[132:135]
    ds_read_b128 a[28:31], v240 offset:30720
    v_cvt_pk_bf16_f32 v164, v148, v149
    v_mfma_f32_16x16x32_bf16 v[136:139], a[12:15], a[160:163], v[136:139]
    v_cvt_pk_bf16_f32 v165, v150, v151
    v_cvt_pk_bf16_f32 v166, v156, v157
    v_mfma_f32_16x16x32_bf16 v[140:143], a[12:15], a[164:167], v[140:143]
    s_waitcnt lgkmcnt(2)
    ds_read_b64_tr_b16 a[0:1], v224 offset:32768
    v_cvt_pk_bf16_f32 v167, v158, v159
    v_mfma_f32_16x16x32_bf16 v[128:131], a[16:19], a[168:171], v[128:131]
    ds_read_b64_tr_b16 a[2:3], v224 offset:34816
    v_mfma_f32_16x16x32_bf16 v[132:135], a[16:19], a[172:175], v[132:135]
    buffer_load_dwordx4 v222, s[60:63], s82 offen offset:2048 lds
    v_mfma_f32_16x16x32_bf16 v[136:139], a[20:23], a[168:171], v[136:139]
    ds_read_b64_tr_b16 a[4:5], v226 offset:32768
    ds_read_b64_tr_b16 a[6:7], v226 offset:34816
    v_mfma_f32_16x16x32_bf16 v[140:143], a[20:23], a[172:175], v[140:143]
    s_waitcnt lgkmcnt(4)
    ds_read_b64_tr_b16 a[8:9], v228 offset:32768
    ds_read_b64_tr_b16 a[10:11], v228 offset:34816
    v_mfma_f32_16x16x32_bf16 v[128:131], a[24:27], a[176:179], v[128:131]
    ds_read_b64_tr_b16 a[12:13], v230 offset:32768
    ds_read_b64_tr_b16 a[14:15], v230 offset:34816
    v_mfma_f32_16x16x32_bf16 v[132:135], a[24:27], a[180:183], v[132:135]
    ds_read_b64_tr_b16 a[16:17], v224 offset:36864
    ds_read_b64_tr_b16 a[18:19], v224 offset:38912
    v_mfma_f32_16x16x32_bf16 v[136:139], a[28:31], a[176:179], v[136:139]
    buffer_load_dwordx4 v223, s[60:63], s82 offen offset:3072 lds
    v_mfma_f32_16x16x32_bf16 v[140:143], a[28:31], a[180:183], v[140:143]
    s_add_u32 m0, s81, 98304
    ds_read_b64_tr_b16 a[20:21], v226 offset:36864
    ds_read_b64_tr_b16 a[22:23], v226 offset:38912
    v_mfma_f32_16x16x32_bf16 v[168:171], v[184:187], v[160:163], v[168:171]
    s_mov_b32 s82, 114688
    ds_read_b64_tr_b16 a[24:25], v228 offset:36864
    ds_read_b64_tr_b16 a[26:27], v228 offset:38912
    v_mov_b32 v242, 0x7f000000
    v_mfma_f32_16x16x32_bf16 v[172:175], v[184:187], v[164:167], v[172:175]
    s_waitcnt lgkmcnt(10)
    s_mul_i32 s86, s89, 28
    v_add_u32 v255, s86, v251
    v_lshlrev_b32 v255, 7, v255
    v_cmp_gt_u32 vcc, 28, v251
    s_nop 1
    v_cndmask_b32 v255, v242, v255, vcc
    v_mfma_f32_16x16x32_bf16 v[0:3], a[0:3], v[160:163], v[0:3]
    buffer_load_dword v252, v255, s[56:59], 0 offen
    buffer_load_dwordx4 v220, s[60:63], s82 offen offset:0 lds
    ds_read_b64_tr_b16 a[28:29], v230 offset:36864
    ds_read_b64_tr_b16 a[30:31], v230 offset:38912
    v_exp_f32 v128, v128
    v_exp_f32 v129, v129
    v_exp_f32 v130, v130
    v_exp_f32 v131, v131
    v_exp_f32 v132, v132
    v_mfma_f32_16x16x32_bf16 v[4:7], a[0:3], v[164:167], v[4:7]
    v_exp_f32 v133, v133
    v_mfma_f32_16x16x32_bf16 v[8:11], a[4:7], v[160:163], v[8:11]
    v_exp_f32 v134, v134
    v_mfma_f32_16x16x32_bf16 v[12:15], a[4:7], v[164:167], v[12:15]
    s_waitcnt lgkmcnt(8)
    v_exp_f32 v135, v135
    v_mfma_f32_16x16x32_bf16 v[16:19], a[8:11], v[160:163], v[16:19]
    v_exp_f32 v136, v136
    v_mfma_f32_16x16x32_bf16 v[20:23], a[8:11], v[164:167], v[20:23]
    v_exp_f32 v137, v137
    v_mfma_f32_16x16x32_bf16 v[24:27], a[12:15], v[160:163], v[24:27]
    buffer_load_dwordx4 v221, s[60:63], s82 offen offset:1024 lds
    v_mfma_f32_16x16x32_bf16 v[28:31], a[12:15], v[164:167], v[28:31]
    s_waitcnt lgkmcnt(4)
    ds_read_b64_tr_b16 a[0:1], v224 offset:40960
    ds_read_b64_tr_b16 a[2:3], v224 offset:43008
    v_mfma_f32_16x16x32_bf16 v[32:35], a[16:19], v[160:163], v[32:35]
    v_exp_f32 v138, v138
    v_mfma_f32_16x16x32_bf16 v[36:39], a[16:19], v[164:167], v[36:39]
    ds_read_b64_tr_b16 a[4:5], v226 offset:40960
    ds_read_b64_tr_b16 a[6:7], v226 offset:43008
    v_mfma_f32_16x16x32_bf16 v[40:43], a[20:23], v[160:163], v[40:43]
    ds_read_b64_tr_b16 a[8:9], v228 offset:40960
    ds_read_b64_tr_b16 a[10:11], v228 offset:43008
    v_mfma_f32_16x16x32_bf16 v[44:47], a[20:23], v[164:167], v[44:47]
    s_waitcnt lgkmcnt(6)
    buffer_load_dwordx4 v222, s[60:63], s82 offen offset:2048 lds
    v_mfma_f32_16x16x32_bf16 v[48:51], a[24:27], v[160:163], v[48:51]
    v_exp_f32 v139, v139
    v_mfma_f32_16x16x32_bf16 v[52:55], a[24:27], v[164:167], v[52:55]
    ds_read_b64_tr_b16 a[12:13], v230 offset:40960
    ds_read_b64_tr_b16 a[14:15], v230 offset:43008
    v_mfma_f32_16x16x32_bf16 v[56:59], a[28:31], v[160:163], v[56:59]
    v_exp_f32 v140, v140
    v_mfma_f32_16x16x32_bf16 v[60:63], a[28:31], v[164:167], v[60:63]
    s_waitcnt lgkmcnt(4)
    ds_read_b64_tr_b16 a[16:17], v224 offset:45056
    ds_read_b64_tr_b16 a[18:19], v224 offset:47104
    v_mfma_f32_16x16x32_bf16 v[64:67], a[0:3], v[160:163], v[64:67]
    buffer_load_dwordx4 v223, s[60:63], s82 offen offset:3072 lds
    v_mfma_f32_16x16x32_bf16 v[68:71], a[0:3], v[164:167], v[68:71]
    s_add_u32 m0, s81, 114688
    ds_read_b64_tr_b16 a[20:21], v226 offset:45056
    ds_read_b64_tr_b16 a[22:23], v226 offset:47104
    v_mfma_f32_16x16x32_bf16 v[72:75], a[4:7], v[160:163], v[72:75]
    s_waitcnt vmcnt(13)
    s_barrier
    v_exp_f32 v141, v141
    v_mfma_f32_16x16x32_bf16 v[76:79], a[4:7], v[164:167], v[76:79]
    s_waitcnt lgkmcnt(4)
    ds_read_b64_tr_b16 a[24:25], v228 offset:45056
    ds_read_b64_tr_b16 a[26:27], v228 offset:47104
    v_mfma_f32_16x16x32_bf16 v[80:83], a[8:11], v[160:163], v[80:83]
    s_mov_b32 s82, 65536
    ds_read_b64_tr_b16 a[28:29], v230 offset:45056
    ds_read_b64_tr_b16 a[30:31], v230 offset:47104
    v_mfma_f32_16x16x32_bf16 v[84:87], a[8:11], v[164:167], v[84:87]
    buffer_load_dwordx4 v212, s[48:51], s82 offen offset:0 lds
    v_mfma_f32_16x16x32_bf16 v[88:91], a[12:15], v[160:163], v[88:91]
    v_exp_f32 v142, v142
    v_mfma_f32_16x16x32_bf16 v[92:95], a[12:15], v[164:167], v[92:95]
    s_waitcnt lgkmcnt(4)
    ds_read_b128 a[0:3], v238 offset:49152
    v_mfma_f32_16x16x32_bf16 v[96:99], a[16:19], v[160:163], v[96:99]
    ds_read_b128 a[64:67], v245 offset:0
    ds_read_b128 a[68:71], v245 offset:1024
    v_mfma_f32_16x16x32_bf16 v[100:103], a[16:19], v[164:167], v[100:103]
    ds_read_b128 a[72:75], v245 offset:2048
    ds_read_b128 a[4:7], v238 offset:51200
    v_mfma_f32_16x16x32_bf16 v[104:107], a[20:23], v[160:163], v[104:107]
    buffer_load_dwordx4 v213, s[48:51], s82 offen offset:1024 lds
    v_mfma_f32_16x16x32_bf16 v[108:111], a[20:23], v[164:167], v[108:111]
    s_waitcnt lgkmcnt(5)
    ds_read_b128 a[76:79], v245 offset:3072
    ds_read_b128 a[8:11], v240 offset:49152
    v_mfma_f32_16x16x32_bf16 v[112:115], a[24:27], v[160:163], v[112:115]
    ds_read_b128 a[80:83], v245 offset:4096
    ds_read_b128 a[84:87], v245 offset:5120
    v_mfma_f32_16x16x32_bf16 v[116:119], a[24:27], v[164:167], v[116:119]
    ds_read_b128 a[88:91], v245 offset:6144
    ds_read_b128 a[12:15], v240 offset:51200
    v_mfma_f32_16x16x32_bf16 v[120:123], a[28:31], v[160:163], v[120:123]
    ds_read_b128 a[92:95], v245 offset:7168
    ds_read_b128 a[16:19], v238 offset:53248
    v_mfma_f32_16x16x32_bf16 v[124:127], a[28:31], v[164:167], v[124:127]
    s_waitcnt lgkmcnt(8)
    buffer_load_dwordx4 v214, s[48:51], s82 offen offset:2048 lds
    v_mfma_f32_16x16x32_bf16 v[144:147], a[0:3], a[120:123], v[176:179]
    ds_read_b128 a[96:99], v245 offset:8192
    ds_read_b128 a[100:103], v245 offset:9216
    v_add_u32 v206, 98304, v253
    v_mfma_f32_16x16x32_bf16 v[148:151], a[0:3], a[124:127], v[180:183]
    ds_read_b128 a[104:107], v245 offset:10240
    ds_read_b128 a[20:23], v238 offset:55296
    v_mfma_f32_16x16x32_bf16 v[152:155], a[4:7], a[120:123], v[176:179]
    ds_read_b128 a[108:111], v245 offset:11264
    ds_read_b128 a[112:115], v245 offset:12288
    v_mfma_f32_16x16x32_bf16 v[156:159], a[4:7], a[124:127], v[180:183]
    s_waitcnt lgkmcnt(8)
    ds_read_b128 a[116:119], v245 offset:13312
    ds_read_b128 a[24:27], v240 offset:53248
    v_mfma_f32_16x16x32_bf16 v[144:147], a[8:11], a[128:131], v[144:147]
    buffer_load_dwordx4 v215, s[48:51], s82 offen offset:3072 lds
    v_mfma_f32_16x16x32_bf16 v[148:151], a[8:11], a[132:135], v[148:151]
    s_add_u32 m0, s81, 0
    ds_read_b128 a[32:35], v245 offset:14336
    ds_read_b128 a[28:31], v240 offset:55296
    v_mfma_f32_16x16x32_bf16 v[152:155], a[12:15], a[128:131], v[152:155]
    s_mov_b32 s82, 49152
    ds_read_b128 a[36:39], v245 offset:15360
    ds_read_b128 a[40:43], v245 offset:16384
    v_mfma_f32_16x16x32_bf16 v[156:159], a[12:15], a[132:135], v[156:159]
    s_waitcnt lgkmcnt(8)
    ds_read_b128 a[44:47], v245 offset:17408
    ds_read_b128 a[0:3], v238 offset:57344
    v_mfma_f32_16x16x32_bf16 v[144:147], a[16:19], a[136:139], v[144:147]
    ds_read_b128 a[48:51], v245 offset:18432
    ds_read_b128 a[4:7], v238 offset:59392
    v_mfma_f32_16x16x32_bf16 v[148:151], a[16:19], a[140:143], v[148:151]
    buffer_load_dwordx4 v216, s[52:55], s82 offen offset:0 lds
    v_mfma_f32_16x16x32_bf16 v[152:155], a[20:23], a[136:139], v[152:155]
    ds_read_b128 a[52:55], v245 offset:19456
    ds_read_b128 a[56:59], v245 offset:20480
    v_mfma_f32_16x16x32_bf16 v[156:159], a[20:23], a[140:143], v[156:159]
    s_waitcnt lgkmcnt(8)
    ds_read_b128 a[60:63], v245 offset:21504
    ds_read_b128 a[8:11], v240 offset:57344
    v_mfma_f32_16x16x32_bf16 v[144:147], a[24:27], a[144:147], v[144:147]
    ds_read_b128 a[184:187], v245 offset:22528
    ds_read_b128 a[188:191], v245 offset:23552
    v_mfma_f32_16x16x32_bf16 v[148:151], a[24:27], a[148:151], v[148:151]
    ds_read_b128 a[192:195], v245 offset:24576
    ds_read_b128 a[12:15], v240 offset:59392
    v_mfma_f32_16x16x32_bf16 v[152:155], a[28:31], a[144:147], v[152:155]
    buffer_load_dwordx4 v217, s[52:55], s82 offen offset:1024 lds
    v_mfma_f32_16x16x32_bf16 v[156:159], a[28:31], a[148:151], v[156:159]
    s_waitcnt lgkmcnt(8)
    ds_read_b128 a[196:199], v245 offset:25600
    ds_read_b128 a[16:19], v238 offset:61440
    v_mfma_f32_16x16x32_bf16 v[144:147], a[0:3], a[152:155], v[144:147]
    ds_read_b128 a[200:203], v245 offset:26624
    ds_read_b128 a[204:207], v245 offset:27648
    v_mfma_f32_16x16x32_bf16 v[148:151], a[0:3], a[156:159], v[148:151]
    ds_read_b128 a[20:23], v238 offset:63488
    v_mfma_f32_16x16x32_bf16 v[152:155], a[4:7], a[152:155], v[152:155]
    ds_read_b128 a[24:27], v240 offset:61440
    v_mfma_f32_16x16x32_bf16 v[156:159], a[4:7], a[156:159], v[156:159]
    s_waitcnt lgkmcnt(6)
    buffer_load_dwordx4 v218, s[52:55], s82 offen offset:2048 lds
    v_mfma_f32_16x16x32_bf16 v[144:147], a[8:11], a[160:163], v[144:147]
    s_waitcnt lgkmcnt(2) vmcnt(7)
    s_barrier
    v_exp_f32 v143, v143
    v_mfma_f32_16x16x32_bf16 v[148:151], a[8:11], a[164:167], v[148:151]
    ds_read_b128 a[28:31], v240 offset:63488
    v_cvt_pk_bf16_f32 v160, v128, v129
    v_mfma_f32_16x16x32_bf16 v[152:155], a[12:15], a[160:163], v[152:155]
    v_cvt_pk_bf16_f32 v161, v130, v131
    v_cvt_pk_bf16_f32 v162, v136, v137
    v_mfma_f32_16x16x32_bf16 v[156:159], a[12:15], a[164:167], v[156:159]
    s_waitcnt lgkmcnt(2)
    ds_read_b64_tr_b16 a[0:1], v225 offset:0
    v_cvt_pk_bf16_f32 v163, v138, v139
    v_mfma_f32_16x16x32_bf16 v[144:147], a[16:19], a[168:171], v[144:147]
    buffer_load_dwordx4 v219, s[52:55], s82 offen offset:3072 lds
    v_mfma_f32_16x16x32_bf16 v[148:151], a[16:19], a[172:175], v[148:151]
    s_add_u32 m0, s81, 16384
    ds_read_b64_tr_b16 a[2:3], v225 offset:2048
    v_cvt_pk_bf16_f32 v164, v132, v133
    v_mfma_f32_16x16x32_bf16 v[152:155], a[20:23], a[168:171], v[152:155]
    s_mov_b32 s82, 128
    ds_read_b64_tr_b16 a[4:5], v227 offset:0
    v_cvt_pk_bf16_f32 v165, v134, v135
    v_mfma_f32_16x16x32_bf16 v[156:159], a[20:23], a[172:175], v[156:159]
    s_waitcnt lgkmcnt(3)
    ds_read_b64_tr_b16 a[6:7], v227 offset:2048
    v_cvt_pk_bf16_f32 v166, v140, v141
    v_mfma_f32_16x16x32_bf16 v[144:147], a[24:27], a[176:179], v[144:147]
    ds_read_b64_tr_b16 a[8:9], v229 offset:0
    ds_read_b64_tr_b16 a[10:11], v229 offset:2048
    v_cvt_pk_bf16_f32 v167, v142, v143
    v_mfma_f32_16x16x32_bf16 v[148:151], a[24:27], a[180:183], v[148:151]
    buffer_load_dwordx4 v220, s[60:63], s82 offen offset:0 lds
    v_mfma_f32_16x16x32_bf16 v[152:155], a[28:31], a[176:179], v[152:155]
    ds_read_b64_tr_b16 a[12:13], v231 offset:0
    v_mfma_f32_16x16x32_bf16 v[156:159], a[28:31], a[180:183], v[156:159]
    ds_read_b64_tr_b16 a[14:15], v231 offset:2048
    v_mfma_f32_16x16x32_bf16 v[168:171], v[184:187], v[160:163], v[168:171]
    s_lshl_b32 s86, s80, 3
    ds_read_b64_tr_b16 a[16:17], v225 offset:4096
    v_mov_b32 v255, s86
    v_mfma_f32_16x16x32_bf16 v[172:175], v[184:187], v[164:167], v[172:175]
    s_waitcnt lgkmcnt(5)
    ds_read_b64_tr_b16 a[18:19], v225 offset:6144
    v_mfma_f32_16x16x32_bf16 v[0:3], a[0:3], v[160:163], v[0:3]
    buffer_load_dwordx4 v221, s[60:63], s82 offen offset:1024 lds
    v_mfma_f32_16x16x32_bf16 v[4:7], a[0:3], v[164:167], v[4:7]
    ds_read_b64_tr_b16 a[20:21], v227 offset:4096
    ds_read_b64_tr_b16 a[22:23], v227 offset:6144
    v_mfma_f32_16x16x32_bf16 v[8:11], a[4:7], v[160:163], v[8:11]
    ds_read_b64_tr_b16 a[24:25], v229 offset:4096
    v_mfma_f32_16x16x32_bf16 v[12:15], a[4:7], v[164:167], v[12:15]
    s_waitcnt lgkmcnt(5)
    ds_read_b64_tr_b16 a[26:27], v229 offset:6144
    v_mfma_f32_16x16x32_bf16 v[16:19], a[8:11], v[160:163], v[16:19]
    ds_read_b64_tr_b16 a[28:29], v231 offset:4096
    ds_read_b64_tr_b16 a[30:31], v231 offset:6144
    v_mfma_f32_16x16x32_bf16 v[20:23], a[8:11], v[164:167], v[20:23]
    buffer_load_dwordx4 v222, s[60:63], s82 offen offset:2048 lds
    v_mfma_f32_16x16x32_bf16 v[24:27], a[12:15], v[160:163], v[24:27]
    ds_read_b64_tr_b16 a[0:1], v225 offset:8192
    v_mfma_f32_16x16x32_bf16 v[28:31], a[12:15], v[164:167], v[28:31]
    s_waitcnt lgkmcnt(5)
    ds_read_b64_tr_b16 a[2:3], v225 offset:10240
    v_mfma_f32_16x16x32_bf16 v[32:35], a[16:19], v[160:163], v[32:35]
    ds_read_b64_tr_b16 a[4:5], v227 offset:8192
    v_mfma_f32_16x16x32_bf16 v[36:39], a[16:19], v[164:167], v[36:39]
    ds_read_b64_tr_b16 a[6:7], v227 offset:10240
    v_mfma_f32_16x16x32_bf16 v[40:43], a[20:23], v[160:163], v[40:43]
    buffer_load_dwordx4 v223, s[60:63], s82 offen offset:3072 lds
    v_mfma_f32_16x16x32_bf16 v[44:47], a[20:23], v[164:167], v[44:47]
    s_waitcnt lgkmcnt(4)
    ds_read_b64_tr_b16 a[8:9], v229 offset:8192
    ds_read_b64_tr_b16 a[10:11], v229 offset:10240
    v_mfma_f32_16x16x32_bf16 v[48:51], a[24:27], v[160:163], v[48:51]
    s_add_u32 m0, s81, 32768
    ds_read_b64_tr_b16 a[12:13], v231 offset:8192
    v_mfma_f32_16x16x32_bf16 v[52:55], a[24:27], v[164:167], v[52:55]
    s_mov_b32 s82, 114816
    ds_read_b64_tr_b16 a[14:15], v231 offset:10240
    v_mfma_f32_16x16x32_bf16 v[56:59], a[28:31], v[160:163], v[56:59]
    ds_read_b64_tr_b16 a[16:17], v225 offset:12288
    ds_read_b64_tr_b16 a[18:19], v225 offset:14336
    v_mfma_f32_16x16x32_bf16 v[60:63], a[28:31], v[164:167], v[60:63]
    s_waitcnt lgkmcnt(6)
    buffer_load_dwordx4 v220, s[60:63], s82 offen offset:0 lds
    v_mfma_f32_16x16x32_bf16 v[64:67], a[0:3], v[160:163], v[64:67]
    ds_read_b64_tr_b16 a[20:21], v227 offset:12288
    v_mfma_f32_16x16x32_bf16 v[68:71], a[0:3], v[164:167], v[68:71]
    ds_read_b64_tr_b16 a[22:23], v227 offset:14336
    v_mfma_f32_16x16x32_bf16 v[72:75], a[4:7], v[160:163], v[72:75]
    ds_read_b64_tr_b16 a[24:25], v229 offset:12288
    v_mfma_f32_16x16x32_bf16 v[76:79], a[4:7], v[164:167], v[76:79]
    s_waitcnt lgkmcnt(5)
    ds_read_b64_tr_b16 a[26:27], v229 offset:14336
    v_mfma_f32_16x16x32_bf16 v[80:83], a[8:11], v[160:163], v[80:83]
    buffer_load_dwordx4 v221, s[60:63], s82 offen offset:1024 lds
    v_mfma_f32_16x16x32_bf16 v[84:87], a[8:11], v[164:167], v[84:87]
    ds_read_b64_tr_b16 a[28:29], v231 offset:12288
    ds_read_b64_tr_b16 a[30:31], v231 offset:14336
    v_mfma_f32_16x16x32_bf16 v[88:91], a[12:15], v[160:163], v[88:91]
    ds_read_b64_tr_b16 a[0:1], v233 offset:16384
    v_mfma_f32_16x16x32_bf16 v[92:95], a[12:15], v[164:167], v[92:95]
    s_waitcnt lgkmcnt(5)
    ds_read_b64_tr_b16 a[2:3], v233 offset:18432
    v_mfma_f32_16x16x32_bf16 v[96:99], a[16:19], v[160:163], v[96:99]
    buffer_load_dwordx4 v222, s[60:63], s82 offen offset:2048 lds
    v_mfma_f32_16x16x32_bf16 v[100:103], a[16:19], v[164:167], v[100:103]
    ds_read_b64_tr_b16 a[4:5], v233 offset:20480
    v_mfma_f32_16x16x32_bf16 v[104:107], a[20:23], v[160:163], v[104:107]
    ds_read_b64_tr_b16 a[6:7], v233 offset:22528
    v_mfma_f32_16x16x32_bf16 v[108:111], a[20:23], v[164:167], v[108:111]
    s_waitcnt lgkmcnt(4)
    ds_read_b64_tr_b16 a[8:9], v233 offset:24576
    v_mfma_f32_16x16x32_bf16 v[112:115], a[24:27], v[160:163], v[112:115]
    ds_read_b64_tr_b16 a[10:11], v233 offset:26624
    v_mfma_f32_16x16x32_bf16 v[116:119], a[24:27], v[164:167], v[116:119]
    buffer_load_dwordx4 v223, s[60:63], s82 offen offset:3072 lds
    v_mfma_f32_16x16x32_bf16 v[120:123], a[28:31], v[160:163], v[120:123]
    s_add_u32 m0, s81, 131072
    s_mov_b32 s82, 81920
    v_mfma_f32_16x16x32_bf16 v[124:127], a[28:31], v[164:167], v[124:127]
    s_waitcnt lgkmcnt(4)
    ds_read_b64_tr_b16 a[12:13], v233 offset:28672
    v_mfma_f32_16x16x32_bf16 v[188:191], a[0:3], a[64:67], 0
    buffer_load_dword v246, v255, s[72:75], 0 offen offset:4 sc1
    v_mfma_f32_16x16x32_bf16 v[192:195], a[0:3], a[68:71], 0
    ds_read_b64_tr_b16 a[14:15], v233 offset:30720
    v_lshl_or_b32 v243, v251, 8, s81
    v_mfma_f32_16x16x32_bf16 v[196:199], a[0:3], a[72:75], 0
    buffer_load_dwordx4 v212, s[48:51], s82 offen offset:0 lds
    v_mfma_f32_16x16x32_bf16 v[200:203], a[0:3], a[76:79], 0
    s_waitcnt lgkmcnt(4)
    v_exp_f32 v144, v144
    v_mfma_f32_16x16x32_bf16 v[188:191], a[4:7], a[80:83], v[188:191]
    v_exp_f32 v145, v145
    v_mfma_f32_16x16x32_bf16 v[192:195], a[4:7], a[84:87], v[192:195]
    v_exp_f32 v146, v146
    v_mfma_f32_16x16x32_bf16 v[196:199], a[4:7], a[88:91], v[196:199]
    ds_read_b64_tr_b16 a[16:17], v233 offset:32768
    v_add_u32 v243, s86, v243
    v_mfma_f32_16x16x32_bf16 v[200:203], a[4:7], a[92:95], v[200:203]
    s_waitcnt lgkmcnt(3)
    ds_read_b64_tr_b16 a[18:19], v233 offset:34816
    v_mfma_f32_16x16x32_bf16 v[188:191], a[8:11], a[96:99], v[188:191]
    buffer_load_dwordx4 v213, s[48:51], s82 offen offset:1024 lds
    v_mfma_f32_16x16x32_bf16 v[192:195], a[8:11], a[100:103], v[192:195]
    v_exp_f32 v147, v147
    v_mfma_f32_16x16x32_bf16 v[196:199], a[8:11], a[104:107], v[196:199]
    v_exp_f32 v148, v148
    v_mfma_f32_16x16x32_bf16 v[200:203], a[8:11], a[108:111], v[200:203]
    s_waitcnt lgkmcnt(2)
    ds_read_b64_tr_b16 a[20:21], v233 offset:36864
    ds_read_b64_tr_b16 a[22:23], v233 offset:38912
    v_mfma_f32_16x16x32_bf16 v[188:191], a[12:15], a[112:115], v[188:191]
    v_exp_f32 v149, v149
    v_mfma_f32_16x16x32_bf16 v[192:195], a[12:15], a[116:119], v[192:195]
    buffer_load_dwordx4 v214, s[48:51], s82 offen offset:2048 lds
    v_mfma_f32_16x16x32_bf16 v[196:199], a[12:15], a[32:35], v[196:199]
    s_waitcnt vmcnt(16)
    s_barrier
    v_exp_f32 v150, v150
    v_mfma_f32_16x16x32_bf16 v[200:203], a[12:15], a[36:39], v[200:203]
    s_waitcnt lgkmcnt(2)
    ds_read_b64_tr_b16 a[24:25], v233 offset:40960
    ds_read_b64_tr_b16 a[26:27], v233 offset:43008
    v_mfma_f32_16x16x32_bf16 v[188:191], a[16:19], a[40:43], v[188:191]
    v_exp_f32 v151, v151
    v_mfma_f32_16x16x32_bf16 v[192:195], a[16:19], a[44:47], v[192:195]
    v_exp_f32 v152, v152
    v_mfma_f32_16x16x32_bf16 v[196:199], a[16:19], a[48:51], v[196:199]
    buffer_load_dwordx4 v215, s[48:51], s82 offen offset:3072 lds
    v_mfma_f32_16x16x32_bf16 v[200:203], a[16:19], a[52:55], v[200:203]
    s_waitcnt lgkmcnt(2)
    ds_read_b128 a[28:31], v239 offset:49152
    v_mfma_f32_16x16x32_bf16 v[188:191], a[20:23], a[56:59], v[188:191]
    s_add_u32 m0, s81, 147456
    v_exp_f32 v153, v153
    v_mfma_f32_16x16x32_bf16 v[192:195], a[20:23], a[60:63], v[192:195]
    s_mov_b32 s82, 65536
    ds_read_b128 a[0:3], v239 offset:51200
    v_mfma_f32_16x16x32_bf16 v[196:199], a[20:23], a[184:187], v[196:199]
    ds_read_b128 a[4:7], v241 offset:49152
    v_mfma_f32_16x16x32_bf16 v[200:203], a[20:23], a[188:191], v[200:203]
    s_waitcnt lgkmcnt(3)
    buffer_load_dwordx4 v216, s[52:55], s82 offen offset:0 lds
    v_mfma_f32_16x16x32_bf16 v[188:191], a[24:27], a[192:195], v[188:191]
    v_exp_f32 v154, v154
    v_mfma_f32_16x16x32_bf16 v[192:195], a[24:27], a[196:199], v[192:195]
    ds_read_b128 a[8:11], v241 offset:51200
    v_mfma_f32_16x16x32_bf16 v[196:199], a[24:27], a[200:203], v[196:199]
    s_add_u32 s68, s32, 33554432
    s_addc_u32 s69, s33, 0
    v_exp_f32 v155, v155
    v_mfma_f32_16x16x32_bf16 v[200:203], a[24:27], a[204:207], v[200:203]
    s_waitcnt lgkmcnt(2)
    ds_read_b128 a[12:15], v239 offset:53248
    v_mfma_f32_16x16x32_bf16 v[128:131], a[28:31], a[120:123], v[176:179]
    s_mov_b32 s70, 4096
    buffer_load_dwordx4 v217, s[52:55], s82 offen offset:1024 lds
    v_mfma_f32_16x16x32_bf16 v[132:135], a[28:31], a[124:127], v[180:183]
    s_mov_b32 s71, 0x20000
    ds_read_b128 a[16:19], v239 offset:55296
    v_mfma_f32_16x16x32_bf16 v[136:139], a[0:3], a[120:123], v[176:179]
    s_lshl_b32 s86, s80, 7
    v_exp_f32 v156, v156
    v_mfma_f32_16x16x32_bf16 v[140:143], a[0:3], a[124:127], v[180:183]
    s_waitcnt lgkmcnt(2)
    ds_read_b128 a[20:23], v241 offset:53248
    v_lshrrev_b32 v242, 3, v251
    v_mfma_f32_16x16x32_bf16 v[128:131], a[4:7], a[128:131], v[128:131]
    ds_read_b128 a[24:27], v241 offset:55296
    v_lshlrev_b32 v242, 12, v242
    v_mfma_f32_16x16x32_bf16 v[132:135], a[4:7], a[132:135], v[132:135]
    buffer_load_dwordx4 v218, s[52:55], s82 offen offset:2048 lds
    v_mfma_f32_16x16x32_bf16 v[136:139], a[8:11], a[128:131], v[136:139]
    v_exp_f32 v157, v157
    v_mfma_f32_16x16x32_bf16 v[140:143], a[8:11], a[132:135], v[140:143]
    s_waitcnt lgkmcnt(2)
    ds_read_b128 a[28:31], v239 offset:57344
    v_lshl_add_u32 v242, v251, 3, v242
    v_mfma_f32_16x16x32_bf16 v[128:131], a[12:15], a[136:139], v[128:131]
    v_exp_f32 v158, v158
    v_mfma_f32_16x16x32_bf16 v[132:135], a[12:15], a[140:143], v[132:135]
    ds_read_b128 a[0:3], v239 offset:59392
    v_add_u32 v242, s86, v242
    v_mfma_f32_16x16x32_bf16 v[136:139], a[16:19], a[136:139], v[136:139]
    s_lshl_b32 s87, s79, 3
    s_add_u32 s86, s86, s87
    buffer_load_dwordx4 v219, s[52:55], s82 offen offset:3072 lds
    v_mfma_f32_16x16x32_bf16 v[140:143], a[16:19], a[140:143], v[140:143]
    s_waitcnt lgkmcnt(2)
    ds_read_b128 a[4:7], v241 offset:57344
    v_cvt_pk_bf16_f32 v188, v188, v189
    v_mfma_f32_16x16x32_bf16 v[128:131], a[20:23], a[144:147], v[128:131]
    s_add_u32 s86, s86, s81
    v_exp_f32 v159, v159
    v_mfma_f32_16x16x32_bf16 v[132:135], a[20:23], a[148:151], v[132:135]
    s_add_u32 m0, s81, 49152
    ds_read_b128 a[8:11], v241 offset:59392
    v_lshl_add_u32 v244, v251, 12, s86
    v_mfma_f32_16x16x32_bf16 v[136:139], a[24:27], a[144:147], v[136:139]
    s_mov_b32 s82, 256
    ds_read_b128 a[12:15], v239 offset:61440
    v_cvt_pk_bf16_f32 v160, v144, v145
    v_mfma_f32_16x16x32_bf16 v[140:143], a[24:27], a[148:151], v[140:143]
    s_waitcnt lgkmcnt(3)
    buffer_load_dwordx4 v220, s[60:63], s82 offen offset:0 lds
    v_mfma_f32_16x16x32_bf16 v[128:131], a[28:31], a[152:155], v[128:131]
    v_cvt_pk_bf16_f32 v161, v146, v147
    v_cvt_pk_bf16_f32 v162, v152, v153
    v_mfma_f32_16x16x32_bf16 v[132:135], a[28:31], a[156:159], v[132:135]
    ds_read_b128 a[16:19], v239 offset:63488
    v_cvt_pk_bf16_f32 v163, v154, v155
    v_mfma_f32_16x16x32_bf16 v[136:139], a[0:3], a[152:155], v[136:139]
    v_cvt_pk_bf16_f32 v164, v148, v149
    v_cvt_pk_bf16_f32 v165, v150, v151
    v_mfma_f32_16x16x32_bf16 v[140:143], a[0:3], a[156:159], v[140:143]
    s_waitcnt lgkmcnt(2)
    ds_read_b128 a[20:23], v241 offset:61440
    v_cvt_pk_bf16_f32 v166, v156, v157
    v_mfma_f32_16x16x32_bf16 v[128:131], a[4:7], a[160:163], v[128:131]
    s_waitcnt vmcnt(10)
    s_barrier
    buffer_load_dwordx4 v221, s[60:63], s82 offen offset:1024 lds
    v_mfma_f32_16x16x32_bf16 v[132:135], a[4:7], a[164:167], v[132:135]
    ds_read_b128 a[24:27], v241 offset:63488
    v_cvt_pk_bf16_f32 v167, v158, v159
    v_mfma_f32_16x16x32_bf16 v[136:139], a[8:11], a[160:163], v[136:139]
    v_cvt_pk_bf16_f32 v189, v190, v191
    v_cvt_pk_bf16_f32 v190, v192, v193
    v_mfma_f32_16x16x32_bf16 v[140:143], a[8:11], a[164:167], v[140:143]
    s_waitcnt lgkmcnt(2)
    ds_read_b64_tr_b16 a[28:29], v224 offset:0
    v_cvt_pk_bf16_f32 v191, v194, v195
    v_mfma_f32_16x16x32_bf16 v[128:131], a[12:15], a[168:171], v[128:131]
    ds_read_b64_tr_b16 a[30:31], v224 offset:2048
    v_cvt_pk_bf16_f32 v192, v196, v197
    v_mfma_f32_16x16x32_bf16 v[132:135], a[12:15], a[172:175], v[132:135]
    buffer_load_dwordx4 v222, s[60:63], s82 offen offset:2048 lds
    v_mfma_f32_16x16x32_bf16 v[136:139], a[16:19], a[168:171], v[136:139]
    ds_read_b64_tr_b16 a[0:1], v226 offset:0
    v_cvt_pk_bf16_f32 v193, v198, v199
    v_mfma_f32_16x16x32_bf16 v[140:143], a[16:19], a[172:175], v[140:143]
    s_waitcnt lgkmcnt(3)
    ds_read_b64_tr_b16 a[2:3], v226 offset:2048
    v_cvt_pk_bf16_f32 v194, v200, v201
    v_mfma_f32_16x16x32_bf16 v[128:131], a[20:23], a[176:179], v[128:131]
    ds_read_b64_tr_b16 a[4:5], v228 offset:0
    v_cvt_pk_bf16_f32 v195, v202, v203
    v_mfma_f32_16x16x32_bf16 v[132:135], a[20:23], a[180:183], v[132:135]
    s_mov_b32 s83, 14680064
    ds_read_b64_tr_b16 a[6:7], v228 offset:2048
    v_mfma_f32_16x16x32_bf16 v[136:139], a[24:27], a[176:179], v[136:139]
    buffer_load_dwordx4 v223, s[60:63], s82 offen offset:3072 lds
    v_mfma_f32_16x16x32_bf16 v[140:143], a[24:27], a[180:183], v[140:143]
    s_add_u32 m0, s81, 65536
    ds_read_b64_tr_b16 a[8:9], v230 offset:0
    ds_read_b64_tr_b16 a[10:11], v230 offset:2048
    v_mfma_f32_16x16x32_bf16 v[168:171], v[184:187], v[160:163], v[168:171]
    buffer_store_dwordx4 v[188:191], v211, s[64:67], s83 offen offset:0 sc1
    v_mfma_f32_16x16x32_bf16 v[172:175], v[184:187], v[164:167], v[172:175]
    s_waitcnt lgkmcnt(4)
    ds_read_b64_tr_b16 a[12:13], v224 offset:4096
    ds_read_b64_tr_b16 a[14:15], v224 offset:6144
    v_mfma_f32_16x16x32_bf16 v[0:3], a[28:31], v[160:163], v[0:3]
    s_mov_b32 s82, 114944
    ds_read_b64_tr_b16 a[16:17], v226 offset:4096
    ds_read_b64_tr_b16 a[18:19], v226 offset:6144
    v_mfma_f32_16x16x32_bf16 v[4:7], a[28:31], v[164:167], v[4:7]
    buffer_load_dwordx4 v220, s[60:63], s82 offen offset:0 lds
    v_mfma_f32_16x16x32_bf16 v[8:11], a[0:3], v[160:163], v[8:11]
    ds_read_b64_tr_b16 a[20:21], v228 offset:4096
    v_mfma_f32_16x16x32_bf16 v[12:15], a[0:3], v[164:167], v[12:15]
    s_waitcnt lgkmcnt(5)
    ds_read_b64_tr_b16 a[22:23], v228 offset:6144
    v_mfma_f32_16x16x32_bf16 v[16:19], a[4:7], v[160:163], v[16:19]
    buffer_store_dwordx4 v[192:195], v211, s[64:67], s83 offen offset:1024 sc1
    v_mfma_f32_16x16x32_bf16 v[20:23], a[4:7], v[164:167], v[20:23]
    ds_read_b64_tr_b16 a[24:25], v230 offset:4096
    ds_read_b64_tr_b16 a[26:27], v230 offset:6144
    v_mfma_f32_16x16x32_bf16 v[24:27], a[8:11], v[160:163], v[24:27]
    buffer_load_dwordx4 v221, s[60:63], s82 offen offset:1024 lds
    v_mfma_f32_16x16x32_bf16 v[28:31], a[8:11], v[164:167], v[28:31]
    s_waitcnt lgkmcnt(4)
    ds_read_b64_tr_b16 a[28:29], v224 offset:8192
    ds_read_b64_tr_b16 a[30:31], v224 offset:10240
    v_mfma_f32_16x16x32_bf16 v[32:35], a[12:15], v[160:163], v[32:35]
    ds_read_b64_tr_b16 a[0:1], v226 offset:8192
    v_mfma_f32_16x16x32_bf16 v[36:39], a[12:15], v[164:167], v[36:39]
    ds_read_b64_tr_b16 a[2:3], v226 offset:10240
    v_mfma_f32_16x16x32_bf16 v[40:43], a[16:19], v[160:163], v[40:43]
    ds_read_b64_tr_b16 a[4:5], v228 offset:8192
    ds_read_b64_tr_b16 a[6:7], v228 offset:10240
    v_mfma_f32_16x16x32_bf16 v[44:47], a[16:19], v[164:167], v[44:47]
    s_waitcnt lgkmcnt(6)
    buffer_load_dwordx4 v222, s[60:63], s82 offen offset:2048 lds
    v_mfma_f32_16x16x32_bf16 v[48:51], a[20:23], v[160:163], v[48:51]
    ds_read_b64_tr_b16 a[8:9], v230 offset:8192
    v_mfma_f32_16x16x32_bf16 v[52:55], a[20:23], v[164:167], v[52:55]
    ds_read_b64_tr_b16 a[10:11], v230 offset:10240
    v_mfma_f32_16x16x32_bf16 v[56:59], a[24:27], v[160:163], v[56:59]
    ds_read_b64_tr_b16 a[12:13], v224 offset:12288
    v_mfma_f32_16x16x32_bf16 v[60:63], a[24:27], v[164:167], v[60:63]
    s_waitcnt lgkmcnt(5)
    ds_read_b64_tr_b16 a[14:15], v224 offset:14336
    v_mfma_f32_16x16x32_bf16 v[64:67], a[28:31], v[160:163], v[64:67]
    buffer_load_dwordx4 v223, s[60:63], s82 offen offset:3072 lds
    v_mfma_f32_16x16x32_bf16 v[68:71], a[28:31], v[164:167], v[68:71]
    s_add_u32 m0, s81, 81920
    ds_read_b64_tr_b16 a[16:17], v226 offset:12288
    ds_read_b64_tr_b16 a[18:19], v226 offset:14336
    v_mfma_f32_16x16x32_bf16 v[72:75], a[0:3], v[160:163], v[72:75]
    s_mov_b32 s82, 98304
    ds_read_b64_tr_b16 a[20:21], v228 offset:12288
    v_mfma_f32_16x16x32_bf16 v[76:79], a[0:3], v[164:167], v[76:79]
    s_waitcnt lgkmcnt(5)
    ds_read_b64_tr_b16 a[22:23], v228 offset:14336
    v_mfma_f32_16x16x32_bf16 v[80:83], a[4:7], v[160:163], v[80:83]
    ds_read_b64_tr_b16 a[24:25], v230 offset:12288
    ds_read_b64_tr_b16 a[26:27], v230 offset:14336
    v_mfma_f32_16x16x32_bf16 v[84:87], a[4:7], v[164:167], v[84:87]
    buffer_load_dwordx4 v212, s[48:51], s82 offen offset:0 lds
    v_mfma_f32_16x16x32_bf16 v[88:91], a[8:11], v[160:163], v[88:91]
    ds_read_b64_tr_b16 a[28:29], v232 offset:16384
    v_mfma_f32_16x16x32_bf16 v[92:95], a[8:11], v[164:167], v[92:95]
    s_waitcnt lgkmcnt(5)
    ds_read_b64_tr_b16 a[30:31], v232 offset:18432
    v_mfma_f32_16x16x32_bf16 v[96:99], a[12:15], v[160:163], v[96:99]
    ds_read_b64_tr_b16 a[0:1], v232 offset:20480
    v_mfma_f32_16x16x32_bf16 v[100:103], a[12:15], v[164:167], v[100:103]
    buffer_load_dwordx4 v213, s[48:51], s82 offen offset:1024 lds
    v_mfma_f32_16x16x32_bf16 v[104:107], a[16:19], v[160:163], v[104:107]
    ds_read_b64_tr_b16 a[2:3], v232 offset:22528
    v_mfma_f32_16x16x32_bf16 v[108:111], a[16:19], v[164:167], v[108:111]
    s_waitcnt lgkmcnt(4)
    ds_read_b64_tr_b16 a[4:5], v232 offset:24576
    v_mfma_f32_16x16x32_bf16 v[112:115], a[20:23], v[160:163], v[112:115]
    ds_read_b64_tr_b16 a[6:7], v232 offset:26624
    v_mfma_f32_16x16x32_bf16 v[116:119], a[20:23], v[164:167], v[116:119]
    v_exp_f32 v128, v128
    v_mfma_f32_16x16x32_bf16 v[120:123], a[24:27], v[160:163], v[120:123]
    buffer_load_dwordx4 v214, s[48:51], s82 offen offset:2048 lds
    v_mfma_f32_16x16x32_bf16 v[124:127], a[24:27], v[164:167], v[124:127]
    s_waitcnt lgkmcnt(4)
    ds_read_b64_tr_b16 a[8:9], v232 offset:28672
    v_mfma_f32_16x16x32_bf16 v[188:191], a[28:31], a[64:67], 0
    ds_read_b64_tr_b16 a[10:11], v232 offset:30720
    v_mfma_f32_16x16x32_bf16 v[192:195], a[28:31], a[68:71], 0
    v_exp_f32 v129, v129
    v_mfma_f32_16x16x32_bf16 v[196:199], a[28:31], a[72:75], 0
    ds_read_b64_tr_b16 a[12:13], v232 offset:32768
    v_mfma_f32_16x16x32_bf16 v[200:203], a[28:31], a[76:79], 0
    s_waitcnt lgkmcnt(5)
    ds_read_b64_tr_b16 a[14:15], v232 offset:34816
    v_mfma_f32_16x16x32_bf16 v[188:191], a[0:3], a[80:83], v[188:191]
    buffer_load_dwordx4 v215, s[48:51], s82 offen offset:3072 lds
    v_mfma_f32_16x16x32_bf16 v[192:195], a[0:3], a[84:87], v[192:195]
    s_add_u32 m0, s81, 98304
    v_exp_f32 v130, v130
    v_mfma_f32_16x16x32_bf16 v[196:199], a[0:3], a[88:91], v[196:199]
    s_mov_b32 s82, 81920
    v_exp_f32 v131, v131
    v_mfma_f32_16x16x32_bf16 v[200:203], a[0:3], a[92:95], v[200:203]
    s_waitcnt lgkmcnt(4)
    ds_read_b64_tr_b16 a[16:17], v232 offset:36864
    v_mfma_f32_16x16x32_bf16 v[188:191], a[4:7], a[96:99], v[188:191]
    buffer_load_dwordx4 v216, s[52:55], s82 offen offset:0 lds
    v_mfma_f32_16x16x32_bf16 v[192:195], a[4:7], a[100:103], v[192:195]
    ds_read_b64_tr_b16 a[18:19], v232 offset:38912
    v_mfma_f32_16x16x32_bf16 v[196:199], a[4:7], a[104:107], v[196:199]
    v_exp_f32 v132, v132
    v_mfma_f32_16x16x32_bf16 v[200:203], a[4:7], a[108:111], v[200:203]
    s_waitcnt lgkmcnt(4)
    v_exp_f32 v133, v133
    v_mfma_f32_16x16x32_bf16 v[188:191], a[8:11], a[112:115], v[188:191]
    ds_read_b64_tr_b16 a[20:21], v232 offset:40960
    v_mfma_f32_16x16x32_bf16 v[192:195], a[8:11], a[116:119], v[192:195]
    buffer_load_dwordx4 v217, s[52:55], s82 offen offset:1024 lds
    v_mfma_f32_16x16x32_bf16 v[196:199], a[8:11], a[32:35], v[196:199]
    s_waitcnt vmcnt(20)
    s_barrier
    v_mfma_f32_16x16x32_bf16 v[200:203], a[8:11], a[36:39], v[200:203]
    s_waitcnt lgkmcnt(3)
    ds_read_b64_tr_b16 a[22:23], v232 offset:43008
    v_mfma_f32_16x16x32_bf16 v[188:191], a[12:15], a[40:43], v[188:191]
    v_exp_f32 v134, v134
    v_mfma_f32_16x16x32_bf16 v[192:195], a[12:15], a[44:47], v[192:195]
    v_exp_f32 v135, v135
    v_mfma_f32_16x16x32_bf16 v[196:199], a[12:15], a[48:51], v[196:199]
    ds_read_b128 a[24:27], v235 offset:0
    v_mfma_f32_16x16x32_bf16 v[200:203], a[12:15], a[52:55], v[200:203]
    s_waitcnt lgkmcnt(3)
    buffer_load_dwordx4 v218, s[52:55], s82 offen offset:2048 lds
    v_mfma_f32_16x16x32_bf16 v[188:191], a[16:19], a[56:59], v[188:191]
    v_exp_f32 v136, v136
    v_mfma_f32_16x16x32_bf16 v[192:195], a[16:19], a[60:63], v[192:195]
    ds_read_b128 a[28:31], v235 offset:2048
    v_mfma_f32_16x16x32_bf16 v[196:199], a[16:19], a[184:187], v[196:199]
    v_exp_f32 v137, v137
    v_mfma_f32_16x16x32_bf16 v[200:203], a[16:19], a[188:191], v[200:203]
    s_waitcnt lgkmcnt(2)
    ds_read_b128 a[0:3], v237 offset:0
    v_mfma_f32_16x16x32_bf16 v[188:191], a[20:23], a[192:195], v[188:191]
    buffer_load_dwordx4 v219, s[52:55], s82 offen offset:3072 lds
    v_mfma_f32_16x16x32_bf16 v[192:195], a[20:23], a[196:199], v[192:195]
    s_add_u32 m0, s81, 0
    ds_read_b128 a[4:7], v237 offset:2048
    v_mfma_f32_16x16x32_bf16 v[196:199], a[20:23], a[200:203], v[196:199]
    s_mov_b32 s82, 384
    v_exp_f32 v138, v138
    v_mfma_f32_16x16x32_bf16 v[200:203], a[20:23], a[204:207], v[200:203]
    s_waitcnt lgkmcnt(2)
    ds_read_b128 a[8:11], v235 offset:4096
    v_mfma_f32_16x16x32_bf16 v[144:147], a[24:27], a[120:123], v[176:179]
    s_mov_b32 s40, s32
    ds_read_b128 a[12:15], v235 offset:6144
    v_mfma_f32_16x16x32_bf16 v[148:151], a[24:27], a[124:127], v[180:183]
    buffer_load_dwordx4 v220, s[60:63], s82 offen offset:0 lds
    v_mfma_f32_16x16x32_bf16 v[152:155], a[28:31], a[120:123], v[176:179]
    s_mov_b32 s41, s33
    v_exp_f32 v139, v139
    v_mfma_f32_16x16x32_bf16 v[156:159], a[28:31], a[124:127], v[180:183]
    s_waitcnt lgkmcnt(2)
    ds_read_b128 a[16:19], v237 offset:4096
    v_cvt_pk_bf16_f32 v188, v188, v189
    v_mfma_f32_16x16x32_bf16 v[144:147], a[0:3], a[128:131], v[144:147]
    s_mov_b32 s42, 29360128
    v_exp_f32 v140, v140
    v_mfma_f32_16x16x32_bf16 v[148:151], a[0:3], a[132:135], v[148:151]
    s_mov_b32 s43, 0x20000
    ds_read_b128 a[20:23], v237 offset:6144
    v_cvt_pk_bf16_f32 v189, v190, v191
    v_mfma_f32_16x16x32_bf16 v[152:155], a[4:7], a[128:131], v[152:155]
    buffer_load_dwordx4 v221, s[60:63], s82 offen offset:1024 lds
    v_mfma_f32_16x16x32_bf16 v[156:159], a[4:7], a[132:135], v[156:159]
    s_waitcnt lgkmcnt(2)
    ds_read_b128 a[24:27], v235 offset:8192
    v_cvt_pk_bf16_f32 v190, v192, v193
    v_mfma_f32_16x16x32_bf16 v[144:147], a[8:11], a[136:139], v[144:147]
    s_mov_b32 s44, s8
    v_exp_f32 v141, v141
    v_mfma_f32_16x16x32_bf16 v[148:151], a[8:11], a[140:143], v[148:151]
    s_mov_b32 s45, s9
    ds_read_b128 a[28:31], v235 offset:10240
    v_cvt_pk_bf16_f32 v191, v194, v195
    v_mfma_f32_16x16x32_bf16 v[152:155], a[12:15], a[136:139], v[152:155]
    s_mov_b32 s46, 1835008
    ds_read_b128 a[0:3], v237 offset:8192
    v_cvt_pk_bf16_f32 v192, v196, v197
    v_mfma_f32_16x16x32_bf16 v[156:159], a[12:15], a[140:143], v[156:159]
    s_waitcnt lgkmcnt(3)
    buffer_load_dwordx4 v222, s[60:63], s82 offen offset:2048 lds
    v_mfma_f32_16x16x32_bf16 v[144:147], a[16:19], a[144:147], v[144:147]
    s_mov_b32 s47, 0x20000
    v_exp_f32 v142, v142
    v_mfma_f32_16x16x32_bf16 v[148:151], a[16:19], a[148:151], v[148:151]
    ds_read_b128 a[4:7], v237 offset:10240
    v_cvt_pk_bf16_f32 v193, v198, v199
    v_mfma_f32_16x16x32_bf16 v[152:155], a[20:23], a[144:147], v[152:155]
    v_exp_f32 v143, v143
    v_mfma_f32_16x16x32_bf16 v[156:159], a[20:23], a[148:151], v[156:159]
    s_waitcnt lgkmcnt(2)
    ds_read_b128 a[8:11], v235 offset:12288
    v_cvt_pk_bf16_f32 v160, v128, v129
    v_mfma_f32_16x16x32_bf16 v[144:147], a[24:27], a[152:155], v[144:147]
    buffer_load_dwordx4 v223, s[60:63], s82 offen offset:3072 lds
    v_mfma_f32_16x16x32_bf16 v[148:151], a[24:27], a[156:159], v[148:151]
    s_add_u32 m0, s81, 16384
    ds_read_b128 a[12:15], v235 offset:14336
    v_cvt_pk_bf16_f32 v161, v130, v131
    v_mfma_f32_16x16x32_bf16 v[152:155], a[28:31], a[152:155], v[152:155]
    s_mov_b32 s82, 115072
    v_cvt_pk_bf16_f32 v162, v136, v137
    v_cvt_pk_bf16_f32 v163, v138, v139
    v_mfma_f32_16x16x32_bf16 v[156:159], a[28:31], a[156:159], v[156:159]
    s_waitcnt lgkmcnt(2)
    ds_read_b128 a[16:19], v237 offset:12288
    v_cvt_pk_bf16_f32 v164, v132, v133
    v_mfma_f32_16x16x32_bf16 v[144:147], a[0:3], a[160:163], v[144:147]
    s_waitcnt vmcnt(12)
    s_barrier
    ds_read_b128 a[20:23], v237 offset:14336
    v_cvt_pk_bf16_f32 v165, v134, v135
    v_mfma_f32_16x16x32_bf16 v[148:151], a[0:3], a[164:167], v[148:151]
    buffer_load_dwordx4 v220, s[60:63], s82 offen offset:0 lds
    v_mfma_f32_16x16x32_bf16 v[152:155], a[4:7], a[160:163], v[152:155]
    v_cvt_pk_bf16_f32 v166, v140, v141
    v_cvt_pk_bf16_f32 v167, v142, v143
    v_mfma_f32_16x16x32_bf16 v[156:159], a[4:7], a[164:167], v[156:159]
    s_waitcnt lgkmcnt(2)
    ds_read_b64_tr_b16 a[24:25], v204 offset:16384
    v_cvt_pk_bf16_f32 v194, v200, v201
    v_mfma_f32_16x16x32_bf16 v[144:147], a[8:11], a[168:171], v[144:147]
    ds_read_b64_tr_b16 a[26:27], v204 offset:18432
    v_cvt_pk_bf16_f32 v195, v202, v203
    v_mfma_f32_16x16x32_bf16 v[148:151], a[8:11], a[172:175], v[148:151]
    buffer_load_dwordx4 v221, s[60:63], s82 offen offset:1024 lds
    v_mfma_f32_16x16x32_bf16 v[152:155], a[12:15], a[168:171], v[152:155]
    s_mov_b32 s83, 14682112
    ds_read_b64_tr_b16 a[28:29], v205 offset:16384
    v_mfma_f32_16x16x32_bf16 v[156:159], a[12:15], a[172:175], v[156:159]
    s_waitcnt lgkmcnt(3)
    ds_read_b64_tr_b16 a[30:31], v205 offset:18432
    v_mfma_f32_16x16x32_bf16 v[144:147], a[16:19], a[176:179], v[144:147]
    ds_read_b64_tr_b16 a[0:1], v254 offset:16384
    v_mfma_f32_16x16x32_bf16 v[148:151], a[16:19], a[180:183], v[148:151]
    ds_read_b64_tr_b16 a[2:3], v254 offset:18432
    v_mfma_f32_16x16x32_bf16 v[152:155], a[20:23], a[176:179], v[152:155]
    ds_read_b64_tr_b16 a[4:5], v236 offset:16384
    ds_read_b64_tr_b16 a[6:7], v236 offset:18432
    v_mfma_f32_16x16x32_bf16 v[156:159], a[20:23], a[180:183], v[156:159]
    buffer_load_dwordx4 v222, s[60:63], s82 offen offset:2048 lds
    v_mfma_f32_16x16x32_bf16 v[168:171], v[184:187], v[160:163], v[168:171]
    ds_read_b64_tr_b16 a[8:9], v204 offset:20480
    v_mfma_f32_16x16x32_bf16 v[172:175], v[184:187], v[164:167], v[172:175]
    s_waitcnt lgkmcnt(5)
    ds_read_b64_tr_b16 a[10:11], v204 offset:22528
    v_mfma_f32_16x16x32_bf16 v[0:3], a[24:27], v[160:163], v[0:3]
    buffer_store_dwordx4 v[188:191], v211, s[64:67], s83 offen offset:0 sc1
    v_mfma_f32_16x16x32_bf16 v[4:7], a[24:27], v[164:167], v[4:7]
    ds_read_b64_tr_b16 a[12:13], v205 offset:20480
    ds_read_b64_tr_b16 a[14:15], v205 offset:22528
    v_mfma_f32_16x16x32_bf16 v[8:11], a[28:31], v[160:163], v[8:11]
    buffer_load_dwordx4 v223, s[60:63], s82 offen offset:3072 lds
    v_mfma_f32_16x16x32_bf16 v[12:15], a[28:31], v[164:167], v[12:15]
    s_waitcnt lgkmcnt(4)
    ds_read_b64_tr_b16 a[16:17], v254 offset:20480
    ds_read_b64_tr_b16 a[18:19], v254 offset:22528
    v_mfma_f32_16x16x32_bf16 v[16:19], a[0:3], v[160:163], v[16:19]
    buffer_store_dwordx4 v[192:195], v211, s[64:67], s83 offen offset:1024 sc1
    v_mfma_f32_16x16x32_bf16 v[20:23], a[0:3], v[164:167], v[20:23]
    s_add_u32 m0, s81, 114688
    ds_read_b64_tr_b16 a[20:21], v236 offset:20480
    ds_read_b64_tr_b16 a[22:23], v236 offset:22528
    v_mfma_f32_16x16x32_bf16 v[24:27], a[4:7], v[160:163], v[24:27]
    s_mov_b32 s82, 114688
    ds_read_b64_tr_b16 a[24:25], v204 offset:24576
    ds_read_b64_tr_b16 a[26:27], v204 offset:26624
    v_mfma_f32_16x16x32_bf16 v[28:31], a[4:7], v[164:167], v[28:31]
    s_waitcnt lgkmcnt(6)
    buffer_load_dwordx4 v212, s[48:51], s82 offen offset:0 lds
    v_mfma_f32_16x16x32_bf16 v[32:35], a[8:11], v[160:163], v[32:35]
    ds_read_b64_tr_b16 a[28:29], v205 offset:24576
    v_mfma_f32_16x16x32_bf16 v[36:39], a[8:11], v[164:167], v[36:39]
    ds_read_b64_tr_b16 a[30:31], v205 offset:26624
    v_mfma_f32_16x16x32_bf16 v[40:43], a[12:15], v[160:163], v[40:43]
    ds_read_b64_tr_b16 a[0:1], v254 offset:24576
    v_mfma_f32_16x16x32_bf16 v[44:47], a[12:15], v[164:167], v[44:47]
    s_waitcnt lgkmcnt(5)
    ds_read_b64_tr_b16 a[2:3], v254 offset:26624
    v_mfma_f32_16x16x32_bf16 v[48:51], a[16:19], v[160:163], v[48:51]
    buffer_load_dwordx4 v213, s[48:51], s82 offen offset:1024 lds
    v_mfma_f32_16x16x32_bf16 v[52:55], a[16:19], v[164:167], v[52:55]
    ds_read_b64_tr_b16 a[4:5], v236 offset:24576
    ds_read_b64_tr_b16 a[6:7], v236 offset:26624
    v_mfma_f32_16x16x32_bf16 v[56:59], a[20:23], v[160:163], v[56:59]
    ds_read_b64_tr_b16 a[8:9], v204 offset:28672
    v_mfma_f32_16x16x32_bf16 v[60:63], a[20:23], v[164:167], v[60:63]
    s_waitcnt lgkmcnt(5)
    ds_read_b64_tr_b16 a[10:11], v204 offset:30720
    v_mfma_f32_16x16x32_bf16 v[64:67], a[24:27], v[160:163], v[64:67]
    ds_read_b64_tr_b16 a[12:13], v205 offset:28672
    ds_read_b64_tr_b16 a[14:15], v205 offset:30720
    v_mfma_f32_16x16x32_bf16 v[68:71], a[24:27], v[164:167], v[68:71]
    buffer_load_dwordx4 v214, s[48:51], s82 offen offset:2048 lds
    v_mfma_f32_16x16x32_bf16 v[72:75], a[28:31], v[160:163], v[72:75]
    ds_read_b64_tr_b16 a[16:17], v254 offset:28672
    v_mfma_f32_16x16x32_bf16 v[76:79], a[28:31], v[164:167], v[76:79]
    s_waitcnt lgkmcnt(5)
    ds_read_b64_tr_b16 a[18:19], v254 offset:30720
    v_mfma_f32_16x16x32_bf16 v[80:83], a[0:3], v[160:163], v[80:83]
    ds_read_b64_tr_b16 a[20:21], v236 offset:28672
    v_mfma_f32_16x16x32_bf16 v[84:87], a[0:3], v[164:167], v[84:87]
    ds_read_b64_tr_b16 a[22:23], v236 offset:30720
    v_mfma_f32_16x16x32_bf16 v[88:91], a[4:7], v[160:163], v[88:91]
    buffer_load_dwordx4 v215, s[48:51], s82 offen offset:3072 lds
    v_mfma_f32_16x16x32_bf16 v[92:95], a[4:7], v[164:167], v[92:95]
    s_waitcnt lgkmcnt(4)
    ds_read_b64_tr_b16 a[24:25], v232 offset:49152
    ds_read_b64_tr_b16 a[26:27], v232 offset:51200
    v_mfma_f32_16x16x32_bf16 v[96:99], a[8:11], v[160:163], v[96:99]
    s_add_u32 m0, s81, 32768
    s_mov_b32 s82, 98304
    v_mfma_f32_16x16x32_bf16 v[100:103], a[8:11], v[164:167], v[100:103]
    ds_read_b64_tr_b16 a[28:29], v232 offset:53248
    v_mfma_f32_16x16x32_bf16 v[104:107], a[12:15], v[160:163], v[104:107]
    ds_read_b64_tr_b16 a[30:31], v232 offset:55296
    v_mfma_f32_16x16x32_bf16 v[108:111], a[12:15], v[164:167], v[108:111]
    s_waitcnt lgkmcnt(4)
    buffer_load_dwordx4 v216, s[52:55], s82 offen offset:0 lds
    v_mfma_f32_16x16x32_bf16 v[112:115], a[16:19], v[160:163], v[112:115]
    ds_read_b64_tr_b16 a[0:1], v232 offset:57344
    v_mfma_f32_16x16x32_bf16 v[116:119], a[16:19], v[164:167], v[116:119]
    ds_read_b64_tr_b16 a[2:3], v232 offset:59392
    v_mfma_f32_16x16x32_bf16 v[120:123], a[20:23], v[160:163], v[120:123]
    v_exp_f32 v144, v144
    v_mfma_f32_16x16x32_bf16 v[124:127], a[20:23], v[164:167], v[124:127]
    s_waitcnt lgkmcnt(4)
    ds_read_b64_tr_b16 a[4:5], v232 offset:61440
    v_mfma_f32_16x16x32_bf16 v[188:191], a[24:27], a[64:67], 0
    buffer_load_dwordx4 v217, s[52:55], s82 offen offset:1024 lds
    v_mfma_f32_16x16x32_bf16 v[192:195], a[24:27], a[68:71], 0
    ds_read_b64_tr_b16 a[6:7], v232 offset:63488
    v_mfma_f32_16x16x32_bf16 v[196:199], a[24:27], a[72:75], 0
    v_exp_f32 v145, v145
    v_mfma_f32_16x16x32_bf16 v[200:203], a[24:27], a[76:79], 0
    s_waitcnt lgkmcnt(4)
    v_exp_f32 v146, v146
    v_mfma_f32_16x16x32_bf16 v[188:191], a[28:31], a[80:83], v[188:191]
    buffer_load_dwordx4 v218, s[52:55], s82 offen offset:2048 lds
    v_mfma_f32_16x16x32_bf16 v[192:195], a[28:31], a[84:87], v[192:195]
    ds_read_b64_tr_b16 a[8:9], v233 offset:0
    v_mfma_f32_16x16x32_bf16 v[196:199], a[28:31], a[88:91], v[196:199]
    ds_read_b64_tr_b16 a[10:11], v233 offset:2048
    v_mfma_f32_16x16x32_bf16 v[200:203], a[28:31], a[92:95], v[200:203]
    s_waitcnt lgkmcnt(4)
    v_exp_f32 v147, v147
    v_mfma_f32_16x16x32_bf16 v[188:191], a[0:3], a[96:99], v[188:191]
    v_exp_f32 v148, v148
    v_mfma_f32_16x16x32_bf16 v[192:195], a[0:3], a[100:103], v[192:195]
    buffer_load_dwordx4 v219, s[52:55], s82 offen offset:3072 lds
    v_mfma_f32_16x16x32_bf16 v[196:199], a[0:3], a[104:107], v[196:199]
    s_add_u32 m0, s81, 49152
    ds_read_b64_tr_b16 a[12:13], v233 offset:4096
    v_mfma_f32_16x16x32_bf16 v[200:203], a[0:3], a[108:111], v[200:203]
    s_waitcnt lgkmcnt(3)
    ds_read_b64_tr_b16 a[14:15], v233 offset:6144
    v_mfma_f32_16x16x32_bf16 v[188:191], a[4:7], a[112:115], v[188:191]
    s_mov_b32 s82, 512
    v_exp_f32 v149, v149
    v_mfma_f32_16x16x32_bf16 v[192:195], a[4:7], a[116:119], v[192:195]
    v_exp_f32 v150, v150
    v_mfma_f32_16x16x32_bf16 v[196:199], a[4:7], a[32:35], v[196:199]
    s_waitcnt vmcnt(22)
    s_barrier
    ds_read_b64_tr_b16 a[16:17], v233 offset:8192
    ds_read_b64_tr_b16 a[18:19], v233 offset:10240
    v_mfma_f32_16x16x32_bf16 v[200:203], a[4:7], a[36:39], v[200:203]
    s_waitcnt lgkmcnt(4)
    buffer_load_dwordx4 v220, s[60:63], s82 offen offset:0 lds
    v_mfma_f32_16x16x32_bf16 v[188:191], a[8:11], a[40:43], v[188:191]
    v_exp_f32 v151, v151
    v_mfma_f32_16x16x32_bf16 v[192:195], a[8:11], a[44:47], v[192:195]
    v_exp_f32 v152, v152
    v_mfma_f32_16x16x32_bf16 v[196:199], a[8:11], a[48:51], v[196:199]
    v_exp_f32 v153, v153
    v_mfma_f32_16x16x32_bf16 v[200:203], a[8:11], a[52:55], v[200:203]
    s_waitcnt lgkmcnt(2)
    ds_read_b128 a[20:23], v239 offset:16384
    v_mfma_f32_16x16x32_bf16 v[188:191], a[12:15], a[56:59], v[188:191]
    buffer_load_dwordx4 v221, s[60:63], s82 offen offset:1024 lds
    v_mfma_f32_16x16x32_bf16 v[192:195], a[12:15], a[60:63], v[192:195]
    ds_read_b128 a[24:27], v239 offset:18432
    v_mfma_f32_16x16x32_bf16 v[196:199], a[12:15], a[184:187], v[196:199]
    v_exp_f32 v154, v154
    v_mfma_f32_16x16x32_bf16 v[200:203], a[12:15], a[188:191], v[200:203]
    s_waitcnt lgkmcnt(2)
    ds_read_b128 a[28:31], v241 offset:16384
    v_mfma_f32_16x16x32_bf16 v[188:191], a[16:19], a[192:195], v[188:191]
    ds_read_b128 a[0:3], v241 offset:18432
    v_mfma_f32_16x16x32_bf16 v[192:195], a[16:19], a[196:199], v[192:195]
    buffer_load_dwordx4 v222, s[60:63], s82 offen offset:2048 lds
    v_mfma_f32_16x16x32_bf16 v[196:199], a[16:19], a[200:203], v[196:199]
    v_exp_f32 v155, v155
    v_mfma_f32_16x16x32_bf16 v[200:203], a[16:19], a[204:207], v[200:203]
    s_waitcnt lgkmcnt(2)
    ds_read_b128 a[4:7], v239 offset:20480
    v_mfma_f32_16x16x32_bf16 v[128:131], a[20:23], a[120:123], v[176:179]
    v_exp_f32 v156, v156
    v_mfma_f32_16x16x32_bf16 v[132:135], a[20:23], a[124:127], v[180:183]
    ds_read_b128 a[8:11], v239 offset:22528
    v_mfma_f32_16x16x32_bf16 v[136:139], a[24:27], a[120:123], v[176:179]
    buffer_load_dwordx4 v223, s[60:63], s82 offen offset:3072 lds
    v_mfma_f32_16x16x32_bf16 v[140:143], a[24:27], a[124:127], v[180:183]
    s_waitcnt lgkmcnt(2)
    ds_read_b128 a[12:15], v241 offset:20480
    v_cvt_pk_bf16_f32 v188, v188, v189
    v_mfma_f32_16x16x32_bf16 v[128:131], a[28:31], a[128:131], v[128:131]
    s_add_u32 m0, s81, 131072
    v_exp_f32 v157, v157
    v_mfma_f32_16x16x32_bf16 v[132:135], a[28:31], a[132:135], v[132:135]
    s_mov_b32 s82, 115200
    ds_read_b128 a[16:19], v241 offset:22528
    v_cvt_pk_bf16_f32 v189, v190, v191
    v_mfma_f32_16x16x32_bf16 v[136:139], a[0:3], a[128:131], v[136:139]
    ds_read_b128 a[20:23], v239 offset:24576
    v_cvt_pk_bf16_f32 v190, v192, v193
    v_mfma_f32_16x16x32_bf16 v[140:143], a[0:3], a[132:135], v[140:143]
    s_waitcnt lgkmcnt(3)
    buffer_load_dwordx4 v220, s[60:63], s82 offen offset:0 lds
    v_mfma_f32_16x16x32_bf16 v[128:131], a[4:7], a[136:139], v[128:131]
    v_exp_f32 v158, v158
    v_mfma_f32_16x16x32_bf16 v[132:135], a[4:7], a[140:143], v[132:135]
    ds_read_b128 a[24:27], v239 offset:26624
    v_cvt_pk_bf16_f32 v191, v194, v195
    v_mfma_f32_16x16x32_bf16 v[136:139], a[8:11], a[136:139], v[136:139]
    v_exp_f32 v159, v159
    v_mfma_f32_16x16x32_bf16 v[140:143], a[8:11], a[140:143], v[140:143]
    s_waitcnt lgkmcnt(2)
    ds_read_b128 a[28:31], v241 offset:24576
    v_cvt_pk_bf16_f32 v160, v144, v145
    v_mfma_f32_16x16x32_bf16 v[128:131], a[12:15], a[144:147], v[128:131]
    buffer_load_dwordx4 v221, s[60:63], s82 offen offset:1024 lds
    v_mfma_f32_16x16x32_bf16 v[132:135], a[12:15], a[148:151], v[132:135]
    ds_read_b128 a[0:3], v241 offset:26624
    v_cvt_pk_bf16_f32 v161, v146, v147
    v_mfma_f32_16x16x32_bf16 v[136:139], a[16:19], a[144:147], v[136:139]
    ds_read_b128 a[4:7], v239 offset:28672
    v_cvt_pk_bf16_f32 v162, v152, v153
    v_mfma_f32_16x16x32_bf16 v[140:143], a[16:19], a[148:151], v[140:143]
    s_waitcnt lgkmcnt(3)
    ds_read_b128 a[8:11], v239 offset:30720
    v_cvt_pk_bf16_f32 v163, v154, v155
    v_mfma_f32_16x16x32_bf16 v[128:131], a[20:23], a[152:155], v[128:131]
    buffer_load_dwordx4 v222, s[60:63], s82 offen offset:2048 lds
    v_mfma_f32_16x16x32_bf16 v[132:135], a[20:23], a[156:159], v[132:135]
    v_cvt_pk_bf16_f32 v164, v148, v149
    v_cvt_pk_bf16_f32 v165, v150, v151
    v_mfma_f32_16x16x32_bf16 v[136:139], a[24:27], a[152:155], v[136:139]
    ds_read_b128 a[12:15], v241 offset:28672
    v_cvt_pk_bf16_f32 v166, v156, v157
    v_mfma_f32_16x16x32_bf16 v[140:143], a[24:27], a[156:159], v[140:143]
    s_waitcnt lgkmcnt(3)
    ds_read_b128 a[16:19], v241 offset:30720
    v_cvt_pk_bf16_f32 v167, v158, v159
    v_mfma_f32_16x16x32_bf16 v[128:131], a[28:31], a[160:163], v[128:131]
    s_waitcnt vmcnt(16)
    s_barrier
    v_cvt_pk_bf16_f32 v192, v196, v197
    v_mfma_f32_16x16x32_bf16 v[132:135], a[28:31], a[164:167], v[132:135]
    buffer_load_dwordx4 v223, s[60:63], s82 offen offset:3072 lds
    v_mfma_f32_16x16x32_bf16 v[136:139], a[0:3], a[160:163], v[136:139]
    s_add_u32 m0, s81, 147456
    ds_read_b64_tr_b16 a[20:21], v225 offset:32768
    v_cvt_pk_bf16_f32 v193, v198, v199
    v_mfma_f32_16x16x32_bf16 v[140:143], a[0:3], a[164:167], v[140:143]
    s_waitcnt lgkmcnt(3)
    ds_read_b64_tr_b16 a[22:23], v225 offset:34816
    v_cvt_pk_bf16_f32 v194, v200, v201
    v_mfma_f32_16x16x32_bf16 v[128:131], a[4:7], a[168:171], v[128:131]
    s_mov_b32 s82, 131072
    ds_read_b64_tr_b16 a[24:25], v227 offset:32768
    v_cvt_pk_bf16_f32 v195, v202, v203
    v_mfma_f32_16x16x32_bf16 v[132:135], a[4:7], a[172:175], v[132:135]
    s_mov_b32 s83, 14684160
    ds_read_b64_tr_b16 a[26:27], v227 offset:34816
    v_mfma_f32_16x16x32_bf16 v[136:139], a[8:11], a[168:171], v[136:139]
    buffer_load_dwordx4 v212, s[48:51], s82 offen offset:0 lds
    v_mfma_f32_16x16x32_bf16 v[140:143], a[8:11], a[172:175], v[140:143]
    s_waitcnt lgkmcnt(4)
    ds_read_b64_tr_b16 a[28:29], v229 offset:32768
    v_mfma_f32_16x16x32_bf16 v[128:131], a[12:15], a[176:179], v[128:131]
    ds_read_b64_tr_b16 a[30:31], v229 offset:34816
    v_mfma_f32_16x16x32_bf16 v[132:135], a[12:15], a[180:183], v[132:135]
    buffer_store_dwordx4 v[188:191], v211, s[64:67], s83 offen offset:0 sc1
    v_mfma_f32_16x16x32_bf16 v[136:139], a[16:19], a[176:179], v[136:139]
    ds_read_b64_tr_b16 a[0:1], v231 offset:32768
    v_mfma_f32_16x16x32_bf16 v[140:143], a[16:19], a[180:183], v[140:143]
    ds_read_b64_tr_b16 a[2:3], v231 offset:34816
    v_mfma_f32_16x16x32_bf16 v[168:171], v[184:187], v[160:163], v[168:171]
    buffer_load_dwordx4 v213, s[48:51], s82 offen offset:1024 lds
    v_mfma_f32_16x16x32_bf16 v[172:175], v[184:187], v[164:167], v[172:175]
    s_waitcnt lgkmcnt(4)
    ds_read_b64_tr_b16 a[4:5], v225 offset:36864
    ds_read_b64_tr_b16 a[6:7], v225 offset:38912
    v_mfma_f32_16x16x32_bf16 v[0:3], a[20:23], v[160:163], v[0:3]
    buffer_store_dwordx4 v[192:195], v211, s[64:67], s83 offen offset:1024 sc1
    v_mfma_f32_16x16x32_bf16 v[4:7], a[20:23], v[164:167], v[4:7]
    ds_read_b64_tr_b16 a[8:9], v227 offset:36864
    ds_read_b64_tr_b16 a[10:11], v227 offset:38912
    v_mfma_f32_16x16x32_bf16 v[8:11], a[24:27], v[160:163], v[8:11]
    ds_read_b64_tr_b16 a[12:13], v229 offset:36864
    ds_read_b64_tr_b16 a[14:15], v229 offset:38912
    v_mfma_f32_16x16x32_bf16 v[12:15], a[24:27], v[164:167], v[12:15]
    s_waitcnt lgkmcnt(6)
    buffer_load_dwordx4 v214, s[48:51], s82 offen offset:2048 lds
    v_mfma_f32_16x16x32_bf16 v[16:19], a[28:31], v[160:163], v[16:19]
    ds_read_b64_tr_b16 a[16:17], v231 offset:36864
    v_mfma_f32_16x16x32_bf16 v[20:23], a[28:31], v[164:167], v[20:23]
    ds_read_b64_tr_b16 a[18:19], v231 offset:38912
    v_mfma_f32_16x16x32_bf16 v[24:27], a[0:3], v[160:163], v[24:27]
    ds_read_b64_tr_b16 a[20:21], v225 offset:40960
    v_mfma_f32_16x16x32_bf16 v[28:31], a[0:3], v[164:167], v[28:31]
    s_waitcnt lgkmcnt(5)
    ds_read_b64_tr_b16 a[22:23], v225 offset:43008
    v_mfma_f32_16x16x32_bf16 v[32:35], a[4:7], v[160:163], v[32:35]
    buffer_load_dwordx4 v215, s[48:51], s82 offen offset:3072 lds
    v_mfma_f32_16x16x32_bf16 v[36:39], a[4:7], v[164:167], v[36:39]
    s_add_u32 m0, s81, 65536
    ds_read_b64_tr_b16 a[24:25], v227 offset:40960
    ds_read_b64_tr_b16 a[26:27], v227 offset:43008
    v_mfma_f32_16x16x32_bf16 v[40:43], a[8:11], v[160:163], v[40:43]
    s_mov_b32 s82, 114688
    ds_read_b64_tr_b16 a[28:29], v229 offset:40960
    v_mfma_f32_16x16x32_bf16 v[44:47], a[8:11], v[164:167], v[44:47]
    s_waitcnt lgkmcnt(5)
    ds_read_b64_tr_b16 a[30:31], v229 offset:43008
    v_mfma_f32_16x16x32_bf16 v[48:51], a[12:15], v[160:163], v[48:51]
    ds_read_b64_tr_b16 a[0:1], v231 offset:40960
    ds_read_b64_tr_b16 a[2:3], v231 offset:43008
    v_mfma_f32_16x16x32_bf16 v[52:55], a[12:15], v[164:167], v[52:55]
    buffer_load_dwordx4 v216, s[52:55], s82 offen offset:0 lds
    v_mfma_f32_16x16x32_bf16 v[56:59], a[16:19], v[160:163], v[56:59]
    ds_read_b64_tr_b16 a[4:5], v225 offset:45056
    v_mfma_f32_16x16x32_bf16 v[60:63], a[16:19], v[164:167], v[60:63]
    s_waitcnt lgkmcnt(5)
    ds_read_b64_tr_b16 a[6:7], v225 offset:47104
    v_mfma_f32_16x16x32_bf16 v[64:67], a[20:23], v[160:163], v[64:67]
    ds_read_b64_tr_b16 a[8:9], v227 offset:45056
    v_mfma_f32_16x16x32_bf16 v[68:71], a[20:23], v[164:167], v[68:71]
    ds_read_b64_tr_b16 a[10:11], v227 offset:47104
    v_mfma_f32_16x16x32_bf16 v[72:75], a[24:27], v[160:163], v[72:75]
    buffer_load_dwordx4 v217, s[52:55], s82 offen offset:1024 lds
    v_mfma_f32_16x16x32_bf16 v[76:79], a[24:27], v[164:167], v[76:79]
    s_waitcnt lgkmcnt(4)
    ds_read_b64_tr_b16 a[12:13], v229 offset:45056
    ds_read_b64_tr_b16 a[14:15], v229 offset:47104
    v_mfma_f32_16x16x32_bf16 v[80:83], a[28:31], v[160:163], v[80:83]
    ds_read_b64_tr_b16 a[16:17], v231 offset:45056
    v_mfma_f32_16x16x32_bf16 v[84:87], a[28:31], v[164:167], v[84:87]
    ds_read_b64_tr_b16 a[18:19], v231 offset:47104
    v_mfma_f32_16x16x32_bf16 v[88:91], a[0:3], v[160:163], v[88:91]
    ds_read_b64_tr_b16 a[20:21], v232 offset:0
    ds_read_b64_tr_b16 a[22:23], v232 offset:2048
    v_mfma_f32_16x16x32_bf16 v[92:95], a[0:3], v[164:167], v[92:95]
    s_waitcnt lgkmcnt(6)
    buffer_load_dwordx4 v218, s[52:55], s82 offen offset:2048 lds
    v_mfma_f32_16x16x32_bf16 v[96:99], a[4:7], v[160:163], v[96:99]
    ds_read_b64_tr_b16 a[24:25], v232 offset:4096
    v_mfma_f32_16x16x32_bf16 v[100:103], a[4:7], v[164:167], v[100:103]
    ds_read_b64_tr_b16 a[26:27], v232 offset:6144
    v_mfma_f32_16x16x32_bf16 v[104:107], a[8:11], v[160:163], v[104:107]
    ds_read_b64_tr_b16 a[28:29], v232 offset:8192
    v_mfma_f32_16x16x32_bf16 v[108:111], a[8:11], v[164:167], v[108:111]
    s_waitcnt lgkmcnt(5)
    ds_read_b64_tr_b16 a[30:31], v232 offset:10240
    v_mfma_f32_16x16x32_bf16 v[112:115], a[12:15], v[160:163], v[112:115]
    buffer_load_dwordx4 v219, s[52:55], s82 offen offset:3072 lds
    v_mfma_f32_16x16x32_bf16 v[116:119], a[12:15], v[164:167], v[116:119]
    v_exp_f32 v128, v128
    v_mfma_f32_16x16x32_bf16 v[120:123], a[16:19], v[160:163], v[120:123]
    ds_read_b64_tr_b16 a[0:1], v232 offset:12288
    v_mfma_f32_16x16x32_bf16 v[124:127], a[16:19], v[164:167], v[124:127]
    s_waitcnt lgkmcnt(5)
    ds_read_b64_tr_b16 a[2:3], v232 offset:14336
    v_mfma_f32_16x16x32_bf16 v[188:191], a[20:23], a[64:67], 0
    v_exp_f32 v129, v129
    v_mfma_f32_16x16x32_bf16 v[192:195], a[20:23], a[68:71], 0
    v_exp_f32 v130, v130
    v_mfma_f32_16x16x32_bf16 v[196:199], a[20:23], a[72:75], 0
    ds_read_b64_tr_b16 a[4:5], v232 offset:16384
    v_mfma_f32_16x16x32_bf16 v[200:203], a[20:23], a[76:79], 0
    s_waitcnt lgkmcnt(5)
    ds_read_b64_tr_b16 a[6:7], v232 offset:18432
    v_mfma_f32_16x16x32_bf16 v[188:191], a[24:27], a[80:83], v[188:191]
    v_exp_f32 v131, v131
    v_mfma_f32_16x16x32_bf16 v[192:195], a[24:27], a[84:87], v[192:195]
    v_exp_f32 v132, v132
    v_mfma_f32_16x16x32_bf16 v[196:199], a[24:27], a[88:91], v[196:199]
    ds_read_b64_tr_b16 a[8:9], v232 offset:20480
    v_mfma_f32_16x16x32_bf16 v[200:203], a[24:27], a[92:95], v[200:203]
    s_waitcnt lgkmcnt(5)
    ds_read_b64_tr_b16 a[10:11], v232 offset:22528
    v_mfma_f32_16x16x32_bf16 v[188:191], a[28:31], a[96:99], v[188:191]
    s_add_u32 m0, s81, 0
    v_exp_f32 v133, v133
    v_mfma_f32_16x16x32_bf16 v[192:195], a[28:31], a[100:103], v[192:195]
    s_mov_b32 s82, 640
    v_exp_f32 v134, v134
    v_mfma_f32_16x16x32_bf16 v[196:199], a[28:31], a[104:107], v[196:199]
    ds_read_b64_tr_b16 a[12:13], v232 offset:24576
    v_mfma_f32_16x16x32_bf16 v[200:203], a[28:31], a[108:111], v[200:203]
    s_waitcnt lgkmcnt(5)
    ds_read_b64_tr_b16 a[14:15], v232 offset:26624
    v_mfma_f32_16x16x32_bf16 v[188:191], a[0:3], a[112:115], v[188:191]
    v_exp_f32 v135, v135
    v_mfma_f32_16x16x32_bf16 v[192:195], a[0:3], a[116:119], v[192:195]
    v_exp_f32 v136, v136
    v_mfma_f32_16x16x32_bf16 v[196:199], a[0:3], a[32:35], v[196:199]
    s_waitcnt vmcnt(22)
    s_barrier
    v_xor_b32 v247, 2654435769, v246
    v_mfma_f32_16x16x32_bf16 v[200:203], a[0:3], a[36:39], v[200:203]
    s_waitcnt lgkmcnt(4)
    buffer_load_dwordx4 v220, s[60:63], s82 offen offset:0 lds
    v_mfma_f32_16x16x32_bf16 v[188:191], a[4:7], a[40:43], v[188:191]
    v_exp_f32 v137, v137
    v_mfma_f32_16x16x32_bf16 v[192:195], a[4:7], a[44:47], v[192:195]
    ds_read_b128 a[16:19], v239 offset:49152
    v_readfirstlane_b32 s34, v246
    v_mfma_f32_16x16x32_bf16 v[196:199], a[4:7], a[48:51], v[196:199]
    ds_read_b128 a[20:23], v239 offset:51200
    v_mfma_f32_16x16x32_bf16 v[200:203], a[4:7], a[52:55], v[200:203]
    s_waitcnt lgkmcnt(4)
    v_exp_f32 v138, v138
    v_mfma_f32_16x16x32_bf16 v[188:191], a[8:11], a[56:59], v[188:191]
    buffer_load_dwordx4 v221, s[60:63], s82 offen offset:1024 lds
    v_mfma_f32_16x16x32_bf16 v[192:195], a[8:11], a[60:63], v[192:195]
    ds_read_b128 a[24:27], v241 offset:49152
    v_mfma_f32_16x16x32_bf16 v[196:199], a[8:11], a[184:187], v[196:199]
    ds_read_b128 a[28:31], v241 offset:51200
    v_mfma_f32_16x16x32_bf16 v[200:203], a[8:11], a[188:191], v[200:203]
    s_waitcnt lgkmcnt(4)
    v_exp_f32 v139, v139
    v_mfma_f32_16x16x32_bf16 v[188:191], a[12:15], a[192:195], v[188:191]
    buffer_load_dwordx4 v222, s[60:63], s82 offen offset:2048 lds
    v_mfma_f32_16x16x32_bf16 v[192:195], a[12:15], a[196:199], v[192:195]
    ds_read_b128 a[0:3], v239 offset:53248
    v_mfma_f32_16x16x32_bf16 v[196:199], a[12:15], a[200:203], v[196:199]
    v_exp_f32 v140, v140
    v_mfma_f32_16x16x32_bf16 v[200:203], a[12:15], a[204:207], v[200:203]
    s_waitcnt lgkmcnt(3)
    ds_read_b128 a[4:7], v239 offset:55296
    v_mfma_f32_16x16x32_bf16 v[144:147], a[16:19], a[120:123], v[176:179]
    ds_read_b128 a[8:11], v241 offset:53248
    v_mfma_f32_16x16x32_bf16 v[148:151], a[16:19], a[124:127], v[180:183]
    buffer_load_dwordx4 v223, s[60:63], s82 offen offset:3072 lds
    v_mfma_f32_16x16x32_bf16 v[152:155], a[20:23], a[120:123], v[176:179]
    s_add_u32 m0, s81, 81920
    v_exp_f32 v141, v141
    v_mfma_f32_16x16x32_bf16 v[156:159], a[20:23], a[124:127], v[180:183]
    s_waitcnt lgkmcnt(3)
    ds_read_b128 a[12:15], v241 offset:55296
    v_cvt_pk_bf16_f32 v188, v188, v189
    v_mfma_f32_16x16x32_bf16 v[144:147], a[24:27], a[128:131], v[144:147]
    s_mov_b32 s82, 115328
    ds_read_b128 a[16:19], v239 offset:57344
    v_cvt_pk_bf16_f32 v189, v190, v191
    v_mfma_f32_16x16x32_bf16 v[148:151], a[24:27], a[132:135], v[148:151]
    v_exp_f32 v142, v142
    v_mfma_f32_16x16x32_bf16 v[152:155], a[28:31], a[128:131], v[152:155]
    buffer_load_dwordx4 v220, s[60:63], s82 offen offset:0 lds
    v_mfma_f32_16x16x32_bf16 v[156:159], a[28:31], a[132:135], v[156:159]
    s_waitcnt lgkmcnt(3)
    ds_read_b128 a[20:23], v239 offset:59392
    v_cvt_pk_bf16_f32 v190, v192, v193
    v_mfma_f32_16x16x32_bf16 v[144:147], a[0:3], a[136:139], v[144:147]
    v_exp_f32 v143, v143
    v_mfma_f32_16x16x32_bf16 v[148:151], a[0:3], a[140:143], v[148:151]
    ds_read_b128 a[24:27], v241 offset:57344
    v_cvt_pk_bf16_f32 v160, v128, v129
    v_mfma_f32_16x16x32_bf16 v[152:155], a[4:7], a[136:139], v[152:155]
    ds_read_b128 a[28:31], v241 offset:59392
    v_cvt_pk_bf16_f32 v161, v130, v131
    v_mfma_f32_16x16x32_bf16 v[156:159], a[4:7], a[140:143], v[156:159]
    s_waitcnt lgkmcnt(4)
    ds_read_b128 a[0:3], v239 offset:61440
    v_cvt_pk_bf16_f32 v162, v136, v137
    v_mfma_f32_16x16x32_bf16 v[144:147], a[8:11], a[144:147], v[144:147]
    buffer_load_dwordx4 v221, s[60:63], s82 offen offset:1024 lds
    v_mfma_f32_16x16x32_bf16 v[148:151], a[8:11], a[148:151], v[148:151]
    ds_read_b128 a[4:7], v239 offset:63488
    v_cvt_pk_bf16_f32 v163, v138, v139
    v_mfma_f32_16x16x32_bf16 v[152:155], a[12:15], a[144:147], v[152:155]
    v_cvt_pk_bf16_f32 v164, v132, v133
    v_cvt_pk_bf16_f32 v165, v134, v135
    v_mfma_f32_16x16x32_bf16 v[156:159], a[12:15], a[148:151], v[156:159]
    s_waitcnt lgkmcnt(4)
    ds_read_b128 a[8:11], v241 offset:61440
    v_cvt_pk_bf16_f32 v166, v140, v141
    v_mfma_f32_16x16x32_bf16 v[144:147], a[16:19], a[152:155], v[144:147]
    buffer_load_dwordx4 v222, s[60:63], s82 offen offset:2048 lds
    v_mfma_f32_16x16x32_bf16 v[148:151], a[16:19], a[156:159], v[148:151]
    ds_read_b128 a[12:15], v241 offset:63488
    v_cvt_pk_bf16_f32 v167, v142, v143
    v_mfma_f32_16x16x32_bf16 v[152:155], a[20:23], a[152:155], v[152:155]
    v_cvt_pk_bf16_f32 v191, v194, v195
    v_cvt_pk_bf16_f32 v192, v196, v197
    v_mfma_f32_16x16x32_bf16 v[156:159], a[20:23], a[156:159], v[156:159]
    s_waitcnt lgkmcnt(4)
    v_cvt_pk_bf16_f32 v193, v198, v199
    v_cvt_pk_bf16_f32 v194, v200, v201
    v_mfma_f32_16x16x32_bf16 v[144:147], a[24:27], a[160:163], v[144:147]
    s_waitcnt vmcnt(17)
    s_barrier
    v_cvt_pk_bf16_f32 v195, v202, v203
    v_mfma_f32_16x16x32_bf16 v[148:151], a[24:27], a[164:167], v[148:151]
    buffer_load_dwordx4 v223, s[60:63], s82 offen offset:3072 lds
    v_mfma_f32_16x16x32_bf16 v[152:155], a[28:31], a[160:163], v[152:155]
    s_add_u32 m0, s81, 98304
    ds_read_b64_tr_b16 a[16:17], v224 offset:32768
    v_mfma_f32_16x16x32_bf16 v[156:159], a[28:31], a[164:167], v[156:159]
    s_waitcnt lgkmcnt(3)
    ds_read_b64_tr_b16 a[18:19], v224 offset:34816
    v_mfma_f32_16x16x32_bf16 v[144:147], a[0:3], a[168:171], v[144:147]
    s_mov_b32 s82, 147456
    ds_read_b64_tr_b16 a[20:21], v226 offset:32768
    v_mfma_f32_16x16x32_bf16 v[148:151], a[0:3], a[172:175], v[148:151]
    s_mov_b32 s83, 14686208
    ds_read_b64_tr_b16 a[22:23], v226 offset:34816
    v_mfma_f32_16x16x32_bf16 v[152:155], a[4:7], a[168:171], v[152:155]
    buffer_load_dwordx4 v212, s[48:51], s82 offen offset:0 lds
    v_mfma_f32_16x16x32_bf16 v[156:159], a[4:7], a[172:175], v[156:159]
    s_waitcnt lgkmcnt(4)
    ds_read_b64_tr_b16 a[24:25], v228 offset:32768
    v_mfma_f32_16x16x32_bf16 v[144:147], a[8:11], a[176:179], v[144:147]
    ds_read_b64_tr_b16 a[26:27], v228 offset:34816
    v_mfma_f32_16x16x32_bf16 v[148:151], a[8:11], a[180:183], v[148:151]
    buffer_store_dwordx4 v[188:191], v211, s[64:67], s83 offen offset:0 sc1
    v_mfma_f32_16x16x32_bf16 v[152:155], a[12:15], a[176:179], v[152:155]
    ds_read_b64_tr_b16 a[28:29], v230 offset:32768
    v_mfma_f32_16x16x32_bf16 v[156:159], a[12:15], a[180:183], v[156:159]
    ds_read_b64_tr_b16 a[30:31], v230 offset:34816
    v_mfma_f32_16x16x32_bf16 v[168:171], v[184:187], v[160:163], v[168:171]
    buffer_load_dwordx4 v213, s[48:51], s82 offen offset:1024 lds
    v_mfma_f32_16x16x32_bf16 v[172:175], v[184:187], v[164:167], v[172:175]
    s_waitcnt lgkmcnt(4)
    ds_read_b64_tr_b16 a[0:1], v224 offset:36864
    ds_read_b64_tr_b16 a[2:3], v224 offset:38912
    v_mfma_f32_16x16x32_bf16 v[0:3], a[16:19], v[160:163], v[0:3]
    buffer_store_dwordx4 v[192:195], v211, s[64:67], s83 offen offset:1024 sc1
    v_mfma_f32_16x16x32_bf16 v[4:7], a[16:19], v[164:167], v[4:7]
    ds_read_b64_tr_b16 a[4:5], v226 offset:36864
    ds_read_b64_tr_b16 a[6:7], v226 offset:38912
    v_mfma_f32_16x16x32_bf16 v[8:11], a[20:23], v[160:163], v[8:11]
    ds_read_b64_tr_b16 a[8:9], v228 offset:36864
    ds_read_b64_tr_b16 a[10:11], v228 offset:38912
    v_mfma_f32_16x16x32_bf16 v[12:15], a[20:23], v[164:167], v[12:15]
    s_waitcnt lgkmcnt(6)
    buffer_load_dwordx4 v214, s[48:51], s82 offen offset:2048 lds
    v_mfma_f32_16x16x32_bf16 v[16:19], a[24:27], v[160:163], v[16:19]
    ds_read_b64_tr_b16 a[12:13], v230 offset:36864
    v_mfma_f32_16x16x32_bf16 v[20:23], a[24:27], v[164:167], v[20:23]
    ds_read_b64_tr_b16 a[14:15], v230 offset:38912
    v_mfma_f32_16x16x32_bf16 v[24:27], a[28:31], v[160:163], v[24:27]
    ds_read_b64_tr_b16 a[16:17], v224 offset:40960
    v_mfma_f32_16x16x32_bf16 v[28:31], a[28:31], v[164:167], v[28:31]
    s_waitcnt lgkmcnt(5)
    ds_read_b64_tr_b16 a[18:19], v224 offset:43008
    v_mfma_f32_16x16x32_bf16 v[32:35], a[0:3], v[160:163], v[32:35]
    buffer_load_dwordx4 v215, s[48:51], s82 offen offset:3072 lds
    v_mfma_f32_16x16x32_bf16 v[36:39], a[0:3], v[164:167], v[36:39]
    s_add_u32 m0, s81, 16384
    ds_read_b64_tr_b16 a[20:21], v226 offset:40960
    ds_read_b64_tr_b16 a[22:23], v226 offset:43008
    v_mfma_f32_16x16x32_bf16 v[40:43], a[4:7], v[160:163], v[40:43]
    s_mov_b32 s82, 131072
    ds_read_b64_tr_b16 a[24:25], v228 offset:40960
    v_mfma_f32_16x16x32_bf16 v[44:47], a[4:7], v[164:167], v[44:47]
    s_waitcnt lgkmcnt(5)
    ds_read_b64_tr_b16 a[26:27], v228 offset:43008
    v_mfma_f32_16x16x32_bf16 v[48:51], a[8:11], v[160:163], v[48:51]
    ds_read_b64_tr_b16 a[28:29], v230 offset:40960
    ds_read_b64_tr_b16 a[30:31], v230 offset:43008
    v_mfma_f32_16x16x32_bf16 v[52:55], a[8:11], v[164:167], v[52:55]
    buffer_load_dwordx4 v216, s[52:55], s82 offen offset:0 lds
    v_mfma_f32_16x16x32_bf16 v[56:59], a[12:15], v[160:163], v[56:59]
    ds_read_b64_tr_b16 a[0:1], v224 offset:45056
    v_mfma_f32_16x16x32_bf16 v[60:63], a[12:15], v[164:167], v[60:63]
    s_waitcnt lgkmcnt(5)
    ds_read_b64_tr_b16 a[2:3], v224 offset:47104
    v_mfma_f32_16x16x32_bf16 v[64:67], a[16:19], v[160:163], v[64:67]
    ds_read_b64_tr_b16 a[4:5], v226 offset:45056
    v_mfma_f32_16x16x32_bf16 v[68:71], a[16:19], v[164:167], v[68:71]
    ds_read_b64_tr_b16 a[6:7], v226 offset:47104
    v_mfma_f32_16x16x32_bf16 v[72:75], a[20:23], v[160:163], v[72:75]
    buffer_load_dwordx4 v217, s[52:55], s82 offen offset:1024 lds
    v_mfma_f32_16x16x32_bf16 v[76:79], a[20:23], v[164:167], v[76:79]
    s_waitcnt lgkmcnt(4)
    ds_read_b64_tr_b16 a[8:9], v228 offset:45056
    ds_read_b64_tr_b16 a[10:11], v228 offset:47104
    v_mfma_f32_16x16x32_bf16 v[80:83], a[24:27], v[160:163], v[80:83]
    ds_read_b64_tr_b16 a[12:13], v230 offset:45056
    v_mfma_f32_16x16x32_bf16 v[84:87], a[24:27], v[164:167], v[84:87]
    ds_read_b64_tr_b16 a[14:15], v230 offset:47104
    v_mfma_f32_16x16x32_bf16 v[88:91], a[28:31], v[160:163], v[88:91]
    ds_read_b64_tr_b16 a[16:17], v232 offset:49152
    ds_read_b64_tr_b16 a[18:19], v232 offset:51200
    v_mfma_f32_16x16x32_bf16 v[92:95], a[28:31], v[164:167], v[92:95]
    s_waitcnt lgkmcnt(6)
    buffer_load_dwordx4 v218, s[52:55], s82 offen offset:2048 lds
    v_mfma_f32_16x16x32_bf16 v[96:99], a[0:3], v[160:163], v[96:99]
    ds_read_b64_tr_b16 a[20:21], v232 offset:53248
    v_mfma_f32_16x16x32_bf16 v[100:103], a[0:3], v[164:167], v[100:103]
    ds_read_b64_tr_b16 a[22:23], v232 offset:55296
    v_mfma_f32_16x16x32_bf16 v[104:107], a[4:7], v[160:163], v[104:107]
    ds_read_b64_tr_b16 a[24:25], v232 offset:57344
    v_mfma_f32_16x16x32_bf16 v[108:111], a[4:7], v[164:167], v[108:111]
    s_waitcnt lgkmcnt(5)
    ds_read_b64_tr_b16 a[26:27], v232 offset:59392
    v_mfma_f32_16x16x32_bf16 v[112:115], a[8:11], v[160:163], v[112:115]
    buffer_load_dwordx4 v219, s[52:55], s82 offen offset:3072 lds
    v_mfma_f32_16x16x32_bf16 v[116:119], a[8:11], v[164:167], v[116:119]
    s_cmp_eq_u32 s34, 0
    s_cselect_b32 s3, 0x40000000, 0
    v_add_u32 v244, s3, v244
    v_mfma_f32_16x16x32_bf16 v[120:123], a[12:15], v[160:163], v[120:123]
    ds_read_b64_tr_b16 a[28:29], v232 offset:61440
    v_mfma_f32_16x16x32_bf16 v[124:127], a[12:15], v[164:167], v[124:127]
    s_waitcnt lgkmcnt(5)
    ds_read_b64_tr_b16 a[30:31], v232 offset:63488
    v_mfma_f32_16x16x32_bf16 v[188:191], a[16:19], a[64:67], 0
    v_exp_f32 v144, v144
    v_mfma_f32_16x16x32_bf16 v[192:195], a[16:19], a[68:71], 0
    v_exp_f32 v145, v145
    v_mfma_f32_16x16x32_bf16 v[196:199], a[16:19], a[72:75], 0
    ds_read_b64_tr_b16 a[0:1], v234 offset:0
    v_mfma_f32_16x16x32_bf16 v[200:203], a[16:19], a[76:79], 0
    s_waitcnt lgkmcnt(5)
    ds_read_b64_tr_b16 a[2:3], v234 offset:2048
    v_mfma_f32_16x16x32_bf16 v[188:191], a[20:23], a[80:83], v[188:191]
    v_exp_f32 v146, v146
    v_mfma_f32_16x16x32_bf16 v[192:195], a[20:23], a[84:87], v[192:195]
    v_exp_f32 v147, v147
    v_mfma_f32_16x16x32_bf16 v[196:199], a[20:23], a[88:91], v[196:199]
    v_exp_f32 v148, v148
    v_mfma_f32_16x16x32_bf16 v[200:203], a[20:23], a[92:95], v[200:203]
    s_waitcnt lgkmcnt(4)
    ds_read_b64_tr_b16 a[4:5], v234 offset:4096
    v_mfma_f32_16x16x32_bf16 v[188:191], a[24:27], a[96:99], v[188:191]
    s_add_u32 m0, s81, 32768
    ds_read_b64_tr_b16 a[6:7], v234 offset:6144
    v_mfma_f32_16x16x32_bf16 v[192:195], a[24:27], a[100:103], v[192:195]
    s_mov_b32 s82, 768
    v_exp_f32 v149, v149
    v_mfma_f32_16x16x32_bf16 v[196:199], a[24:27], a[104:107], v[196:199]
    v_exp_f32 v150, v150
    v_mfma_f32_16x16x32_bf16 v[200:203], a[24:27], a[108:111], v[200:203]
    s_waitcnt lgkmcnt(4)
    ds_read_b64_tr_b16 a[8:9], v234 offset:8192
    v_mfma_f32_16x16x32_bf16 v[188:191], a[28:31], a[112:115], v[188:191]
    ds_read_b64_tr_b16 a[10:11], v234 offset:10240
    v_mfma_f32_16x16x32_bf16 v[192:195], a[28:31], a[116:119], v[192:195]
    v_exp_f32 v151, v151
    v_mfma_f32_16x16x32_bf16 v[196:199], a[28:31], a[32:35], v[196:199]
    s_waitcnt vmcnt(22)
    s_barrier
    v_mfma_f32_16x16x32_bf16 v[200:203], a[28:31], a[36:39], v[200:203]
    s_waitcnt lgkmcnt(4)
    buffer_load_dwordx4 v220, s[60:63], s82 offen offset:0 lds
    v_mfma_f32_16x16x32_bf16 v[188:191], a[0:3], a[40:43], v[188:191]
    v_exp_f32 v152, v152
    v_mfma_f32_16x16x32_bf16 v[192:195], a[0:3], a[44:47], v[192:195]
    v_exp_f32 v153, v153
    v_mfma_f32_16x16x32_bf16 v[196:199], a[0:3], a[48:51], v[196:199]
    ds_read_b128 a[12:15], v235 offset:16384
    v_mfma_f32_16x16x32_bf16 v[200:203], a[0:3], a[52:55], v[200:203]
    s_waitcnt lgkmcnt(3)
    ds_read_b128 a[16:19], v235 offset:18432
    v_mfma_f32_16x16x32_bf16 v[188:191], a[4:7], a[56:59], v[188:191]
    buffer_load_dwordx4 v221, s[60:63], s82 offen offset:1024 lds
    v_mfma_f32_16x16x32_bf16 v[192:195], a[4:7], a[60:63], v[192:195]
    v_exp_f32 v154, v154
    v_mfma_f32_16x16x32_bf16 v[196:199], a[4:7], a[184:187], v[196:199]
    ds_read_b128 a[20:23], v237 offset:16384
    v_mfma_f32_16x16x32_bf16 v[200:203], a[4:7], a[188:191], v[200:203]
    s_waitcnt lgkmcnt(3)
    ds_read_b128 a[24:27], v237 offset:18432
    v_mfma_f32_16x16x32_bf16 v[188:191], a[8:11], a[192:195], v[188:191]
    buffer_load_dwordx4 v222, s[60:63], s82 offen offset:2048 lds
    v_mfma_f32_16x16x32_bf16 v[192:195], a[8:11], a[196:199], v[192:195]
    v_exp_f32 v155, v155
    v_mfma_f32_16x16x32_bf16 v[196:199], a[8:11], a[200:203], v[196:199]
    ds_read_b128 a[28:31], v235 offset:20480
    v_mfma_f32_16x16x32_bf16 v[200:203], a[8:11], a[204:207], v[200:203]
    s_waitcnt lgkmcnt(3)
    v_exp_f32 v156, v156
    v_mfma_f32_16x16x32_bf16 v[128:131], a[12:15], a[120:123], v[176:179]
    ds_read_b128 a[0:3], v235 offset:22528
    v_mfma_f32_16x16x32_bf16 v[132:135], a[12:15], a[124:127], v[180:183]
    buffer_load_dwordx4 v223, s[60:63], s82 offen offset:3072 lds
    v_mfma_f32_16x16x32_bf16 v[136:139], a[16:19], a[120:123], v[176:179]
    s_add_u32 m0, s81, 49152
    ds_read_b128 a[4:7], v237 offset:20480
    v_cvt_pk_bf16_f32 v188, v188, v189
    v_mfma_f32_16x16x32_bf16 v[140:143], a[16:19], a[124:127], v[180:183]
    s_waitcnt lgkmcnt(3)
    v_exp_f32 v157, v157
    v_mfma_f32_16x16x32_bf16 v[128:131], a[20:23], a[128:131], v[128:131]
    s_mov_b32 s82, 115456
    ds_read_b128 a[8:11], v237 offset:22528
    v_cvt_pk_bf16_f32 v189, v190, v191
    v_mfma_f32_16x16x32_bf16 v[132:135], a[20:23], a[132:135], v[132:135]
    ds_read_b128 a[12:15], v235 offset:24576
    v_cvt_pk_bf16_f32 v190, v192, v193
    v_mfma_f32_16x16x32_bf16 v[136:139], a[24:27], a[128:131], v[136:139]
    buffer_load_dwordx4 v220, s[60:63], s82 offen offset:0 lds
    v_mfma_f32_16x16x32_bf16 v[140:143], a[24:27], a[132:135], v[140:143]
    s_waitcnt lgkmcnt(3)
    v_exp_f32 v158, v158
    v_mfma_f32_16x16x32_bf16 v[128:131], a[28:31], a[136:139], v[128:131]
    ds_read_b128 a[16:19], v235 offset:26624
    v_cvt_pk_bf16_f32 v191, v194, v195
    v_mfma_f32_16x16x32_bf16 v[132:135], a[28:31], a[140:143], v[132:135]
    v_exp_f32 v159, v159
    v_mfma_f32_16x16x32_bf16 v[136:139], a[0:3], a[136:139], v[136:139]
    ds_read_b128 a[20:23], v237 offset:24576
    v_cvt_pk_bf16_f32 v160, v144, v145
    v_mfma_f32_16x16x32_bf16 v[140:143], a[0:3], a[140:143], v[140:143]
    s_waitcnt lgkmcnt(3)
    ds_read_b128 a[24:27], v237 offset:26624
    v_cvt_pk_bf16_f32 v161, v146, v147
    v_mfma_f32_16x16x32_bf16 v[128:131], a[4:7], a[144:147], v[128:131]
    buffer_load_dwordx4 v221, s[60:63], s82 offen offset:1024 lds
    v_mfma_f32_16x16x32_bf16 v[132:135], a[4:7], a[148:151], v[132:135]
    ds_read_b128 a[28:31], v235 offset:28672
    v_cvt_pk_bf16_f32 v162, v152, v153
    v_mfma_f32_16x16x32_bf16 v[136:139], a[8:11], a[144:147], v[136:139]
    ds_read_b128 a[0:3], v235 offset:30720
    v_cvt_pk_bf16_f32 v163, v154, v155
    v_mfma_f32_16x16x32_bf16 v[140:143], a[8:11], a[148:151], v[140:143]
    s_waitcnt lgkmcnt(4)
    v_cvt_pk_bf16_f32 v164, v148, v149
    v_cvt_pk_bf16_f32 v165, v150, v151
    v_mfma_f32_16x16x32_bf16 v[128:131], a[12:15], a[152:155], v[128:131]
    buffer_load_dwordx4 v222, s[60:63], s82 offen offset:2048 lds
    v_mfma_f32_16x16x32_bf16 v[132:135], a[12:15], a[156:159], v[132:135]
    ds_read_b128 a[4:7], v237 offset:28672
    v_cvt_pk_bf16_f32 v166, v156, v157
    v_mfma_f32_16x16x32_bf16 v[136:139], a[16:19], a[152:155], v[136:139]
    ds_read_b128 a[8:11], v237 offset:30720
    v_cvt_pk_bf16_f32 v167, v158, v159
    v_mfma_f32_16x16x32_bf16 v[140:143], a[16:19], a[156:159], v[140:143]
    s_waitcnt lgkmcnt(4)
    v_cvt_pk_bf16_f32 v192, v196, v197
    v_cvt_pk_bf16_f32 v193, v198, v199
    v_mfma_f32_16x16x32_bf16 v[128:131], a[20:23], a[160:163], v[128:131]
    s_waitcnt vmcnt(17)
    s_barrier
    v_cvt_pk_bf16_f32 v194, v200, v201
    v_mfma_f32_16x16x32_bf16 v[132:135], a[20:23], a[164:167], v[132:135]
    buffer_load_dwordx4 v223, s[60:63], s82 offen offset:3072 lds
    v_mfma_f32_16x16x32_bf16 v[136:139], a[24:27], a[160:163], v[136:139]
    s_add_u32 m0, s81, 114688
    ds_read_b64_tr_b16 a[12:13], v225 offset:0
    v_cvt_pk_bf16_f32 v195, v202, v203
    v_mfma_f32_16x16x32_bf16 v[140:143], a[24:27], a[164:167], v[140:143]
    s_waitcnt lgkmcnt(3)
    ds_read_b64_tr_b16 a[14:15], v225 offset:2048
    v_mfma_f32_16x16x32_bf16 v[128:131], a[28:31], a[168:171], v[128:131]
    s_mov_b32 s82, 163840
    ds_read_b64_tr_b16 a[16:17], v227 offset:0
    v_mfma_f32_16x16x32_bf16 v[132:135], a[28:31], a[172:175], v[132:135]
    s_mov_b32 s83, 14688256
    ds_read_b64_tr_b16 a[18:19], v227 offset:2048
    v_mfma_f32_16x16x32_bf16 v[136:139], a[0:3], a[168:171], v[136:139]
    buffer_load_dwordx4 v212, s[48:51], s82 offen offset:0 lds
    v_mfma_f32_16x16x32_bf16 v[140:143], a[0:3], a[172:175], v[140:143]
    s_waitcnt lgkmcnt(4)
    ds_read_b64_tr_b16 a[20:21], v229 offset:0
    v_mfma_f32_16x16x32_bf16 v[128:131], a[4:7], a[176:179], v[128:131]
    ds_read_b64_tr_b16 a[22:23], v229 offset:2048
    v_mfma_f32_16x16x32_bf16 v[132:135], a[4:7], a[180:183], v[132:135]
    buffer_store_dwordx4 v[188:191], v211, s[64:67], s83 offen offset:0 sc1
    v_mfma_f32_16x16x32_bf16 v[136:139], a[8:11], a[176:179], v[136:139]
    ds_read_b64_tr_b16 a[24:25], v231 offset:0
    v_mfma_f32_16x16x32_bf16 v[140:143], a[8:11], a[180:183], v[140:143]
    ds_read_b64_tr_b16 a[26:27], v231 offset:2048
    v_mfma_f32_16x16x32_bf16 v[168:171], v[184:187], v[160:163], v[168:171]
    buffer_load_dwordx4 v213, s[48:51], s82 offen offset:1024 lds
    v_mfma_f32_16x16x32_bf16 v[172:175], v[184:187], v[164:167], v[172:175]
    s_waitcnt lgkmcnt(4)
    ds_read_b64_tr_b16 a[28:29], v225 offset:4096
    ds_read_b64_tr_b16 a[30:31], v225 offset:6144
    v_mfma_f32_16x16x32_bf16 v[0:3], a[12:15], v[160:163], v[0:3]
    buffer_store_dwordx4 v[192:195], v211, s[64:67], s83 offen offset:1024 sc1
    v_mfma_f32_16x16x32_bf16 v[4:7], a[12:15], v[164:167], v[4:7]
    ds_read_b64_tr_b16 a[0:1], v227 offset:4096
    ds_read_b64_tr_b16 a[2:3], v227 offset:6144
    v_mfma_f32_16x16x32_bf16 v[8:11], a[16:19], v[160:163], v[8:11]
    ds_read_b64_tr_b16 a[4:5], v229 offset:4096
    ds_read_b64_tr_b16 a[6:7], v229 offset:6144
    v_mfma_f32_16x16x32_bf16 v[12:15], a[16:19], v[164:167], v[12:15]
    s_waitcnt lgkmcnt(6)
    buffer_load_dwordx4 v214, s[48:51], s82 offen offset:2048 lds
    v_mfma_f32_16x16x32_bf16 v[16:19], a[20:23], v[160:163], v[16:19]
    ds_read_b64_tr_b16 a[8:9], v231 offset:4096
    v_mfma_f32_16x16x32_bf16 v[20:23], a[20:23], v[164:167], v[20:23]
    ds_read_b64_tr_b16 a[10:11], v231 offset:6144
    v_mfma_f32_16x16x32_bf16 v[24:27], a[24:27], v[160:163], v[24:27]
    ds_read_b64_tr_b16 a[12:13], v225 offset:8192
    v_mfma_f32_16x16x32_bf16 v[28:31], a[24:27], v[164:167], v[28:31]
    s_waitcnt lgkmcnt(5)
    ds_read_b64_tr_b16 a[14:15], v225 offset:10240
    v_mfma_f32_16x16x32_bf16 v[32:35], a[28:31], v[160:163], v[32:35]
    buffer_load_dwordx4 v215, s[48:51], s82 offen offset:3072 lds
    v_mfma_f32_16x16x32_bf16 v[36:39], a[28:31], v[164:167], v[36:39]
    s_add_u32 m0, s81, 131072
    ds_read_b64_tr_b16 a[16:17], v227 offset:8192
    ds_read_b64_tr_b16 a[18:19], v227 offset:10240
    v_mfma_f32_16x16x32_bf16 v[40:43], a[0:3], v[160:163], v[40:43]
    s_mov_b32 s82, 147456
    ds_read_b64_tr_b16 a[20:21], v229 offset:8192
    v_mfma_f32_16x16x32_bf16 v[44:47], a[0:3], v[164:167], v[44:47]
    s_waitcnt lgkmcnt(5)
    ds_read_b64_tr_b16 a[22:23], v229 offset:10240
    v_mfma_f32_16x16x32_bf16 v[48:51], a[4:7], v[160:163], v[48:51]
    ds_read_b64_tr_b16 a[24:25], v231 offset:8192
    ds_read_b64_tr_b16 a[26:27], v231 offset:10240
    v_mfma_f32_16x16x32_bf16 v[52:55], a[4:7], v[164:167], v[52:55]
    buffer_load_dwordx4 v216, s[52:55], s82 offen offset:0 lds
    v_mfma_f32_16x16x32_bf16 v[56:59], a[8:11], v[160:163], v[56:59]
    ds_read_b64_tr_b16 a[28:29], v225 offset:12288
    v_mfma_f32_16x16x32_bf16 v[60:63], a[8:11], v[164:167], v[60:63]
    s_waitcnt lgkmcnt(5)
    ds_read_b64_tr_b16 a[30:31], v225 offset:14336
    v_mfma_f32_16x16x32_bf16 v[64:67], a[12:15], v[160:163], v[64:67]
    ds_read_b64_tr_b16 a[0:1], v227 offset:12288
    v_mfma_f32_16x16x32_bf16 v[68:71], a[12:15], v[164:167], v[68:71]
    ds_read_b64_tr_b16 a[2:3], v227 offset:14336
    v_mfma_f32_16x16x32_bf16 v[72:75], a[16:19], v[160:163], v[72:75]
    buffer_load_dwordx4 v217, s[52:55], s82 offen offset:1024 lds
    v_mfma_f32_16x16x32_bf16 v[76:79], a[16:19], v[164:167], v[76:79]
    s_waitcnt lgkmcnt(4)
    ds_read_b64_tr_b16 a[4:5], v229 offset:12288
    ds_read_b64_tr_b16 a[6:7], v229 offset:14336
    v_mfma_f32_16x16x32_bf16 v[80:83], a[20:23], v[160:163], v[80:83]
    ds_read_b64_tr_b16 a[8:9], v231 offset:12288
    v_mfma_f32_16x16x32_bf16 v[84:87], a[20:23], v[164:167], v[84:87]
    ds_read_b64_tr_b16 a[10:11], v231 offset:14336
    v_mfma_f32_16x16x32_bf16 v[88:91], a[24:27], v[160:163], v[88:91]
    ds_read_b64_tr_b16 a[12:13], v232 offset:0
    ds_read_b64_tr_b16 a[14:15], v232 offset:2048
    v_mfma_f32_16x16x32_bf16 v[92:95], a[24:27], v[164:167], v[92:95]
    s_waitcnt lgkmcnt(6)
    buffer_load_dwordx4 v218, s[52:55], s82 offen offset:2048 lds
    v_mfma_f32_16x16x32_bf16 v[96:99], a[28:31], v[160:163], v[96:99]
    ds_read_b64_tr_b16 a[16:17], v232 offset:4096
    v_mfma_f32_16x16x32_bf16 v[100:103], a[28:31], v[164:167], v[100:103]
    ds_read_b64_tr_b16 a[18:19], v232 offset:6144
    v_mfma_f32_16x16x32_bf16 v[104:107], a[0:3], v[160:163], v[104:107]
    ds_read_b64_tr_b16 a[20:21], v232 offset:8192
    v_mfma_f32_16x16x32_bf16 v[108:111], a[0:3], v[164:167], v[108:111]
    s_waitcnt lgkmcnt(5)
    ds_read_b64_tr_b16 a[22:23], v232 offset:10240
    v_mfma_f32_16x16x32_bf16 v[112:115], a[4:7], v[160:163], v[112:115]
    buffer_load_dwordx4 v219, s[52:55], s82 offen offset:3072 lds
    v_mfma_f32_16x16x32_bf16 v[116:119], a[4:7], v[164:167], v[116:119]
    v_exp_f32 v128, v128
    v_mfma_f32_16x16x32_bf16 v[120:123], a[8:11], v[160:163], v[120:123]
    ds_read_b64_tr_b16 a[24:25], v232 offset:12288
    v_mfma_f32_16x16x32_bf16 v[124:127], a[8:11], v[164:167], v[124:127]
    s_waitcnt lgkmcnt(5)
    ds_read_b64_tr_b16 a[26:27], v232 offset:14336
    v_mfma_f32_16x16x32_bf16 v[188:191], a[12:15], a[64:67], 0
    v_exp_f32 v129, v129
    v_mfma_f32_16x16x32_bf16 v[192:195], a[12:15], a[68:71], 0
    v_exp_f32 v130, v130
    v_mfma_f32_16x16x32_bf16 v[196:199], a[12:15], a[72:75], 0
    ds_read_b64_tr_b16 a[28:29], v233 offset:16384
    v_mfma_f32_16x16x32_bf16 v[200:203], a[12:15], a[76:79], 0
    s_waitcnt lgkmcnt(5)
    ds_read_b64_tr_b16 a[30:31], v233 offset:18432
    v_mfma_f32_16x16x32_bf16 v[188:191], a[16:19], a[80:83], v[188:191]
    v_exp_f32 v131, v131
    v_mfma_f32_16x16x32_bf16 v[192:195], a[16:19], a[84:87], v[192:195]
    v_exp_f32 v132, v132
    v_mfma_f32_16x16x32_bf16 v[196:199], a[16:19], a[88:91], v[196:199]
    ds_read_b64_tr_b16 a[0:1], v233 offset:20480
    v_mfma_f32_16x16x32_bf16 v[200:203], a[16:19], a[92:95], v[200:203]
    s_waitcnt lgkmcnt(5)
    ds_read_b64_tr_b16 a[2:3], v233 offset:22528
    v_mfma_f32_16x16x32_bf16 v[188:191], a[20:23], a[96:99], v[188:191]
    s_add_u32 m0, s81, 0
    v_exp_f32 v133, v133
    v_mfma_f32_16x16x32_bf16 v[192:195], a[20:23], a[100:103], v[192:195]
    s_mov_b32 s82, 180224
    v_exp_f32 v134, v134
    v_mfma_f32_16x16x32_bf16 v[196:199], a[20:23], a[104:107], v[196:199]
    ds_read_b64_tr_b16 a[4:5], v233 offset:24576
    v_mfma_f32_16x16x32_bf16 v[200:203], a[20:23], a[108:111], v[200:203]
    s_waitcnt lgkmcnt(5)
    ds_read_b64_tr_b16 a[6:7], v233 offset:26624
    v_mfma_f32_16x16x32_bf16 v[188:191], a[24:27], a[112:115], v[188:191]
    v_exp_f32 v135, v135
    v_mfma_f32_16x16x32_bf16 v[192:195], a[24:27], a[116:119], v[192:195]
    v_exp_f32 v136, v136
    v_mfma_f32_16x16x32_bf16 v[196:199], a[24:27], a[32:35], v[196:199]
    s_waitcnt vmcnt(22)
    s_barrier
    v_mfma_f32_16x16x32_bf16 v[200:203], a[24:27], a[36:39], v[200:203]
    s_waitcnt lgkmcnt(4)
    buffer_load_dwordx4 v212, s[48:51], s82 offen offset:0 lds
    v_mfma_f32_16x16x32_bf16 v[188:191], a[28:31], a[40:43], v[188:191]
    v_exp_f32 v137, v137
    v_mfma_f32_16x16x32_bf16 v[192:195], a[28:31], a[44:47], v[192:195]
    ds_read_b128 a[8:11], v239 offset:32768
    v_mfma_f32_16x16x32_bf16 v[196:199], a[28:31], a[48:51], v[196:199]
    ds_read_b128 a[12:15], v239 offset:34816
    v_mfma_f32_16x16x32_bf16 v[200:203], a[28:31], a[52:55], v[200:203]
    s_waitcnt lgkmcnt(4)
    v_exp_f32 v138, v138
    v_mfma_f32_16x16x32_bf16 v[188:191], a[0:3], a[56:59], v[188:191]
    buffer_load_dwordx4 v213, s[48:51], s82 offen offset:1024 lds
    v_mfma_f32_16x16x32_bf16 v[192:195], a[0:3], a[60:63], v[192:195]
    ds_read_b128 a[16:19], v241 offset:32768
    v_mfma_f32_16x16x32_bf16 v[196:199], a[0:3], a[184:187], v[196:199]
    ds_read_b128 a[20:23], v241 offset:34816
    v_mfma_f32_16x16x32_bf16 v[200:203], a[0:3], a[188:191], v[200:203]
    s_waitcnt lgkmcnt(4)
    v_exp_f32 v139, v139
    v_mfma_f32_16x16x32_bf16 v[188:191], a[4:7], a[192:195], v[188:191]
    buffer_load_dwordx4 v214, s[48:51], s82 offen offset:2048 lds
    v_mfma_f32_16x16x32_bf16 v[192:195], a[4:7], a[196:199], v[192:195]
    ds_read_b128 a[24:27], v239 offset:36864
    v_mfma_f32_16x16x32_bf16 v[196:199], a[4:7], a[200:203], v[196:199]
    v_exp_f32 v140, v140
    v_mfma_f32_16x16x32_bf16 v[200:203], a[4:7], a[204:207], v[200:203]
    s_waitcnt lgkmcnt(3)
    ds_read_b128 a[28:31], v239 offset:38912
    v_mfma_f32_16x16x32_bf16 v[144:147], a[8:11], a[120:123], v[176:179]
    ds_read_b128 a[0:3], v241 offset:36864
    v_mfma_f32_16x16x32_bf16 v[148:151], a[8:11], a[124:127], v[180:183]
    buffer_load_dwordx4 v215, s[48:51], s82 offen offset:3072 lds
    v_mfma_f32_16x16x32_bf16 v[152:155], a[12:15], a[120:123], v[176:179]
    s_add_u32 m0, s81, 65536
    v_exp_f32 v141, v141
    v_mfma_f32_16x16x32_bf16 v[156:159], a[12:15], a[124:127], v[180:183]
    s_waitcnt lgkmcnt(3)
    ds_read_b128 a[4:7], v241 offset:38912
    v_cvt_pk_bf16_f32 v188, v188, v189
    v_mfma_f32_16x16x32_bf16 v[144:147], a[16:19], a[128:131], v[144:147]
    s_mov_b32 s82, 163840
    ds_read_b128 a[8:11], v239 offset:40960
    v_cvt_pk_bf16_f32 v189, v190, v191
    v_mfma_f32_16x16x32_bf16 v[148:151], a[16:19], a[132:135], v[148:151]
    v_exp_f32 v142, v142
    v_mfma_f32_16x16x32_bf16 v[152:155], a[20:23], a[128:131], v[152:155]
    buffer_load_dwordx4 v216, s[52:55], s82 offen offset:0 lds
    v_mfma_f32_16x16x32_bf16 v[156:159], a[20:23], a[132:135], v[156:159]
    s_waitcnt lgkmcnt(3)
    ds_read_b128 a[12:15], v239 offset:43008
    v_cvt_pk_bf16_f32 v190, v192, v193
    v_mfma_f32_16x16x32_bf16 v[144:147], a[24:27], a[136:139], v[144:147]
    v_exp_f32 v143, v143
    v_mfma_f32_16x16x32_bf16 v[148:151], a[24:27], a[140:143], v[148:151]
    ds_read_b128 a[16:19], v241 offset:40960
    v_cvt_pk_bf16_f32 v160, v128, v129
    v_mfma_f32_16x16x32_bf16 v[152:155], a[28:31], a[136:139], v[152:155]
    ds_read_b128 a[20:23], v241 offset:43008
    v_cvt_pk_bf16_f32 v161, v130, v131
    v_mfma_f32_16x16x32_bf16 v[156:159], a[28:31], a[140:143], v[156:159]
    s_waitcnt lgkmcnt(4)
    ds_read_b128 a[24:27], v239 offset:45056
    v_cvt_pk_bf16_f32 v162, v136, v137
    v_mfma_f32_16x16x32_bf16 v[144:147], a[0:3], a[144:147], v[144:147]
    buffer_load_dwordx4 v217, s[52:55], s82 offen offset:1024 lds
    v_mfma_f32_16x16x32_bf16 v[148:151], a[0:3], a[148:151], v[148:151]
    ds_read_b128 a[28:31], v239 offset:47104
    v_cvt_pk_bf16_f32 v163, v138, v139
    v_mfma_f32_16x16x32_bf16 v[152:155], a[4:7], a[144:147], v[152:155]
    v_cvt_pk_bf16_f32 v164, v132, v133
    v_cvt_pk_bf16_f32 v165, v134, v135
    v_mfma_f32_16x16x32_bf16 v[156:159], a[4:7], a[148:151], v[156:159]
    s_waitcnt lgkmcnt(4)
    ds_read_b128 a[0:3], v241 offset:45056
    v_cvt_pk_bf16_f32 v166, v140, v141
    v_mfma_f32_16x16x32_bf16 v[144:147], a[8:11], a[152:155], v[144:147]
    buffer_load_dwordx4 v218, s[52:55], s82 offen offset:2048 lds
    v_mfma_f32_16x16x32_bf16 v[148:151], a[8:11], a[156:159], v[148:151]
    ds_read_b128 a[4:7], v241 offset:47104
    v_cvt_pk_bf16_f32 v167, v142, v143
    v_mfma_f32_16x16x32_bf16 v[152:155], a[12:15], a[152:155], v[152:155]
    v_cvt_pk_bf16_f32 v191, v194, v195
    v_cvt_pk_bf16_f32 v192, v196, v197
    v_mfma_f32_16x16x32_bf16 v[156:159], a[12:15], a[156:159], v[156:159]
    s_waitcnt lgkmcnt(4)
    v_cvt_pk_bf16_f32 v193, v198, v199
    v_cvt_pk_bf16_f32 v194, v200, v201
    v_mfma_f32_16x16x32_bf16 v[144:147], a[16:19], a[160:163], v[144:147]
    s_waitcnt vmcnt(17)
    s_barrier
    v_cvt_pk_bf16_f32 v195, v202, v203
    v_mfma_f32_16x16x32_bf16 v[148:151], a[16:19], a[164:167], v[148:151]
    buffer_load_dwordx4 v219, s[52:55], s82 offen offset:3072 lds
    v_mfma_f32_16x16x32_bf16 v[152:155], a[20:23], a[160:163], v[152:155]
    s_add_u32 m0, s81, 147456
    ds_read_b64_tr_b16 a[8:9], v224 offset:16384
    v_mfma_f32_16x16x32_bf16 v[156:159], a[20:23], a[164:167], v[156:159]
    s_waitcnt lgkmcnt(3)
    ds_read_b64_tr_b16 a[10:11], v224 offset:18432
    v_mfma_f32_16x16x32_bf16 v[144:147], a[24:27], a[168:171], v[144:147]
    s_mov_b32 s82, 196608
    ds_read_b64_tr_b16 a[12:13], v226 offset:16384
    v_mfma_f32_16x16x32_bf16 v[148:151], a[24:27], a[172:175], v[148:151]
    s_mov_b32 s83, 14690304
    ds_read_b64_tr_b16 a[14:15], v226 offset:18432
    v_mfma_f32_16x16x32_bf16 v[152:155], a[28:31], a[168:171], v[152:155]
    buffer_load_dwordx4 v212, s[48:51], s82 offen offset:0 lds
    v_mfma_f32_16x16x32_bf16 v[156:159], a[28:31], a[172:175], v[156:159]
    s_waitcnt lgkmcnt(4)
    ds_read_b64_tr_b16 a[16:17], v228 offset:16384
    v_mfma_f32_16x16x32_bf16 v[144:147], a[0:3], a[176:179], v[144:147]
    ds_read_b64_tr_b16 a[18:19], v228 offset:18432
    v_mfma_f32_16x16x32_bf16 v[148:151], a[0:3], a[180:183], v[148:151]
    buffer_store_dwordx4 v[188:191], v211, s[64:67], s83 offen offset:0 sc1
    v_mfma_f32_16x16x32_bf16 v[152:155], a[4:7], a[176:179], v[152:155]
    ds_read_b64_tr_b16 a[20:21], v230 offset:16384
    v_mfma_f32_16x16x32_bf16 v[156:159], a[4:7], a[180:183], v[156:159]
    ds_read_b64_tr_b16 a[22:23], v230 offset:18432
    v_mfma_f32_16x16x32_bf16 v[168:171], v[184:187], v[160:163], v[168:171]
    buffer_load_dwordx4 v213, s[48:51], s82 offen offset:1024 lds
    v_mfma_f32_16x16x32_bf16 v[172:175], v[184:187], v[164:167], v[172:175]
    s_waitcnt lgkmcnt(4)
    ds_read_b64_tr_b16 a[24:25], v224 offset:20480
    ds_read_b64_tr_b16 a[26:27], v224 offset:22528
    v_mfma_f32_16x16x32_bf16 v[0:3], a[8:11], v[160:163], v[0:3]
    buffer_store_dwordx4 v[192:195], v211, s[64:67], s83 offen offset:1024 sc1
    v_mfma_f32_16x16x32_bf16 v[4:7], a[8:11], v[164:167], v[4:7]
    ds_read_b64_tr_b16 a[28:29], v226 offset:20480
    ds_read_b64_tr_b16 a[30:31], v226 offset:22528
    v_mfma_f32_16x16x32_bf16 v[8:11], a[12:15], v[160:163], v[8:11]
    ds_read_b64_tr_b16 a[0:1], v228 offset:20480
    ds_read_b64_tr_b16 a[2:3], v228 offset:22528
    v_mfma_f32_16x16x32_bf16 v[12:15], a[12:15], v[164:167], v[12:15]
    s_waitcnt lgkmcnt(6)
    buffer_load_dwordx4 v214, s[48:51], s82 offen offset:2048 lds
    v_mfma_f32_16x16x32_bf16 v[16:19], a[16:19], v[160:163], v[16:19]
    ds_read_b64_tr_b16 a[4:5], v230 offset:20480
    v_mfma_f32_16x16x32_bf16 v[20:23], a[16:19], v[164:167], v[20:23]
    ds_read_b64_tr_b16 a[6:7], v230 offset:22528
    v_mfma_f32_16x16x32_bf16 v[24:27], a[20:23], v[160:163], v[24:27]
    ds_read_b64_tr_b16 a[8:9], v224 offset:24576
    v_mfma_f32_16x16x32_bf16 v[28:31], a[20:23], v[164:167], v[28:31]
    s_waitcnt lgkmcnt(5)
    ds_read_b64_tr_b16 a[10:11], v224 offset:26624
    v_mfma_f32_16x16x32_bf16 v[32:35], a[24:27], v[160:163], v[32:35]
    buffer_load_dwordx4 v215, s[48:51], s82 offen offset:3072 lds
    v_mfma_f32_16x16x32_bf16 v[36:39], a[24:27], v[164:167], v[36:39]
    s_add_u32 m0, s81, 81920
    ds_read_b64_tr_b16 a[12:13], v226 offset:24576
    ds_read_b64_tr_b16 a[14:15], v226 offset:26624
    v_mfma_f32_16x16x32_bf16 v[40:43], a[28:31], v[160:163], v[40:43]
    s_mov_b32 s82, 180224
    ds_read_b64_tr_b16 a[16:17], v228 offset:24576
    v_mfma_f32_16x16x32_bf16 v[44:47], a[28:31], v[164:167], v[44:47]
    s_waitcnt lgkmcnt(5)
    ds_read_b64_tr_b16 a[18:19], v228 offset:26624
    v_mfma_f32_16x16x32_bf16 v[48:51], a[0:3], v[160:163], v[48:51]
    ds_read_b64_tr_b16 a[20:21], v230 offset:24576
    ds_read_b64_tr_b16 a[22:23], v230 offset:26624
    v_mfma_f32_16x16x32_bf16 v[52:55], a[0:3], v[164:167], v[52:55]
    buffer_load_dwordx4 v216, s[52:55], s82 offen offset:0 lds
    v_mfma_f32_16x16x32_bf16 v[56:59], a[4:7], v[160:163], v[56:59]
    ds_read_b64_tr_b16 a[24:25], v224 offset:28672
    v_mfma_f32_16x16x32_bf16 v[60:63], a[4:7], v[164:167], v[60:63]
    s_waitcnt lgkmcnt(5)
    ds_read_b64_tr_b16 a[26:27], v224 offset:30720
    v_mfma_f32_16x16x32_bf16 v[64:67], a[8:11], v[160:163], v[64:67]
    ds_read_b64_tr_b16 a[28:29], v226 offset:28672
    v_mfma_f32_16x16x32_bf16 v[68:71], a[8:11], v[164:167], v[68:71]
    ds_read_b64_tr_b16 a[30:31], v226 offset:30720
    v_mfma_f32_16x16x32_bf16 v[72:75], a[12:15], v[160:163], v[72:75]
    buffer_load_dwordx4 v217, s[52:55], s82 offen offset:1024 lds
    v_mfma_f32_16x16x32_bf16 v[76:79], a[12:15], v[164:167], v[76:79]
    s_waitcnt lgkmcnt(4)
    ds_read_b64_tr_b16 a[0:1], v228 offset:28672
    ds_read_b64_tr_b16 a[2:3], v228 offset:30720
    v_mfma_f32_16x16x32_bf16 v[80:83], a[16:19], v[160:163], v[80:83]
    ds_read_b64_tr_b16 a[4:5], v230 offset:28672
    v_mfma_f32_16x16x32_bf16 v[84:87], a[16:19], v[164:167], v[84:87]
    ds_read_b64_tr_b16 a[6:7], v230 offset:30720
    v_mfma_f32_16x16x32_bf16 v[88:91], a[20:23], v[160:163], v[88:91]
    ds_read_b64_tr_b16 a[8:9], v232 offset:32768
    ds_read_b64_tr_b16 a[10:11], v232 offset:34816
    v_mfma_f32_16x16x32_bf16 v[92:95], a[20:23], v[164:167], v[92:95]
    s_waitcnt lgkmcnt(6)
    buffer_load_dwordx4 v218, s[52:55], s82 offen offset:2048 lds
    v_mfma_f32_16x16x32_bf16 v[96:99], a[24:27], v[160:163], v[96:99]
    ds_read_b64_tr_b16 a[12:13], v232 offset:36864
    v_mfma_f32_16x16x32_bf16 v[100:103], a[24:27], v[164:167], v[100:103]
    ds_read_b64_tr_b16 a[14:15], v232 offset:38912
    v_mfma_f32_16x16x32_bf16 v[104:107], a[28:31], v[160:163], v[104:107]
    ds_read_b64_tr_b16 a[16:17], v232 offset:40960
    v_mfma_f32_16x16x32_bf16 v[108:111], a[28:31], v[164:167], v[108:111]
    s_waitcnt lgkmcnt(5)
    ds_read_b64_tr_b16 a[18:19], v232 offset:43008
    v_mfma_f32_16x16x32_bf16 v[112:115], a[0:3], v[160:163], v[112:115]
    buffer_load_dwordx4 v219, s[52:55], s82 offen offset:3072 lds
    v_mfma_f32_16x16x32_bf16 v[116:119], a[0:3], v[164:167], v[116:119]
    v_exp_f32 v144, v144
    v_mfma_f32_16x16x32_bf16 v[120:123], a[4:7], v[160:163], v[120:123]
    ds_read_b64_tr_b16 a[20:21], v232 offset:45056
    v_mfma_f32_16x16x32_bf16 v[124:127], a[4:7], v[164:167], v[124:127]
    s_waitcnt lgkmcnt(5)
    ds_read_b64_tr_b16 a[22:23], v232 offset:47104
    v_mfma_f32_16x16x32_bf16 v[188:191], a[8:11], a[64:67], 0
    v_exp_f32 v145, v145
    v_mfma_f32_16x16x32_bf16 v[192:195], a[8:11], a[68:71], 0
    v_exp_f32 v146, v146
    v_mfma_f32_16x16x32_bf16 v[196:199], a[8:11], a[72:75], 0
    ds_read_b64_tr_b16 a[24:25], v232 offset:49152
    v_mfma_f32_16x16x32_bf16 v[200:203], a[8:11], a[76:79], 0
    s_waitcnt lgkmcnt(5)
    ds_read_b64_tr_b16 a[26:27], v232 offset:51200
    v_mfma_f32_16x16x32_bf16 v[188:191], a[12:15], a[80:83], v[188:191]
    v_exp_f32 v147, v147
    v_mfma_f32_16x16x32_bf16 v[192:195], a[12:15], a[84:87], v[192:195]
    v_exp_f32 v148, v148
    v_mfma_f32_16x16x32_bf16 v[196:199], a[12:15], a[88:91], v[196:199]
    ds_read_b64_tr_b16 a[28:29], v232 offset:53248
    v_mfma_f32_16x16x32_bf16 v[200:203], a[12:15], a[92:95], v[200:203]
    s_waitcnt lgkmcnt(5)
    ds_read_b64_tr_b16 a[30:31], v232 offset:55296
    v_mfma_f32_16x16x32_bf16 v[188:191], a[16:19], a[96:99], v[188:191]
    s_add_u32 m0, s81, 98304
    s_mov_b32 s82, 212992
    v_mfma_f32_16x16x32_bf16 v[192:195], a[16:19], a[100:103], v[192:195]
    v_exp_f32 v149, v149
    v_mfma_f32_16x16x32_bf16 v[196:199], a[16:19], a[104:107], v[196:199]
    ds_read_b64_tr_b16 a[0:1], v232 offset:57344
    v_mfma_f32_16x16x32_bf16 v[200:203], a[16:19], a[108:111], v[200:203]
    s_waitcnt lgkmcnt(5)
    ds_read_b64_tr_b16 a[2:3], v232 offset:59392
    v_mfma_f32_16x16x32_bf16 v[188:191], a[20:23], a[112:115], v[188:191]
    v_exp_f32 v150, v150
    v_mfma_f32_16x16x32_bf16 v[192:195], a[20:23], a[116:119], v[192:195]
    v_exp_f32 v151, v151
    v_mfma_f32_16x16x32_bf16 v[196:199], a[20:23], a[32:35], v[196:199]
    s_waitcnt vmcnt(22)
    s_barrier
    v_mfma_f32_16x16x32_bf16 v[200:203], a[20:23], a[36:39], v[200:203]
    s_waitcnt lgkmcnt(4)
    buffer_load_dwordx4 v212, s[48:51], s82 offen offset:0 lds
    v_mfma_f32_16x16x32_bf16 v[188:191], a[24:27], a[40:43], v[188:191]
    ds_read_b128 a[4:7], v239 offset:49152
    v_mfma_f32_16x16x32_bf16 v[192:195], a[24:27], a[44:47], v[192:195]
    ds_read_b128 a[8:11], v239 offset:51200
    v_mfma_f32_16x16x32_bf16 v[196:199], a[24:27], a[48:51], v[196:199]
    ds_read_b128 a[12:15], v241 offset:49152
    v_mfma_f32_16x16x32_bf16 v[200:203], a[24:27], a[52:55], v[200:203]
    s_waitcnt lgkmcnt(5)
    v_exp_f32 v152, v152
    v_mfma_f32_16x16x32_bf16 v[188:191], a[28:31], a[56:59], v[188:191]
    buffer_load_dwordx4 v213, s[48:51], s82 offen offset:1024 lds
    v_mfma_f32_16x16x32_bf16 v[192:195], a[28:31], a[60:63], v[192:195]
    ds_read_b128 a[16:19], v241 offset:51200
    v_mfma_f32_16x16x32_bf16 v[196:199], a[28:31], a[184:187], v[196:199]
    ds_read_b128 a[20:23], v239 offset:53248
    v_mfma_f32_16x16x32_bf16 v[200:203], a[28:31], a[188:191], v[200:203]
    s_waitcnt lgkmcnt(5)
    v_exp_f32 v153, v153
    v_mfma_f32_16x16x32_bf16 v[188:191], a[0:3], a[192:195], v[188:191]
    buffer_load_dwordx4 v214, s[48:51], s82 offen offset:2048 lds
    v_mfma_f32_16x16x32_bf16 v[192:195], a[0:3], a[196:199], v[192:195]
    ds_read_b128 a[24:27], v239 offset:55296
    v_mfma_f32_16x16x32_bf16 v[196:199], a[0:3], a[200:203], v[196:199]
    ds_read_b128 a[28:31], v241 offset:53248
    v_mfma_f32_16x16x32_bf16 v[200:203], a[0:3], a[204:207], v[200:203]
    s_waitcnt lgkmcnt(5)
    v_exp_f32 v154, v154
    v_mfma_f32_16x16x32_bf16 v[128:131], a[4:7], a[120:123], v[176:179]
    ds_read_b128 a[0:3], v241 offset:55296
    v_mfma_f32_16x16x32_bf16 v[132:135], a[4:7], a[124:127], v[180:183]
    buffer_load_dwordx4 v215, s[48:51], s82 offen offset:3072 lds
    v_mfma_f32_16x16x32_bf16 v[136:139], a[8:11], a[120:123], v[176:179]
    ds_read_b128 a[4:7], v239 offset:57344
    v_cvt_pk_bf16_f32 v188, v188, v189
    v_mfma_f32_16x16x32_bf16 v[140:143], a[8:11], a[124:127], v[180:183]
    s_waitcnt lgkmcnt(5)
    v_exp_f32 v155, v155
    v_mfma_f32_16x16x32_bf16 v[128:131], a[12:15], a[128:131], v[128:131]
    ds_read_b128 a[8:11], v239 offset:59392
    v_cvt_pk_bf16_f32 v189, v190, v191
    v_mfma_f32_16x16x32_bf16 v[132:135], a[12:15], a[132:135], v[132:135]
    v_exp_f32 v156, v156
    v_mfma_f32_16x16x32_bf16 v[136:139], a[16:19], a[128:131], v[136:139]
    ds_read_b128 a[12:15], v241 offset:57344
    v_cvt_pk_bf16_f32 v190, v192, v193
    v_mfma_f32_16x16x32_bf16 v[140:143], a[16:19], a[132:135], v[140:143]
    s_waitcnt lgkmcnt(5)
    v_exp_f32 v157, v157
    v_mfma_f32_16x16x32_bf16 v[128:131], a[20:23], a[136:139], v[128:131]
    ds_read_b128 a[16:19], v241 offset:59392
    v_cvt_pk_bf16_f32 v191, v194, v195
    v_mfma_f32_16x16x32_bf16 v[132:135], a[20:23], a[140:143], v[132:135]
    v_exp_f32 v158, v158
    v_mfma_f32_16x16x32_bf16 v[136:139], a[24:27], a[136:139], v[136:139]
    ds_read_b128 a[20:23], v239 offset:61440
    v_cvt_pk_bf16_f32 v192, v196, v197
    v_mfma_f32_16x16x32_bf16 v[140:143], a[24:27], a[140:143], v[140:143]
    s_waitcnt lgkmcnt(5)
    v_exp_f32 v159, v159
    v_mfma_f32_16x16x32_bf16 v[128:131], a[28:31], a[144:147], v[128:131]
    ds_read_b128 a[24:27], v239 offset:63488
    v_cvt_pk_bf16_f32 v160, v144, v145
    v_mfma_f32_16x16x32_bf16 v[132:135], a[28:31], a[148:151], v[132:135]
    v_cvt_pk_bf16_f32 v161, v146, v147
    v_cvt_pk_bf16_f32 v162, v152, v153
    v_mfma_f32_16x16x32_bf16 v[136:139], a[0:3], a[144:147], v[136:139]
    ds_read_b128 a[28:31], v241 offset:61440
    v_cvt_pk_bf16_f32 v163, v154, v155
    v_mfma_f32_16x16x32_bf16 v[140:143], a[0:3], a[148:151], v[140:143]
    s_waitcnt lgkmcnt(5)
    v_cvt_pk_bf16_f32 v164, v148, v149
    v_cvt_pk_bf16_f32 v165, v150, v151
    v_mfma_f32_16x16x32_bf16 v[128:131], a[4:7], a[152:155], v[128:131]
    ds_read_b128 a[0:3], v241 offset:63488
    v_cvt_pk_bf16_f32 v166, v156, v157
    v_mfma_f32_16x16x32_bf16 v[132:135], a[4:7], a[156:159], v[132:135]
    v_cvt_pk_bf16_f32 v167, v158, v159
    v_cvt_pk_bf16_f32 v193, v198, v199
    v_mfma_f32_16x16x32_bf16 v[136:139], a[8:11], a[152:155], v[136:139]
    v_cvt_pk_bf16_f32 v194, v200, v201
    v_cvt_pk_bf16_f32 v195, v202, v203
    v_mfma_f32_16x16x32_bf16 v[140:143], a[8:11], a[156:159], v[140:143]
    s_waitcnt lgkmcnt(4)
    s_mov_b32 s83, 14692352
    v_mfma_f32_16x16x32_bf16 v[128:131], a[12:15], a[160:163], v[128:131]
    s_waitcnt vmcnt(22)
    s_barrier
    v_mfma_f32_16x16x32_bf16 v[132:135], a[12:15], a[164:167], v[132:135]
    ds_read_b64_tr_b16 a[4:5], v204 offset:0
    v_mfma_f32_16x16x32_bf16 v[136:139], a[16:19], a[160:163], v[136:139]
    ds_read_b64_tr_b16 a[6:7], v204 offset:2048
    v_mfma_f32_16x16x32_bf16 v[140:143], a[16:19], a[164:167], v[140:143]
    s_waitcnt lgkmcnt(4)
    ds_read_b64_tr_b16 a[8:9], v205 offset:0
    v_mfma_f32_16x16x32_bf16 v[128:131], a[20:23], a[168:171], v[128:131]
    ds_read_b64_tr_b16 a[10:11], v205 offset:2048
    v_mfma_f32_16x16x32_bf16 v[132:135], a[20:23], a[172:175], v[132:135]
    ds_read_b64_tr_b16 a[12:13], v254 offset:0
    v_mfma_f32_16x16x32_bf16 v[136:139], a[24:27], a[168:171], v[136:139]
    ds_read_b64_tr_b16 a[14:15], v254 offset:2048
    v_mfma_f32_16x16x32_bf16 v[140:143], a[24:27], a[172:175], v[140:143]
    s_waitcnt lgkmcnt(6)
    ds_read_b64_tr_b16 a[16:17], v236 offset:0
    v_mfma_f32_16x16x32_bf16 v[128:131], a[28:31], a[176:179], v[128:131]
    ds_read_b64_tr_b16 a[18:19], v236 offset:2048
    v_mfma_f32_16x16x32_bf16 v[132:135], a[28:31], a[180:183], v[132:135]
    ds_read_b64_tr_b16 a[20:21], v204 offset:4096
    v_mfma_f32_16x16x32_bf16 v[136:139], a[0:3], a[176:179], v[136:139]
    ds_read_b64_tr_b16 a[22:23], v204 offset:6144
    v_mfma_f32_16x16x32_bf16 v[140:143], a[0:3], a[180:183], v[140:143]
    ds_read_b64_tr_b16 a[24:25], v205 offset:4096
    v_mfma_f32_16x16x32_bf16 v[168:171], v[184:187], v[160:163], v[168:171]
    ds_read_b64_tr_b16 a[26:27], v205 offset:6144
    v_mfma_f32_16x16x32_bf16 v[172:175], v[184:187], v[164:167], v[172:175]
    s_waitcnt lgkmcnt(8)
    ds_read_b64_tr_b16 a[28:29], v254 offset:4096
    v_mfma_f32_16x16x32_bf16 v[0:3], a[4:7], v[160:163], v[0:3]
    buffer_store_dwordx4 v[188:191], v211, s[64:67], s83 offen offset:0 sc1
    v_mfma_f32_16x16x32_bf16 v[4:7], a[4:7], v[164:167], v[4:7]
    ds_read_b64_tr_b16 a[30:31], v254 offset:6144
    v_mfma_f32_16x16x32_bf16 v[8:11], a[8:11], v[160:163], v[8:11]
    buffer_store_dwordx4 v[192:195], v211, s[64:67], s83 offen offset:1024 sc1
    v_mfma_f32_16x16x32_bf16 v[12:15], a[8:11], v[164:167], v[12:15]
    s_waitcnt lgkmcnt(6)
    ds_read_b64_tr_b16 a[0:1], v236 offset:4096
    v_mfma_f32_16x16x32_bf16 v[16:19], a[12:15], v[160:163], v[16:19]
    ds_read_b64_tr_b16 a[2:3], v236 offset:6144
    v_mfma_f32_16x16x32_bf16 v[20:23], a[12:15], v[164:167], v[20:23]
    ds_read_b64_tr_b16 a[4:5], v204 offset:8192
    v_mfma_f32_16x16x32_bf16 v[24:27], a[16:19], v[160:163], v[24:27]
    s_mov_b32 s84, s79
    ds_read_b64_tr_b16 a[6:7], v204 offset:10240
    v_mfma_f32_16x16x32_bf16 v[28:31], a[16:19], v[164:167], v[28:31]
    s_waitcnt lgkmcnt(6)
    ds_read_b64_tr_b16 a[8:9], v205 offset:8192
    v_mfma_f32_16x16x32_bf16 v[32:35], a[20:23], v[160:163], v[32:35]
    s_mov_b32 s85, s76
    ds_read_b64_tr_b16 a[10:11], v205 offset:10240
    v_lshrrev_b32 v199, 4, v251
    v_mfma_f32_16x16x32_bf16 v[36:39], a[20:23], v[164:167], v[36:39]
    ds_read_b64_tr_b16 a[12:13], v254 offset:8192
    v_lshlrev_b32 v199, 3, v199
    v_mfma_f32_16x16x32_bf16 v[40:43], a[24:27], v[160:163], v[40:43]
    s_mul_i32 s86, s84, 7
    ds_read_b64_tr_b16 a[14:15], v254 offset:10240
    v_mfma_f32_16x16x32_bf16 v[44:47], a[24:27], v[164:167], v[44:47]
    s_waitcnt lgkmcnt(6)
    ds_read_b64_tr_b16 a[16:17], v236 offset:8192
    v_mfma_f32_16x16x32_bf16 v[48:51], a[28:31], v[160:163], v[48:51]
    s_add_u32 m0, s81, 114688
    ds_read_b64_tr_b16 a[18:19], v236 offset:10240
    v_mfma_f32_16x16x32_bf16 v[52:55], a[28:31], v[164:167], v[52:55]
    s_mov_b32 s82, 196608
    ds_read_b64_tr_b16 a[20:21], v204 offset:12288
    v_mfma_f32_16x16x32_bf16 v[56:59], a[0:3], v[160:163], v[56:59]
    s_add_u32 s86, s86, s85
    ds_read_b64_tr_b16 a[22:23], v204 offset:14336
    v_mfma_f32_16x16x32_bf16 v[60:63], a[0:3], v[164:167], v[60:63]
    s_waitcnt lgkmcnt(6)
    ds_read_b64_tr_b16 a[24:25], v205 offset:12288
    v_mfma_f32_16x16x32_bf16 v[64:67], a[4:7], v[160:163], v[64:67]
    s_mul_i32 s87, s80, 56
    ds_read_b64_tr_b16 a[26:27], v205 offset:14336
    v_mfma_f32_16x16x32_bf16 v[68:71], a[4:7], v[164:167], v[68:71]
    s_add_u32 s87, s87, s86
    ds_read_b64_tr_b16 a[28:29], v254 offset:12288
    v_mfma_f32_16x16x32_bf16 v[72:75], a[8:11], v[160:163], v[72:75]
    s_waitcnt vmcnt(16)
    s_barrier
    ds_read_b64_tr_b16 a[30:31], v254 offset:14336
    v_mfma_f32_16x16x32_bf16 v[76:79], a[8:11], v[164:167], v[76:79]
    s_waitcnt lgkmcnt(6)
    buffer_load_dwordx4 v216, s[52:55], s82 offen offset:0 lds
    v_mfma_f32_16x16x32_bf16 v[80:83], a[12:15], v[160:163], v[80:83]
    s_lshl_b32 s87, s87, 10
    v_exp_f32 v128, v128
    v_mfma_f32_16x16x32_bf16 v[84:87], a[12:15], v[164:167], v[84:87]
    ds_read_b64_tr_b16 a[0:1], v236 offset:12288
    ds_read_b64_tr_b16 a[2:3], v236 offset:14336
    v_add_u32 v207, s87, v253
    v_mfma_f32_16x16x32_bf16 v[88:91], a[16:19], v[160:163], v[88:91]
    s_mul_i32 s87, s86, 4682
    v_exp_f32 v129, v129
    v_mfma_f32_16x16x32_bf16 v[92:95], a[16:19], v[164:167], v[92:95]
    s_waitcnt lgkmcnt(4)
    ds_read_b128 a[4:7], v238 offset:0
    v_mfma_f32_16x16x32_bf16 v[96:99], a[20:23], v[160:163], v[96:99]
    buffer_load_dwordx4 v217, s[52:55], s82 offen offset:1024 lds
    v_mfma_f32_16x16x32_bf16 v[100:103], a[20:23], v[164:167], v[100:103]
    s_lshr_b32 s87, s87, 16
    ds_read_b128 a[8:11], v238 offset:2048
    v_mfma_f32_16x16x32_bf16 v[104:107], a[24:27], v[160:163], v[104:107]
    s_mul_i32 s78, s87, 14
    v_exp_f32 v130, v130
    v_mfma_f32_16x16x32_bf16 v[108:111], a[24:27], v[164:167], v[108:111]
    s_waitcnt lgkmcnt(2)
    ds_read_b128 a[12:15], v240 offset:0
    v_mfma_f32_16x16x32_bf16 v[112:115], a[28:31], v[160:163], v[112:115]
    s_sub_u32 s86, s86, s78
    ds_read_b128 a[16:19], v240 offset:2048
    v_mfma_f32_16x16x32_bf16 v[116:119], a[28:31], v[164:167], v[116:119]
    buffer_load_dwordx4 v218, s[52:55], s82 offen offset:2048 lds
    v_mfma_f32_16x16x32_bf16 v[120:123], a[0:3], v[160:163], v[120:123]
    s_lshl_b32 s87, s87, 5
    v_exp_f32 v131, v131
    v_mfma_f32_16x16x32_bf16 v[124:127], a[0:3], v[164:167], v[124:127]
    s_waitcnt lgkmcnt(2)
    ds_read_b128 a[20:23], v238 offset:4096
    v_mfma_f32_16x16x32_bf16 v[144:147], a[4:7], a[120:123], v[176:179]
    s_lshr_b32 s78, s86, 1
    v_exp_f32 v132, v132
    v_mfma_f32_16x16x32_bf16 v[148:151], a[4:7], a[124:127], v[180:183]
    s_lshl_b32 s78, s78, 7
    ds_read_b128 a[24:27], v238 offset:6144
    v_mfma_f32_16x16x32_bf16 v[152:155], a[8:11], a[120:123], v[176:179]
    buffer_load_dwordx4 v219, s[52:55], s82 offen offset:3072 lds
    v_mfma_f32_16x16x32_bf16 v[156:159], a[8:11], a[124:127], v[180:183]
    s_waitcnt lgkmcnt(2)
    ds_read_b128 a[28:31], v240 offset:4096
    v_mfma_f32_16x16x32_bf16 v[144:147], a[12:15], a[128:131], v[144:147]
    s_add_u32 s87, s87, s78
    v_exp_f32 v133, v133
    v_mfma_f32_16x16x32_bf16 v[148:151], a[12:15], a[132:135], v[148:151]
    ds_read_b128 a[0:3], v240 offset:6144
    v_add_u32 v196, s87, v199
    v_mfma_f32_16x16x32_bf16 v[152:155], a[16:19], a[128:131], v[152:155]
    s_mul_i32 s86, s84, 7
    v_exp_f32 v134, v134
    v_mfma_f32_16x16x32_bf16 v[156:159], a[16:19], a[132:135], v[156:159]
    s_waitcnt lgkmcnt(2)
    ds_read_b128 a[4:7], v238 offset:8192
    v_mfma_f32_16x16x32_bf16 v[144:147], a[20:23], a[136:139], v[144:147]
    s_add_u32 s86, s86, s85
    v_exp_f32 v135, v135
    v_mfma_f32_16x16x32_bf16 v[148:151], a[20:23], a[140:143], v[148:151]
    s_add_u32 s86, s86, 4
    ds_read_b128 a[8:11], v238 offset:10240
    v_mfma_f32_16x16x32_bf16 v[152:155], a[24:27], a[136:139], v[152:155]
    s_mul_i32 s87, s80, 56
    v_exp_f32 v136, v136
    v_mfma_f32_16x16x32_bf16 v[156:159], a[24:27], a[140:143], v[156:159]
    s_waitcnt lgkmcnt(2)
    ds_read_b128 a[12:15], v240 offset:8192
    v_mfma_f32_16x16x32_bf16 v[144:147], a[28:31], a[144:147], v[144:147]
    s_add_u32 s87, s87, s86
    v_exp_f32 v137, v137
    v_mfma_f32_16x16x32_bf16 v[148:151], a[28:31], a[148:151], v[148:151]
    s_lshl_b32 s87, s87, 10
    ds_read_b128 a[16:19], v240 offset:10240
    v_mfma_f32_16x16x32_bf16 v[152:155], a[0:3], a[144:147], v[152:155]
    s_lshl_b32 s35, s85, 29
    v_exp_f32 v138, v138
    v_mfma_f32_16x16x32_bf16 v[156:159], a[0:3], a[148:151], v[156:159]
    s_waitcnt lgkmcnt(2)
    ds_read_b128 a[20:23], v238 offset:12288
    v_mfma_f32_16x16x32_bf16 v[144:147], a[4:7], a[152:155], v[144:147]
    s_lshl_b32 s78, s85, 30
    v_exp_f32 v139, v139
    v_mfma_f32_16x16x32_bf16 v[148:151], a[4:7], a[156:159], v[148:151]
    s_and_b32 s35, s35, s78
    ds_read_b128 a[24:27], v238 offset:14336
    v_mfma_f32_16x16x32_bf16 v[152:155], a[8:11], a[152:155], v[152:155]
    s_add_u32 s87, s87, s35
    v_exp_f32 v140, v140
    v_mfma_f32_16x16x32_bf16 v[156:159], a[8:11], a[156:159], v[156:159]
    s_waitcnt lgkmcnt(2)
    ds_read_b128 a[28:31], v240 offset:12288
    v_add_u32 v208, s87, v253
    v_mfma_f32_16x16x32_bf16 v[144:147], a[12:15], a[160:163], v[144:147]
    s_mul_i32 s87, s86, 4682
    v_exp_f32 v141, v141
    v_mfma_f32_16x16x32_bf16 v[148:151], a[12:15], a[164:167], v[148:151]
    s_lshr_b32 s87, s87, 16
    ds_read_b128 a[0:3], v240 offset:14336
    v_mfma_f32_16x16x32_bf16 v[152:155], a[16:19], a[160:163], v[152:155]
    s_mul_i32 s78, s87, 14
    v_exp_f32 v142, v142
    v_mfma_f32_16x16x32_bf16 v[156:159], a[16:19], a[164:167], v[156:159]
    s_waitcnt lgkmcnt(2)
    v_exp_f32 v143, v143
    v_mfma_f32_16x16x32_bf16 v[144:147], a[20:23], a[168:171], v[144:147]
    s_sub_u32 s86, s86, s78
    v_cvt_pk_bf16_f32 v160, v128, v129
    v_cvt_pk_bf16_f32 v161, v130, v131
    v_mfma_f32_16x16x32_bf16 v[148:151], a[20:23], a[172:175], v[148:151]
    s_lshl_b32 s87, s87, 5
    ds_read_b64_tr_b16 a[4:5], v225 offset:0
    ds_read_b64_tr_b16 a[6:7], v225 offset:2048
    v_cvt_pk_bf16_f32 v162, v136, v137
    v_mfma_f32_16x16x32_bf16 v[152:155], a[24:27], a[168:171], v[152:155]
    s_lshr_b32 s78, s86, 1
    ds_read_b64_tr_b16 a[8:9], v227 offset:0
    v_cvt_pk_bf16_f32 v163, v138, v139
    v_mfma_f32_16x16x32_bf16 v[156:159], a[24:27], a[172:175], v[156:159]
    s_waitcnt lgkmcnt(3)
    ds_read_b64_tr_b16 a[10:11], v227 offset:2048
    v_cvt_pk_bf16_f32 v164, v132, v133
    v_mfma_f32_16x16x32_bf16 v[144:147], a[28:31], a[176:179], v[144:147]
    s_lshl_b32 s78, s78, 7
    ds_read_b64_tr_b16 a[12:13], v229 offset:0
    v_cvt_pk_bf16_f32 v165, v134, v135
    v_mfma_f32_16x16x32_bf16 v[148:151], a[28:31], a[180:183], v[148:151]
    s_add_u32 s87, s87, s78
    ds_read_b64_tr_b16 a[14:15], v229 offset:2048
    v_cvt_pk_bf16_f32 v166, v140, v141
    v_mfma_f32_16x16x32_bf16 v[152:155], a[0:3], a[176:179], v[152:155]
    ds_read_b64_tr_b16 a[16:17], v231 offset:0
    v_cvt_pk_bf16_f32 v167, v142, v143
    v_mfma_f32_16x16x32_bf16 v[156:159], a[0:3], a[180:183], v[156:159]
    ds_read_b64_tr_b16 a[18:19], v231 offset:2048
    v_add_u32 v197, s87, v199
    v_mfma_f32_16x16x32_bf16 v[168:171], v[184:187], v[160:163], v[168:171]
    ds_read_b64_tr_b16 a[20:21], v225 offset:4096
    v_mfma_f32_16x16x32_bf16 v[172:175], v[184:187], v[164:167], v[172:175]
    s_waitcnt lgkmcnt(5)
    ds_read_b64_tr_b16 a[22:23], v225 offset:6144
    v_mfma_f32_16x16x32_bf16 v[0:3], a[4:7], v[160:163], v[0:3]
    ds_read_b64_tr_b16 a[24:25], v227 offset:4096
    v_mfma_f32_16x16x32_bf16 v[4:7], a[4:7], v[164:167], v[4:7]
    ds_read_b64_tr_b16 a[26:27], v227 offset:6144
    v_mfma_f32_16x16x32_bf16 v[8:11], a[8:11], v[160:163], v[8:11]
    ds_read_b64_tr_b16 a[28:29], v229 offset:4096
    v_mfma_f32_16x16x32_bf16 v[12:15], a[8:11], v[164:167], v[12:15]
    s_waitcnt lgkmcnt(5)
    ds_read_b64_tr_b16 a[30:31], v229 offset:6144
    v_mfma_f32_16x16x32_bf16 v[16:19], a[12:15], v[160:163], v[16:19]
    ds_read_b64_tr_b16 a[0:1], v231 offset:4096
    v_mfma_f32_16x16x32_bf16 v[20:23], a[12:15], v[164:167], v[20:23]
    ds_read_b64_tr_b16 a[2:3], v231 offset:6144
    v_mfma_f32_16x16x32_bf16 v[24:27], a[16:19], v[160:163], v[24:27]
    ds_read_b64_tr_b16 a[4:5], v225 offset:8192
    v_mfma_f32_16x16x32_bf16 v[28:31], a[16:19], v[164:167], v[28:31]
    s_waitcnt lgkmcnt(5)
    ds_read_b64_tr_b16 a[6:7], v225 offset:10240
    v_mfma_f32_16x16x32_bf16 v[32:35], a[20:23], v[160:163], v[32:35]
    ds_read_b64_tr_b16 a[8:9], v227 offset:8192
    v_mfma_f32_16x16x32_bf16 v[36:39], a[20:23], v[164:167], v[36:39]
    ds_read_b64_tr_b16 a[10:11], v227 offset:10240
    v_mfma_f32_16x16x32_bf16 v[40:43], a[24:27], v[160:163], v[40:43]
    ds_read_b64_tr_b16 a[12:13], v229 offset:8192
    v_mfma_f32_16x16x32_bf16 v[44:47], a[24:27], v[164:167], v[44:47]
    s_waitcnt lgkmcnt(5)
    ds_read_b64_tr_b16 a[14:15], v229 offset:10240
    v_mfma_f32_16x16x32_bf16 v[48:51], a[28:31], v[160:163], v[48:51]
    s_add_u32 m0, s81, 131072
    ds_read_b64_tr_b16 a[16:17], v231 offset:8192
    v_mfma_f32_16x16x32_bf16 v[52:55], a[28:31], v[164:167], v[52:55]
    s_mov_b32 s82, 229376
    ds_read_b64_tr_b16 a[18:19], v231 offset:10240
    v_mfma_f32_16x16x32_bf16 v[56:59], a[0:3], v[160:163], v[56:59]
    ds_read_b64_tr_b16 a[20:21], v225 offset:12288
    v_mfma_f32_16x16x32_bf16 v[60:63], a[0:3], v[164:167], v[60:63]
    s_waitcnt lgkmcnt(5)
    ds_read_b64_tr_b16 a[22:23], v225 offset:14336
    v_mfma_f32_16x16x32_bf16 v[64:67], a[4:7], v[160:163], v[64:67]
    v_exp_f32 v144, v144
    v_mfma_f32_16x16x32_bf16 v[68:71], a[4:7], v[164:167], v[68:71]
    ds_read_b64_tr_b16 a[24:25], v227 offset:12288
    ds_read_b64_tr_b16 a[26:27], v227 offset:14336
    v_mfma_f32_16x16x32_bf16 v[72:75], a[8:11], v[160:163], v[72:75]
    s_waitcnt vmcnt(4)
    s_barrier
    ds_read_b64_tr_b16 a[28:29], v229 offset:12288
    ds_read_b64_tr_b16 a[30:31], v229 offset:14336
    v_mfma_f32_16x16x32_bf16 v[76:79], a[8:11], v[164:167], v[76:79]
    s_waitcnt lgkmcnt(6)
    buffer_load_dwordx4 v212, s[48:51], s82 offen offset:0 lds
    v_mfma_f32_16x16x32_bf16 v[80:83], a[12:15], v[160:163], v[80:83]
    v_exp_f32 v145, v145
    v_mfma_f32_16x16x32_bf16 v[84:87], a[12:15], v[164:167], v[84:87]
    ds_read_b64_tr_b16 a[0:1], v231 offset:12288
    ds_read_b64_tr_b16 a[2:3], v231 offset:14336
    v_mfma_f32_16x16x32_bf16 v[88:91], a[16:19], v[160:163], v[88:91]
    buffer_store_dwordx2 v[246:247], v244, s[68:71], 0 offen offset:64 sc1
    v_mfma_f32_16x16x32_bf16 v[92:95], a[16:19], v[164:167], v[92:95]
    s_waitcnt lgkmcnt(4)
    ds_read_b128 a[4:7], v235 offset:16384
    v_mfma_f32_16x16x32_bf16 v[96:99], a[20:23], v[160:163], v[96:99]
    buffer_load_dwordx4 v213, s[48:51], s82 offen offset:1024 lds
    v_mfma_f32_16x16x32_bf16 v[100:103], a[20:23], v[164:167], v[100:103]
    ds_read_b128 a[8:11], v235 offset:18432
    v_mfma_f32_16x16x32_bf16 v[104:107], a[24:27], v[160:163], v[104:107]
    v_exp_f32 v146, v146
    v_mfma_f32_16x16x32_bf16 v[108:111], a[24:27], v[164:167], v[108:111]
    s_waitcnt lgkmcnt(2)
    ds_read_b128 a[12:15], v237 offset:16384
    v_mfma_f32_16x16x32_bf16 v[112:115], a[28:31], v[160:163], v[112:115]
    ds_read_b128 a[16:19], v237 offset:18432
    v_mfma_f32_16x16x32_bf16 v[116:119], a[28:31], v[164:167], v[116:119]
    buffer_load_dwordx4 v214, s[48:51], s82 offen offset:2048 lds
    v_mfma_f32_16x16x32_bf16 v[120:123], a[0:3], v[160:163], v[120:123]
    v_exp_f32 v147, v147
    v_mfma_f32_16x16x32_bf16 v[124:127], a[0:3], v[164:167], v[124:127]
    s_waitcnt lgkmcnt(2)
    ds_read_b128 a[20:23], v235 offset:20480
    v_mfma_f32_16x16x32_bf16 v[128:131], a[4:7], a[120:123], v[176:179]
    v_exp_f32 v148, v148
    v_mfma_f32_16x16x32_bf16 v[132:135], a[4:7], a[124:127], v[180:183]
    ds_read_b128 a[24:27], v235 offset:22528
    v_mfma_f32_16x16x32_bf16 v[136:139], a[8:11], a[120:123], v[176:179]
    buffer_load_dwordx4 v215, s[48:51], s82 offen offset:3072 lds
    v_mfma_f32_16x16x32_bf16 v[140:143], a[8:11], a[124:127], v[180:183]
    s_waitcnt lgkmcnt(2)
    ds_read_b128 a[28:31], v237 offset:20480
    v_mfma_f32_16x16x32_bf16 v[128:131], a[12:15], a[128:131], v[128:131]
    v_exp_f32 v149, v149
    v_mfma_f32_16x16x32_bf16 v[132:135], a[12:15], a[132:135], v[132:135]
    ds_read_b128 a[0:3], v237 offset:22528
    v_mfma_f32_16x16x32_bf16 v[136:139], a[16:19], a[128:131], v[136:139]
    v_exp_f32 v150, v150
    v_mfma_f32_16x16x32_bf16 v[140:143], a[16:19], a[132:135], v[140:143]
    s_waitcnt lgkmcnt(2)
    ds_read_b128 a[4:7], v235 offset:24576
    v_mfma_f32_16x16x32_bf16 v[128:131], a[20:23], a[136:139], v[128:131]
    v_exp_f32 v151, v151
    v_mfma_f32_16x16x32_bf16 v[132:135], a[20:23], a[140:143], v[132:135]
    ds_read_b128 a[8:11], v235 offset:26624
    v_mfma_f32_16x16x32_bf16 v[136:139], a[24:27], a[136:139], v[136:139]
    v_exp_f32 v152, v152
    v_mfma_f32_16x16x32_bf16 v[140:143], a[24:27], a[140:143], v[140:143]
    s_waitcnt lgkmcnt(2)
    ds_read_b128 a[12:15], v237 offset:24576
    v_mfma_f32_16x16x32_bf16 v[128:131], a[28:31], a[144:147], v[128:131]
    v_exp_f32 v153, v153
    v_mfma_f32_16x16x32_bf16 v[132:135], a[28:31], a[148:151], v[132:135]
    ds_read_b128 a[16:19], v237 offset:26624
    v_mfma_f32_16x16x32_bf16 v[136:139], a[0:3], a[144:147], v[136:139]
    v_exp_f32 v154, v154
    v_mfma_f32_16x16x32_bf16 v[140:143], a[0:3], a[148:151], v[140:143]
    s_waitcnt lgkmcnt(2)
    ds_read_b128 a[20:23], v235 offset:28672
    v_mfma_f32_16x16x32_bf16 v[128:131], a[4:7], a[152:155], v[128:131]
    v_exp_f32 v155, v155
    v_mfma_f32_16x16x32_bf16 v[132:135], a[4:7], a[156:159], v[132:135]
    ds_read_b128 a[24:27], v235 offset:30720
    v_mfma_f32_16x16x32_bf16 v[136:139], a[8:11], a[152:155], v[136:139]
    v_exp_f32 v156, v156
    v_mfma_f32_16x16x32_bf16 v[140:143], a[8:11], a[156:159], v[140:143]
    s_waitcnt lgkmcnt(2)
    ds_read_b128 a[28:31], v237 offset:28672
    v_mfma_f32_16x16x32_bf16 v[128:131], a[12:15], a[160:163], v[128:131]
    v_exp_f32 v157, v157
    v_mfma_f32_16x16x32_bf16 v[132:135], a[12:15], a[164:167], v[132:135]
    ds_read_b128 a[0:3], v237 offset:30720
    v_mfma_f32_16x16x32_bf16 v[136:139], a[16:19], a[160:163], v[136:139]
    v_exp_f32 v158, v158
    v_mfma_f32_16x16x32_bf16 v[140:143], a[16:19], a[164:167], v[140:143]
    s_waitcnt lgkmcnt(2)
    v_exp_f32 v159, v159
    v_mfma_f32_16x16x32_bf16 v[128:131], a[20:23], a[168:171], v[128:131]
    v_cvt_pk_bf16_f32 v160, v144, v145
    v_cvt_pk_bf16_f32 v161, v146, v147
    v_mfma_f32_16x16x32_bf16 v[132:135], a[20:23], a[172:175], v[132:135]
    ds_read_b64_tr_b16 a[4:5], v225 offset:16384
    ds_read_b64_tr_b16 a[6:7], v225 offset:18432
    v_cvt_pk_bf16_f32 v162, v152, v153
    v_mfma_f32_16x16x32_bf16 v[136:139], a[24:27], a[168:171], v[136:139]
    ds_read_b64_tr_b16 a[8:9], v227 offset:16384
    v_cvt_pk_bf16_f32 v163, v154, v155
    v_mfma_f32_16x16x32_bf16 v[140:143], a[24:27], a[172:175], v[140:143]
    s_waitcnt lgkmcnt(3)
    ds_read_b64_tr_b16 a[10:11], v227 offset:18432
    v_cvt_pk_bf16_f32 v164, v148, v149
    v_mfma_f32_16x16x32_bf16 v[128:131], a[28:31], a[176:179], v[128:131]
    ds_read_b64_tr_b16 a[12:13], v229 offset:16384
    v_cvt_pk_bf16_f32 v165, v150, v151
    v_mfma_f32_16x16x32_bf16 v[132:135], a[28:31], a[180:183], v[132:135]
    ds_read_b64_tr_b16 a[14:15], v229 offset:18432
    v_cvt_pk_bf16_f32 v166, v156, v157
    v_mfma_f32_16x16x32_bf16 v[136:139], a[0:3], a[176:179], v[136:139]
    ds_read_b64_tr_b16 a[16:17], v231 offset:16384
    v_cvt_pk_bf16_f32 v167, v158, v159
    v_mfma_f32_16x16x32_bf16 v[140:143], a[0:3], a[180:183], v[140:143]
    ds_read_b64_tr_b16 a[18:19], v231 offset:18432
    v_mfma_f32_16x16x32_bf16 v[168:171], v[184:187], v[160:163], v[168:171]
    ds_read_b64_tr_b16 a[20:21], v225 offset:20480
    v_mfma_f32_16x16x32_bf16 v[172:175], v[184:187], v[164:167], v[172:175]
    s_waitcnt lgkmcnt(5)
    ds_read_b64_tr_b16 a[22:23], v225 offset:22528
    v_mfma_f32_16x16x32_bf16 v[0:3], a[4:7], v[160:163], v[0:3]
    ds_read_b64_tr_b16 a[24:25], v227 offset:20480
    v_mfma_f32_16x16x32_bf16 v[4:7], a[4:7], v[164:167], v[4:7]
    ds_read_b64_tr_b16 a[26:27], v227 offset:22528
    v_mfma_f32_16x16x32_bf16 v[8:11], a[8:11], v[160:163], v[8:11]
    buffer_load_dwordx2 a[252:253], v196, s[36:39], 0 offen
    v_mfma_f32_16x16x32_bf16 v[12:15], a[8:11], v[164:167], v[12:15]
    s_waitcnt lgkmcnt(4)
    ds_read_b64_tr_b16 a[28:29], v229 offset:20480
    ds_read_b64_tr_b16 a[30:31], v229 offset:22528
    v_mfma_f32_16x16x32_bf16 v[16:19], a[12:15], v[160:163], v[16:19]
    buffer_load_dwordx2 a[254:255], v197, s[36:39], 0 offen
    v_mfma_f32_16x16x32_bf16 v[20:23], a[12:15], v[164:167], v[20:23]
    ds_read_b64_tr_b16 a[0:1], v231 offset:20480
    ds_read_b64_tr_b16 a[2:3], v231 offset:22528
    v_mfma_f32_16x16x32_bf16 v[24:27], a[16:19], v[160:163], v[24:27]
    v_exp_f32 v128, v128
    v_mfma_f32_16x16x32_bf16 v[28:31], a[16:19], v[164:167], v[28:31]
    s_waitcnt lgkmcnt(4)
    ds_read_b64_tr_b16 a[4:5], v225 offset:24576
    ds_read_b64_tr_b16 a[6:7], v225 offset:26624
    v_mfma_f32_16x16x32_bf16 v[32:35], a[20:23], v[160:163], v[32:35]
    v_exp_f32 v129, v129
    v_mfma_f32_16x16x32_bf16 v[36:39], a[20:23], v[164:167], v[36:39]
    ds_read_b64_tr_b16 a[8:9], v227 offset:24576
    ds_read_b64_tr_b16 a[10:11], v227 offset:26624
    v_mfma_f32_16x16x32_bf16 v[40:43], a[24:27], v[160:163], v[40:43]
    v_exp_f32 v130, v130
    v_mfma_f32_16x16x32_bf16 v[44:47], a[24:27], v[164:167], v[44:47]
    s_waitcnt lgkmcnt(4)
    ds_read_b64_tr_b16 a[12:13], v229 offset:24576
    ds_read_b64_tr_b16 a[14:15], v229 offset:26624
    v_mfma_f32_16x16x32_bf16 v[48:51], a[28:31], v[160:163], v[48:51]
    s_add_u32 m0, s81, 147456
    v_exp_f32 v131, v131
    v_mfma_f32_16x16x32_bf16 v[52:55], a[28:31], v[164:167], v[52:55]
    s_mov_b32 s82, 212992
    ds_read_b64_tr_b16 a[16:17], v231 offset:24576
    ds_read_b64_tr_b16 a[18:19], v231 offset:26624
    v_mfma_f32_16x16x32_bf16 v[56:59], a[0:3], v[160:163], v[56:59]
    v_exp_f32 v132, v132
    v_mfma_f32_16x16x32_bf16 v[60:63], a[0:3], v[164:167], v[60:63]
    s_waitcnt lgkmcnt(4)
    ds_read_b64_tr_b16 a[20:21], v225 offset:28672
    ds_read_b64_tr_b16 a[22:23], v225 offset:30720
    v_mfma_f32_16x16x32_bf16 v[64:67], a[4:7], v[160:163], v[64:67]
    v_exp_f32 v133, v133
    v_mfma_f32_16x16x32_bf16 v[68:71], a[4:7], v[164:167], v[68:71]
    ds_read_b64_tr_b16 a[24:25], v227 offset:28672
    ds_read_b64_tr_b16 a[26:27], v227 offset:30720
    v_mfma_f32_16x16x32_bf16 v[72:75], a[8:11], v[160:163], v[72:75]
    s_waitcnt vmcnt(7)
    s_barrier
    ds_read_b64_tr_b16 a[28:29], v229 offset:28672
    ds_read_b64_tr_b16 a[30:31], v229 offset:30720
    v_mfma_f32_16x16x32_bf16 v[76:79], a[8:11], v[164:167], v[76:79]
    s_waitcnt lgkmcnt(6)
    buffer_load_dwordx4 v216, s[52:55], s82 offen offset:0 lds
    v_mfma_f32_16x16x32_bf16 v[80:83], a[12:15], v[160:163], v[80:83]
    v_exp_f32 v134, v134
    v_mfma_f32_16x16x32_bf16 v[84:87], a[12:15], v[164:167], v[84:87]
    ds_read_b64_tr_b16 a[0:1], v231 offset:28672
    ds_read_b64_tr_b16 a[2:3], v231 offset:30720
    v_mfma_f32_16x16x32_bf16 v[88:91], a[16:19], v[160:163], v[88:91]
    v_exp_f32 v135, v135
    v_mfma_f32_16x16x32_bf16 v[92:95], a[16:19], v[164:167], v[92:95]
    s_waitcnt lgkmcnt(4)
    ds_read_b128 a[4:7], v239 offset:32768
    v_mfma_f32_16x16x32_bf16 v[96:99], a[20:23], v[160:163], v[96:99]
    buffer_load_dwordx4 v217, s[52:55], s82 offen offset:1024 lds
    v_mfma_f32_16x16x32_bf16 v[100:103], a[20:23], v[164:167], v[100:103]
    ds_read_b128 a[8:11], v239 offset:34816
    v_mfma_f32_16x16x32_bf16 v[104:107], a[24:27], v[160:163], v[104:107]
    v_exp_f32 v136, v136
    v_mfma_f32_16x16x32_bf16 v[108:111], a[24:27], v[164:167], v[108:111]
    s_waitcnt lgkmcnt(2)
    ds_read_b128 a[12:15], v241 offset:32768
    v_mfma_f32_16x16x32_bf16 v[112:115], a[28:31], v[160:163], v[112:115]
    ds_read_b128 a[16:19], v241 offset:34816
    v_mfma_f32_16x16x32_bf16 v[116:119], a[28:31], v[164:167], v[116:119]
    buffer_load_dwordx4 v218, s[52:55], s82 offen offset:2048 lds
    v_mfma_f32_16x16x32_bf16 v[120:123], a[0:3], v[160:163], v[120:123]
    v_exp_f32 v137, v137
    v_mfma_f32_16x16x32_bf16 v[124:127], a[0:3], v[164:167], v[124:127]
    s_waitcnt lgkmcnt(2)
    ds_read_b128 a[20:23], v239 offset:36864
    v_mfma_f32_16x16x32_bf16 v[144:147], a[4:7], a[120:123], v[176:179]
    v_exp_f32 v138, v138
    v_mfma_f32_16x16x32_bf16 v[148:151], a[4:7], a[124:127], v[180:183]
    ds_read_b128 a[24:27], v239 offset:38912
    v_mfma_f32_16x16x32_bf16 v[152:155], a[8:11], a[120:123], v[176:179]
    buffer_load_dwordx4 v219, s[52:55], s82 offen offset:3072 lds
    v_mfma_f32_16x16x32_bf16 v[156:159], a[8:11], a[124:127], v[180:183]
    s_waitcnt lgkmcnt(2)
    ds_read_b128 a[28:31], v241 offset:36864
    v_mfma_f32_16x16x32_bf16 v[144:147], a[12:15], a[128:131], v[144:147]
    s_add_u32 m0, s81, 16384
    v_exp_f32 v139, v139
    v_mfma_f32_16x16x32_bf16 v[148:151], a[12:15], a[132:135], v[148:151]
    s_mov_b32 s82, 245760
    ds_read_b128 a[0:3], v241 offset:38912
    v_mfma_f32_16x16x32_bf16 v[152:155], a[16:19], a[128:131], v[152:155]
    ds_read_b128 a[4:7], v239 offset:40960
    v_mfma_f32_16x16x32_bf16 v[156:159], a[16:19], a[132:135], v[156:159]
    s_waitcnt lgkmcnt(3)
    buffer_load_dwordx4 v212, s[48:51], s82 offen offset:0 lds
    v_mfma_f32_16x16x32_bf16 v[144:147], a[20:23], a[136:139], v[144:147]
    v_exp_f32 v140, v140
    v_mfma_f32_16x16x32_bf16 v[148:151], a[20:23], a[140:143], v[148:151]
    ds_read_b128 a[8:11], v239 offset:43008
    v_mfma_f32_16x16x32_bf16 v[152:155], a[24:27], a[136:139], v[152:155]
    v_exp_f32 v141, v141
    v_mfma_f32_16x16x32_bf16 v[156:159], a[24:27], a[140:143], v[156:159]
    s_waitcnt lgkmcnt(2)
    ds_read_b128 a[12:15], v241 offset:40960
    v_mfma_f32_16x16x32_bf16 v[144:147], a[28:31], a[144:147], v[144:147]
    buffer_load_dwordx4 v213, s[48:51], s82 offen offset:1024 lds
    v_mfma_f32_16x16x32_bf16 v[148:151], a[28:31], a[148:151], v[148:151]
    ds_read_b128 a[16:19], v241 offset:43008
    v_mfma_f32_16x16x32_bf16 v[152:155], a[0:3], a[144:147], v[152:155]
    v_exp_f32 v142, v142
    v_mfma_f32_16x16x32_bf16 v[156:159], a[0:3], a[148:151], v[156:159]
    s_waitcnt lgkmcnt(2)
    ds_read_b128 a[20:23], v239 offset:45056
    v_mfma_f32_16x16x32_bf16 v[144:147], a[4:7], a[152:155], v[144:147]
    ds_read_b128 a[24:27], v239 offset:47104
    v_mfma_f32_16x16x32_bf16 v[148:151], a[4:7], a[156:159], v[148:151]
    buffer_load_dwordx4 v214, s[48:51], s82 offen offset:2048 lds
    v_mfma_f32_16x16x32_bf16 v[152:155], a[8:11], a[152:155], v[152:155]
    v_exp_f32 v143, v143
    v_mfma_f32_16x16x32_bf16 v[156:159], a[8:11], a[156:159], v[156:159]
    s_waitcnt lgkmcnt(2)
    ds_read_b128 a[28:31], v241 offset:45056
    v_cvt_pk_bf16_f32 v160, v128, v129
    v_mfma_f32_16x16x32_bf16 v[144:147], a[12:15], a[160:163], v[144:147]
    ds_read_b128 a[0:3], v241 offset:47104
    v_cvt_pk_bf16_f32 v161, v130, v131
    v_mfma_f32_16x16x32_bf16 v[148:151], a[12:15], a[164:167], v[148:151]
    buffer_load_dwordx4 v215, s[48:51], s82 offen offset:3072 lds
    v_mfma_f32_16x16x32_bf16 v[152:155], a[16:19], a[160:163], v[152:155]
    s_add_u32 m0, s81, 32768
    v_cvt_pk_bf16_f32 v162, v136, v137
    v_cvt_pk_bf16_f32 v163, v138, v139
    v_mfma_f32_16x16x32_bf16 v[156:159], a[16:19], a[164:167], v[156:159]
    s_waitcnt lgkmcnt(2)
    v_cvt_pk_bf16_f32 v164, v132, v133
    v_cvt_pk_bf16_f32 v165, v134, v135
    v_mfma_f32_16x16x32_bf16 v[144:147], a[20:23], a[168:171], v[144:147]
    s_mov_b32 s82, 229376
    ds_read_b64_tr_b16 a[4:5], v225 offset:49152
    v_cvt_pk_bf16_f32 v166, v140, v141
    v_mfma_f32_16x16x32_bf16 v[148:151], a[20:23], a[172:175], v[148:151]
    ds_read_b64_tr_b16 a[6:7], v225 offset:51200
    v_cvt_pk_bf16_f32 v167, v142, v143
    v_mfma_f32_16x16x32_bf16 v[152:155], a[24:27], a[168:171], v[152:155]
    ds_read_b64_tr_b16 a[8:9], v227 offset:49152
    ds_read_b64_tr_b16 a[10:11], v227 offset:51200
    v_mfma_f32_16x16x32_bf16 v[156:159], a[24:27], a[172:175], v[156:159]
    s_waitcnt lgkmcnt(4)
    buffer_load_dwordx4 v216, s[52:55], s82 offen offset:0 lds
    v_mfma_f32_16x16x32_bf16 v[144:147], a[28:31], a[176:179], v[144:147]
    ds_read_b64_tr_b16 a[12:13], v229 offset:49152
    v_mfma_f32_16x16x32_bf16 v[148:151], a[28:31], a[180:183], v[148:151]
    ds_read_b64_tr_b16 a[14:15], v229 offset:51200
    v_mfma_f32_16x16x32_bf16 v[152:155], a[0:3], a[176:179], v[152:155]
    ds_read_b64_tr_b16 a[16:17], v231 offset:49152
    ds_read_b64_tr_b16 a[18:19], v231 offset:51200
    v_mfma_f32_16x16x32_bf16 v[156:159], a[0:3], a[180:183], v[156:159]
    ds_read_b64_tr_b16 a[20:21], v225 offset:53248
    ds_read_b64_tr_b16 a[22:23], v225 offset:55296
    v_mfma_f32_16x16x32_bf16 v[168:171], v[184:187], v[160:163], v[168:171]
    buffer_load_dwordx4 v217, s[52:55], s82 offen offset:1024 lds
    v_mfma_f32_16x16x32_bf16 v[172:175], v[184:187], v[164:167], v[172:175]
    s_waitcnt lgkmcnt(6)
    ds_read_b64_tr_b16 a[24:25], v227 offset:53248
    ds_read_b64_tr_b16 a[26:27], v227 offset:55296
    v_mfma_f32_16x16x32_bf16 v[0:3], a[4:7], v[160:163], v[0:3]
    ds_read_b64_tr_b16 a[28:29], v229 offset:53248
    ds_read_b64_tr_b16 a[30:31], v229 offset:55296
    v_mfma_f32_16x16x32_bf16 v[4:7], a[4:7], v[164:167], v[4:7]
    ds_read_b64_tr_b16 a[0:1], v231 offset:53248
    ds_read_b64_tr_b16 a[2:3], v231 offset:55296
    v_mfma_f32_16x16x32_bf16 v[8:11], a[8:11], v[160:163], v[8:11]
    v_exp_f32 v144, v144
    v_mfma_f32_16x16x32_bf16 v[12:15], a[8:11], v[164:167], v[12:15]
    s_waitcnt lgkmcnt(8)
    buffer_load_dwordx4 v218, s[52:55], s82 offen offset:2048 lds
    v_mfma_f32_16x16x32_bf16 v[16:19], a[12:15], v[160:163], v[16:19]
    v_exp_f32 v145, v145
    v_mfma_f32_16x16x32_bf16 v[20:23], a[12:15], v[164:167], v[20:23]
    v_exp_f32 v146, v146
    v_mfma_f32_16x16x32_bf16 v[24:27], a[16:19], v[160:163], v[24:27]
    v_exp_f32 v147, v147
    v_mfma_f32_16x16x32_bf16 v[28:31], a[16:19], v[164:167], v[28:31]
    s_waitcnt lgkmcnt(4)
    ds_read_b64_tr_b16 a[4:5], v225 offset:57344
    ds_read_b64_tr_b16 a[6:7], v225 offset:59392
    v_mfma_f32_16x16x32_bf16 v[32:35], a[20:23], v[160:163], v[32:35]
    buffer_load_dwordx4 v219, s[52:55], s82 offen offset:3072 lds
    v_mfma_f32_16x16x32_bf16 v[36:39], a[20:23], v[164:167], v[36:39]
    s_add_u32 m0, s81, 49152
    ds_read_b64_tr_b16 a[8:9], v227 offset:57344
    ds_read_b64_tr_b16 a[10:11], v227 offset:59392
    v_mfma_f32_16x16x32_bf16 v[40:43], a[24:27], v[160:163], v[40:43]
    s_mov_b32 s82, 245760
    v_exp_f32 v148, v148
    v_mfma_f32_16x16x32_bf16 v[44:47], a[24:27], v[164:167], v[44:47]
    s_waitcnt lgkmcnt(4)
    ds_read_b64_tr_b16 a[12:13], v229 offset:57344
    ds_read_b64_tr_b16 a[14:15], v229 offset:59392
    v_mfma_f32_16x16x32_bf16 v[48:51], a[28:31], v[160:163], v[48:51]
    ds_read_b64_tr_b16 a[16:17], v231 offset:57344
    ds_read_b64_tr_b16 a[18:19], v231 offset:59392
    v_mfma_f32_16x16x32_bf16 v[52:55], a[28:31], v[164:167], v[52:55]
    buffer_load_dwordx4 v216, s[52:55], s82 offen offset:0 lds
    v_mfma_f32_16x16x32_bf16 v[56:59], a[0:3], v[160:163], v[56:59]
    v_exp_f32 v149, v149
    v_mfma_f32_16x16x32_bf16 v[60:63], a[0:3], v[164:167], v[60:63]
    s_waitcnt lgkmcnt(4)
    ds_read_b64_tr_b16 a[20:21], v225 offset:61440
    ds_read_b64_tr_b16 a[22:23], v225 offset:63488
    v_mfma_f32_16x16x32_bf16 v[64:67], a[4:7], v[160:163], v[64:67]
    v_exp_f32 v150, v150
    v_mfma_f32_16x16x32_bf16 v[68:71], a[4:7], v[164:167], v[68:71]
    ds_read_b64_tr_b16 a[24:25], v227 offset:61440
    ds_read_b64_tr_b16 a[26:27], v227 offset:63488
    v_mfma_f32_16x16x32_bf16 v[72:75], a[8:11], v[160:163], v[72:75]
    s_waitcnt vmcnt(9)
    s_barrier
    buffer_load_dwordx4 v217, s[52:55], s82 offen offset:1024 lds
    v_mfma_f32_16x16x32_bf16 v[76:79], a[8:11], v[164:167], v[76:79]
    s_waitcnt lgkmcnt(4)
    ds_read_b64_tr_b16 a[28:29], v229 offset:61440
    ds_read_b64_tr_b16 a[30:31], v229 offset:63488
    v_mfma_f32_16x16x32_bf16 v[80:83], a[12:15], v[160:163], v[80:83]
    v_exp_f32 v151, v151
    v_mfma_f32_16x16x32_bf16 v[84:87], a[12:15], v[164:167], v[84:87]
    ds_read_b64_tr_b16 a[0:1], v231 offset:61440
    ds_read_b64_tr_b16 a[2:3], v231 offset:63488
    v_mfma_f32_16x16x32_bf16 v[88:91], a[16:19], v[160:163], v[88:91]
    ds_read_b128 a[4:7], v235 offset:0
    v_mfma_f32_16x16x32_bf16 v[92:95], a[16:19], v[164:167], v[92:95]
    s_waitcnt lgkmcnt(5)
    buffer_load_dwordx4 v218, s[52:55], s82 offen offset:2048 lds
    v_mfma_f32_16x16x32_bf16 v[96:99], a[20:23], v[160:163], v[96:99]
    v_exp_f32 v152, v152
    v_mfma_f32_16x16x32_bf16 v[100:103], a[20:23], v[164:167], v[100:103]
    ds_read_b128 a[8:11], v235 offset:2048
    v_mfma_f32_16x16x32_bf16 v[104:107], a[24:27], v[160:163], v[104:107]
    v_exp_f32 v153, v153
    v_mfma_f32_16x16x32_bf16 v[108:111], a[24:27], v[164:167], v[108:111]
    s_waitcnt lgkmcnt(2)
    ds_read_b128 a[12:15], v237 offset:0
    v_mfma_f32_16x16x32_bf16 v[112:115], a[28:31], v[160:163], v[112:115]
    buffer_load_dwordx4 v219, s[52:55], s82 offen offset:3072 lds
    v_mfma_f32_16x16x32_bf16 v[116:119], a[28:31], v[164:167], v[116:119]
    s_add_u32 m0, s81, 0
    ds_read_b128 a[16:19], v237 offset:2048
    v_mfma_f32_16x16x32_bf16 v[120:123], a[0:3], v[160:163], v[120:123]
    s_mov_b32 s82, 0
    v_exp_f32 v154, v154
    v_mfma_f32_16x16x32_bf16 v[124:127], a[0:3], v[164:167], v[124:127]
    s_waitcnt lgkmcnt(2)
    ds_read_b128 a[20:23], v235 offset:4096
    v_mfma_f32_16x16x32_bf16 v[128:131], a[4:7], a[120:123], v[176:179]
    ds_read_b128 a[24:27], v235 offset:6144
    v_mfma_f32_16x16x32_bf16 v[132:135], a[4:7], a[124:127], v[180:183]
    buffer_load_dwordx4 v220, s[56:59], s82 offen offset:0 lds
    v_mfma_f32_16x16x32_bf16 v[136:139], a[8:11], a[120:123], v[176:179]
    v_exp_f32 v155, v155
    v_mfma_f32_16x16x32_bf16 v[140:143], a[8:11], a[124:127], v[180:183]
    s_waitcnt lgkmcnt(2)
    ds_read_b128 a[28:31], v237 offset:4096
    v_mfma_f32_16x16x32_bf16 v[128:131], a[12:15], a[128:131], v[128:131]
    v_exp_f32 v156, v156
    v_mfma_f32_16x16x32_bf16 v[132:135], a[12:15], a[132:135], v[132:135]
    ds_read_b128 a[0:3], v237 offset:6144
    v_mfma_f32_16x16x32_bf16 v[136:139], a[16:19], a[128:131], v[136:139]
    buffer_load_dwordx4 v221, s[56:59], s82 offen offset:1024 lds
    v_mfma_f32_16x16x32_bf16 v[140:143], a[16:19], a[132:135], v[140:143]
    s_waitcnt lgkmcnt(2)
    ds_read_b128 a[4:7], v235 offset:8192
    v_mfma_f32_16x16x32_bf16 v[128:131], a[20:23], a[136:139], v[128:131]
    v_exp_f32 v157, v157
    v_mfma_f32_16x16x32_bf16 v[132:135], a[20:23], a[140:143], v[132:135]
    ds_read_b128 a[8:11], v235 offset:10240
    v_mfma_f32_16x16x32_bf16 v[136:139], a[24:27], a[136:139], v[136:139]
    ds_read_b128 a[12:15], v237 offset:8192
    v_mfma_f32_16x16x32_bf16 v[140:143], a[24:27], a[140:143], v[140:143]
    s_waitcnt lgkmcnt(3)
    buffer_load_dwordx4 v222, s[56:59], s82 offen offset:2048 lds
    v_mfma_f32_16x16x32_bf16 v[128:131], a[28:31], a[144:147], v[128:131]
    v_exp_f32 v158, v158
    v_mfma_f32_16x16x32_bf16 v[132:135], a[28:31], a[148:151], v[132:135]
    ds_read_b128 a[16:19], v237 offset:10240
    v_mfma_f32_16x16x32_bf16 v[136:139], a[0:3], a[144:147], v[136:139]
    v_exp_f32 v159, v159
    v_mfma_f32_16x16x32_bf16 v[140:143], a[0:3], a[148:151], v[140:143]
    s_waitcnt lgkmcnt(2)
    ds_read_b128 a[20:23], v235 offset:12288
    v_cvt_pk_bf16_f32 v160, v144, v145
    v_mfma_f32_16x16x32_bf16 v[128:131], a[4:7], a[152:155], v[128:131]
    buffer_load_dwordx4 v223, s[56:59], s82 offen offset:3072 lds
    v_mfma_f32_16x16x32_bf16 v[132:135], a[4:7], a[156:159], v[132:135]
    s_add_u32 m0, s81, 65536
    ds_read_b128 a[24:27], v235 offset:14336
    v_cvt_pk_bf16_f32 v161, v146, v147
    v_mfma_f32_16x16x32_bf16 v[136:139], a[8:11], a[152:155], v[136:139]
    s_mov_b32 s82, 114688
    ds_read_b128 a[28:31], v237 offset:12288
    v_cvt_pk_bf16_f32 v162, v152, v153
    v_mfma_f32_16x16x32_bf16 v[140:143], a[8:11], a[156:159], v[140:143]
    s_waitcnt lgkmcnt(3)
    buffer_load_dwordx2 v[194:195], v242, s[68:71], 0 offen offset:64 sc1
    v_mfma_f32_16x16x32_bf16 v[128:131], a[12:15], a[160:163], v[128:131]
    ds_read_b128 a[0:3], v237 offset:14336
    v_cvt_pk_bf16_f32 v163, v154, v155
    v_mfma_f32_16x16x32_bf16 v[132:135], a[12:15], a[164:167], v[132:135]
    buffer_load_dwordx4 v220, s[56:59], s82 offen offset:0 lds
    v_mfma_f32_16x16x32_bf16 v[136:139], a[16:19], a[160:163], v[136:139]
    v_cvt_pk_bf16_f32 v164, v148, v149
    v_cvt_pk_bf16_f32 v165, v150, v151
    v_mfma_f32_16x16x32_bf16 v[140:143], a[16:19], a[164:167], v[140:143]
    s_waitcnt lgkmcnt(2)
    ds_read_b64_tr_b16 a[4:5], v204 offset:16384
    v_cvt_pk_bf16_f32 v166, v156, v157
    v_mfma_f32_16x16x32_bf16 v[128:131], a[20:23], a[168:171], v[128:131]
    ds_read_b64_tr_b16 a[6:7], v204 offset:18432
    v_cvt_pk_bf16_f32 v167, v158, v159
    v_mfma_f32_16x16x32_bf16 v[132:135], a[20:23], a[172:175], v[132:135]
    buffer_load_dwordx4 v221, s[56:59], s82 offen offset:1024 lds
    v_mfma_f32_16x16x32_bf16 v[136:139], a[24:27], a[168:171], v[136:139]
    ds_read_b64_tr_b16 a[8:9], v205 offset:16384
    v_mfma_f32_16x16x32_bf16 v[140:143], a[24:27], a[172:175], v[140:143]
    s_waitcnt lgkmcnt(3)
    ds_read_b64_tr_b16 a[10:11], v205 offset:18432
    v_mfma_f32_16x16x32_bf16 v[128:131], a[28:31], a[176:179], v[128:131]
    ds_read_b64_tr_b16 a[12:13], v254 offset:16384
    v_mfma_f32_16x16x32_bf16 v[132:135], a[28:31], a[180:183], v[132:135]
    ds_read_b64_tr_b16 a[14:15], v254 offset:18432
    v_mfma_f32_16x16x32_bf16 v[136:139], a[0:3], a[176:179], v[136:139]
    ds_read_b64_tr_b16 a[16:17], v236 offset:16384
    ds_read_b64_tr_b16 a[18:19], v236 offset:18432
    v_mfma_f32_16x16x32_bf16 v[140:143], a[0:3], a[180:183], v[140:143]
    buffer_load_dwordx4 v222, s[56:59], s82 offen offset:2048 lds
    v_mfma_f32_16x16x32_bf16 v[168:171], v[184:187], v[160:163], v[168:171]
    ds_read_b64_tr_b16 a[20:21], v204 offset:20480
    ds_read_b64_tr_b16 a[22:23], v204 offset:22528
    v_mfma_f32_16x16x32_bf16 v[172:175], v[184:187], v[164:167], v[172:175]
    s_waitcnt lgkmcnt(6)
    ds_read_b64_tr_b16 a[24:25], v205 offset:20480
    ds_read_b64_tr_b16 a[26:27], v205 offset:22528
    v_mfma_f32_16x16x32_bf16 v[0:3], a[4:7], v[160:163], v[0:3]
    ds_read_b64_tr_b16 a[28:29], v254 offset:20480
    ds_read_b64_tr_b16 a[30:31], v254 offset:22528
    v_mfma_f32_16x16x32_bf16 v[4:7], a[4:7], v[164:167], v[4:7]
    ds_read_b64_tr_b16 a[0:1], v236 offset:20480
    ds_read_b64_tr_b16 a[2:3], v236 offset:22528
    v_mfma_f32_16x16x32_bf16 v[8:11], a[8:11], v[160:163], v[8:11]
    buffer_load_dwordx4 v223, s[56:59], s82 offen offset:3072 lds
    v_mfma_f32_16x16x32_bf16 v[12:15], a[8:11], v[164:167], v[12:15]
    s_waitcnt lgkmcnt(8)
    v_exp_f32 v128, v128
    v_mfma_f32_16x16x32_bf16 v[16:19], a[12:15], v[160:163], v[16:19]
    s_add_u32 m0, s81, 81920
    v_exp_f32 v129, v129
    v_mfma_f32_16x16x32_bf16 v[20:23], a[12:15], v[164:167], v[20:23]
    s_mov_b32 s82, 229376
    v_exp_f32 v130, v130
    v_mfma_f32_16x16x32_bf16 v[24:27], a[16:19], v[160:163], v[24:27]
    ds_read_b64_tr_b16 a[4:5], v204 offset:24576
    ds_read_b64_tr_b16 a[6:7], v204 offset:26624
    v_mfma_f32_16x16x32_bf16 v[28:31], a[16:19], v[164:167], v[28:31]
    s_waitcnt lgkmcnt(6)
    buffer_load_dwordx4 v220, s[56:59], s82 offen offset:0 lds
    v_mfma_f32_16x16x32_bf16 v[32:35], a[20:23], v[160:163], v[32:35]
    v_exp_f32 v131, v131
    v_mfma_f32_16x16x32_bf16 v[36:39], a[20:23], v[164:167], v[36:39]
    ds_read_b64_tr_b16 a[8:9], v205 offset:24576
    ds_read_b64_tr_b16 a[10:11], v205 offset:26624
    v_mfma_f32_16x16x32_bf16 v[40:43], a[24:27], v[160:163], v[40:43]
    v_exp_f32 v132, v132
    v_mfma_f32_16x16x32_bf16 v[44:47], a[24:27], v[164:167], v[44:47]
    s_waitcnt lgkmcnt(4)
    ds_read_b64_tr_b16 a[12:13], v254 offset:24576
    ds_read_b64_tr_b16 a[14:15], v254 offset:26624
    v_mfma_f32_16x16x32_bf16 v[48:51], a[28:31], v[160:163], v[48:51]
    buffer_load_dwordx4 v221, s[56:59], s82 offen offset:1024 lds
    v_mfma_f32_16x16x32_bf16 v[52:55], a[28:31], v[164:167], v[52:55]
    ds_read_b64_tr_b16 a[16:17], v236 offset:24576
    ds_read_b64_tr_b16 a[18:19], v236 offset:26624
    v_mfma_f32_16x16x32_bf16 v[56:59], a[0:3], v[160:163], v[56:59]
    v_exp_f32 v133, v133
    v_mfma_f32_16x16x32_bf16 v[60:63], a[0:3], v[164:167], v[60:63]
    s_waitcnt lgkmcnt(4)
    ds_read_b64_tr_b16 a[20:21], v204 offset:28672
    ds_read_b64_tr_b16 a[22:23], v204 offset:30720
    v_mfma_f32_16x16x32_bf16 v[64:67], a[4:7], v[160:163], v[64:67]
    ds_read_b64_tr_b16 a[24:25], v205 offset:28672
    ds_read_b64_tr_b16 a[26:27], v205 offset:30720
    v_mfma_f32_16x16x32_bf16 v[68:71], a[4:7], v[164:167], v[68:71]
    buffer_load_dwordx4 v222, s[56:59], s82 offen offset:2048 lds
    v_mfma_f32_16x16x32_bf16 v[72:75], a[8:11], v[160:163], v[72:75]
    s_waitcnt vmcnt(20)
    s_barrier
    v_exp_f32 v134, v134
    v_mfma_f32_16x16x32_bf16 v[76:79], a[8:11], v[164:167], v[76:79]
    s_waitcnt lgkmcnt(4)
    ds_read_b64_tr_b16 a[28:29], v254 offset:28672
    ds_read_b64_tr_b16 a[30:31], v254 offset:30720
    v_mfma_f32_16x16x32_bf16 v[80:83], a[12:15], v[160:163], v[80:83]
    s_waitcnt vmcnt(7)
    v_exp_f32 v135, v135
    v_mfma_f32_16x16x32_bf16 v[84:87], a[12:15], v[164:167], v[84:87]
    ds_read_b64_tr_b16 a[0:1], v236 offset:28672
    ds_read_b64_tr_b16 a[2:3], v236 offset:30720
    v_cmp_eq_u64 vcc, v[194:195], v[246:247]
    v_mfma_f32_16x16x32_bf16 v[88:91], a[16:19], v[160:163], v[88:91]
    buffer_load_dwordx4 v223, s[56:59], s82 offen offset:3072 lds
    v_mfma_f32_16x16x32_bf16 v[92:95], a[16:19], v[164:167], v[92:95]
    s_waitcnt lgkmcnt(4)
    ds_read_b128 a[4:7], v238 offset:16384
    v_mfma_f32_16x16x32_bf16 v[96:99], a[20:23], v[160:163], v[96:99]
    s_and_b32 s77, vcc_lo, 0xff
    v_exp_f32 v136, v136
    v_mfma_f32_16x16x32_bf16 v[100:103], a[20:23], v[164:167], v[100:103]
    s_bitset1_b32 s77, s79
    ds_read_b128 a[8:11], v238 offset:18432
    v_mfma_f32_16x16x32_bf16 v[104:107], a[24:27], v[160:163], v[104:107]
    s_bcnt1_i32_b32 s77, s77
    v_exp_f32 v137, v137
    v_mfma_f32_16x16x32_bf16 v[108:111], a[24:27], v[164:167], v[108:111]
    s_waitcnt lgkmcnt(2)
    ds_read_b128 a[12:15], v240 offset:16384
    v_mfma_f32_16x16x32_bf16 v[112:115], a[28:31], v[160:163], v[112:115]
    v_exp_f32 v138, v138
    v_mfma_f32_16x16x32_bf16 v[116:119], a[28:31], v[164:167], v[116:119]
    s_cmp_eq_u32 s34, 0
    s_cselect_b32 s77, 0, s77
    ds_read_b128 a[16:19], v240 offset:18432
    v_mfma_f32_16x16x32_bf16 v[120:123], a[0:3], v[160:163], v[120:123]
    s_cmp_eq_u32 s77, 8
    s_cselect_b32 s42, 29360128, 0
    v_exp_f32 v139, v139
    v_mfma_f32_16x16x32_bf16 v[124:127], a[0:3], v[164:167], v[124:127]
    s_waitcnt lgkmcnt(2)
    ds_read_b128 a[20:23], v238 offset:20480
    v_mfma_f32_16x16x32_bf16 v[144:147], a[4:7], a[120:123], v[176:179]
    s_mov_b32 s86, 14680064
    v_exp_f32 v140, v140
    v_mfma_f32_16x16x32_bf16 v[148:151], a[4:7], a[124:127], v[180:183]
    ds_read_b128 a[24:27], v238 offset:22528
    v_mfma_f32_16x16x32_bf16 v[152:155], a[8:11], a[120:123], v[176:179]
    buffer_load_dwordx4 a[184:187], v207, s[40:43], s86 offen sc1
    v_mfma_f32_16x16x32_bf16 v[156:159], a[8:11], a[124:127], v[180:183]
    s_waitcnt lgkmcnt(2)
    ds_read_b128 a[28:31], v240 offset:20480
    v_mfma_f32_16x16x32_bf16 v[144:147], a[12:15], a[128:131], v[144:147]
    v_exp_f32 v141, v141
    v_mfma_f32_16x16x32_bf16 v[148:151], a[12:15], a[132:135], v[148:151]
    ds_read_b128 a[0:3], v240 offset:22528
    v_mfma_f32_16x16x32_bf16 v[152:155], a[16:19], a[128:131], v[152:155]
    buffer_load_dwordx4 a[216:219], v208, s[40:43], s86 offen sc1
    v_mfma_f32_16x16x32_bf16 v[156:159], a[16:19], a[132:135], v[156:159]
    s_waitcnt lgkmcnt(2)
    ds_read_b128 a[4:7], v238 offset:24576
    v_mfma_f32_16x16x32_bf16 v[144:147], a[20:23], a[136:139], v[144:147]
    s_mov_b32 s86, 16515072
    v_exp_f32 v142, v142
    v_mfma_f32_16x16x32_bf16 v[148:151], a[20:23], a[140:143], v[148:151]
    ds_read_b128 a[8:11], v238 offset:26624
    v_mfma_f32_16x16x32_bf16 v[152:155], a[24:27], a[136:139], v[152:155]
    buffer_load_dwordx4 a[188:191], v207, s[40:43], s86 offen sc1
    v_mfma_f32_16x16x32_bf16 v[156:159], a[24:27], a[140:143], v[156:159]
    s_waitcnt lgkmcnt(2)
    ds_read_b128 a[12:15], v240 offset:24576
    v_mfma_f32_16x16x32_bf16 v[144:147], a[28:31], a[144:147], v[144:147]
    v_exp_f32 v143, v143
    v_mfma_f32_16x16x32_bf16 v[148:151], a[28:31], a[148:151], v[148:151]
    ds_read_b128 a[16:19], v240 offset:26624
    v_cvt_pk_bf16_f32 v160, v128, v129
    v_mfma_f32_16x16x32_bf16 v[152:155], a[0:3], a[144:147], v[152:155]
    buffer_load_dwordx4 a[220:223], v208, s[40:43], s86 offen sc1
    v_mfma_f32_16x16x32_bf16 v[156:159], a[0:3], a[148:151], v[156:159]
    s_waitcnt lgkmcnt(2)
    ds_read_b128 a[20:23], v238 offset:28672
    v_cvt_pk_bf16_f32 v161, v130, v131
    v_mfma_f32_16x16x32_bf16 v[144:147], a[4:7], a[152:155], v[144:147]
    s_mov_b32 s86, 18350080
    ds_read_b128 a[24:27], v238 offset:30720
    v_cvt_pk_bf16_f32 v162, v136, v137
    v_mfma_f32_16x16x32_bf16 v[148:151], a[4:7], a[156:159], v[148:151]
    buffer_load_dwordx4 a[192:195], v207, s[40:43], s86 offen sc1
    v_mfma_f32_16x16x32_bf16 v[152:155], a[8:11], a[152:155], v[152:155]
    ds_read_b128 a[28:31], v240 offset:28672
    v_cvt_pk_bf16_f32 v163, v138, v139
    v_mfma_f32_16x16x32_bf16 v[156:159], a[8:11], a[156:159], v[156:159]
    s_waitcnt lgkmcnt(3)
    v_cvt_pk_bf16_f32 v164, v132, v133
    v_cvt_pk_bf16_f32 v165, v134, v135
    v_mfma_f32_16x16x32_bf16 v[144:147], a[12:15], a[160:163], v[144:147]
    s_barrier
    v_cvt_pk_bf16_f32 v166, v140, v141
    v_mfma_f32_16x16x32_bf16 v[148:151], a[12:15], a[164:167], v[148:151]
    ds_read_b128 a[0:3], v240 offset:30720
    v_cvt_pk_bf16_f32 v167, v142, v143
    v_mfma_f32_16x16x32_bf16 v[152:155], a[16:19], a[160:163], v[152:155]
    buffer_load_dwordx4 a[224:227], v208, s[40:43], s86 offen sc1
    v_mfma_f32_16x16x32_bf16 v[156:159], a[16:19], a[164:167], v[156:159]
    s_waitcnt lgkmcnt(2)
    ds_read_b64_tr_b16 a[4:5], v224 offset:32768
    v_mfma_f32_16x16x32_bf16 v[144:147], a[20:23], a[168:171], v[144:147]
    s_mov_b32 s86, 20185088
    ds_read_b64_tr_b16 a[6:7], v224 offset:34816
    v_mfma_f32_16x16x32_bf16 v[148:151], a[20:23], a[172:175], v[148:151]
    ds_read_b64_tr_b16 a[8:9], v226 offset:32768
    ds_read_b64_tr_b16 a[10:11], v226 offset:34816
    v_mfma_f32_16x16x32_bf16 v[152:155], a[24:27], a[168:171], v[152:155]
    buffer_load_dwordx4 a[196:199], v207, s[40:43], s86 offen sc1
    v_mfma_f32_16x16x32_bf16 v[156:159], a[24:27], a[172:175], v[156:159]
    s_waitcnt lgkmcnt(4)
    ds_read_b64_tr_b16 a[12:13], v228 offset:32768
    ds_read_b64_tr_b16 a[14:15], v228 offset:34816
    v_mfma_f32_16x16x32_bf16 v[144:147], a[28:31], a[176:179], v[144:147]
    ds_read_b64_tr_b16 a[16:17], v230 offset:32768
    ds_read_b64_tr_b16 a[18:19], v230 offset:34816
    v_mfma_f32_16x16x32_bf16 v[148:151], a[28:31], a[180:183], v[148:151]
    ds_read_b64_tr_b16 a[20:21], v224 offset:36864
    ds_read_b64_tr_b16 a[22:23], v224 offset:38912
    v_mfma_f32_16x16x32_bf16 v[152:155], a[0:3], a[176:179], v[152:155]
    buffer_load_dwordx4 a[228:231], v208, s[40:43], s86 offen sc1
    v_mfma_f32_16x16x32_bf16 v[156:159], a[0:3], a[180:183], v[156:159]
    s_mov_b32 s86, 22020096
    ds_read_b64_tr_b16 a[24:25], v226 offset:36864
    ds_read_b64_tr_b16 a[26:27], v226 offset:38912
    v_mfma_f32_16x16x32_bf16 v[168:171], v[184:187], v[160:163], v[168:171]
    ds_read_b64_tr_b16 a[28:29], v228 offset:36864
    ds_read_b64_tr_b16 a[30:31], v228 offset:38912
    v_mfma_f32_16x16x32_bf16 v[172:175], v[184:187], v[164:167], v[172:175]
    s_waitcnt lgkmcnt(10)
    buffer_load_dwordx4 a[200:203], v207, s[40:43], s86 offen sc1
    v_mfma_f32_16x16x32_bf16 v[0:3], a[4:7], v[160:163], v[0:3]
    ds_read_b64_tr_b16 a[0:1], v230 offset:36864
    ds_read_b64_tr_b16 a[2:3], v230 offset:38912
    v_exp_f32 v144, v144
    v_exp_f32 v145, v145
    v_exp_f32 v146, v146
    v_exp_f32 v147, v147
    v_exp_f32 v148, v148
    v_exp_f32 v149, v149
    v_exp_f32 v150, v150
    v_exp_f32 v151, v151
    v_exp_f32 v152, v152
    v_exp_f32 v153, v153
    v_exp_f32 v154, v154
    v_exp_f32 v155, v155
    v_mfma_f32_16x16x32_bf16 v[4:7], a[4:7], v[164:167], v[4:7]
    v_exp_f32 v156, v156
    v_mfma_f32_16x16x32_bf16 v[8:11], a[8:11], v[160:163], v[8:11]
    v_exp_f32 v157, v157
    v_mfma_f32_16x16x32_bf16 v[12:15], a[8:11], v[164:167], v[12:15]
    s_waitcnt lgkmcnt(8)
    v_exp_f32 v158, v158
    v_mfma_f32_16x16x32_bf16 v[16:19], a[12:15], v[160:163], v[16:19]
    buffer_load_dwordx4 a[232:235], v208, s[40:43], s86 offen sc1
    v_mfma_f32_16x16x32_bf16 v[20:23], a[12:15], v[164:167], v[20:23]
    s_mov_b32 s86, 23855104
    v_exp_f32 v159, v159
    v_mfma_f32_16x16x32_bf16 v[24:27], a[16:19], v[160:163], v[24:27]
    v_cvt_pk_bf16_f32 v128, v144, v145
    v_cvt_pk_bf16_f32 v129, v146, v147
    v_mfma_f32_16x16x32_bf16 v[28:31], a[16:19], v[164:167], v[28:31]
    s_waitcnt lgkmcnt(4)
    ds_read_b64_tr_b16 a[4:5], v224 offset:40960
    ds_read_b64_tr_b16 a[6:7], v224 offset:43008
    v_cvt_pk_bf16_f32 v130, v152, v153
    v_mfma_f32_16x16x32_bf16 v[32:35], a[20:23], v[160:163], v[32:35]
    buffer_load_dwordx4 a[204:207], v207, s[40:43], s86 offen sc1
    v_mfma_f32_16x16x32_bf16 v[36:39], a[20:23], v[164:167], v[36:39]
    ds_read_b64_tr_b16 a[8:9], v226 offset:40960
    ds_read_b64_tr_b16 a[10:11], v226 offset:43008
    v_cvt_pk_bf16_f32 v131, v154, v155
    v_mfma_f32_16x16x32_bf16 v[40:43], a[24:27], v[160:163], v[40:43]
    ds_read_b64_tr_b16 a[12:13], v228 offset:40960
    v_cvt_pk_bf16_f32 v132, v148, v149
    v_mfma_f32_16x16x32_bf16 v[44:47], a[24:27], v[164:167], v[44:47]
    s_waitcnt lgkmcnt(5)
    ds_read_b64_tr_b16 a[14:15], v228 offset:43008
    v_cvt_pk_bf16_f32 v133, v150, v151
    v_mfma_f32_16x16x32_bf16 v[48:51], a[28:31], v[160:163], v[48:51]
    buffer_load_dwordx4 a[236:239], v208, s[40:43], s86 offen sc1
    v_mfma_f32_16x16x32_bf16 v[52:55], a[28:31], v[164:167], v[52:55]
    s_mov_b32 s86, 25690112
    ds_read_b64_tr_b16 a[16:17], v230 offset:40960
    ds_read_b64_tr_b16 a[18:19], v230 offset:43008
    v_cvt_pk_bf16_f32 v134, v156, v157
    v_mfma_f32_16x16x32_bf16 v[56:59], a[0:3], v[160:163], v[56:59]
    s_add_u32 m0, s81, 16384
    ds_read_b64_tr_b16 a[20:21], v224 offset:45056
    v_cvt_pk_bf16_f32 v135, v158, v159
    v_mfma_f32_16x16x32_bf16 v[60:63], a[0:3], v[164:167], v[60:63]
    s_waitcnt lgkmcnt(5)
    ds_read_b64_tr_b16 a[22:23], v224 offset:47104
    v_mfma_f32_16x16x32_bf16 v[64:67], a[4:7], v[160:163], v[64:67]
    buffer_load_dwordx4 a[208:211], v207, s[40:43], s86 offen sc1
    v_mfma_f32_16x16x32_bf16 v[68:71], a[4:7], v[164:167], v[68:71]
    s_mov_b32 s82, 344064
    ds_read_b64_tr_b16 a[24:25], v226 offset:45056
    ds_read_b64_tr_b16 a[26:27], v226 offset:47104
    v_mfma_f32_16x16x32_bf16 v[72:75], a[8:11], v[160:163], v[72:75]
    s_barrier
    ds_read_b64_tr_b16 a[28:29], v228 offset:45056
    ds_read_b64_tr_b16 a[30:31], v228 offset:47104
    v_mfma_f32_16x16x32_bf16 v[76:79], a[8:11], v[164:167], v[76:79]
    s_waitcnt lgkmcnt(6)
    buffer_load_dwordx4 v220, s[56:59], s82 offen offset:0 lds
    v_mfma_f32_16x16x32_bf16 v[80:83], a[12:15], v[160:163], v[80:83]
    s_barrier
    buffer_load_dwordx4 a[240:243], v208, s[40:43], s86 offen sc1
    v_mfma_f32_16x16x32_bf16 v[84:87], a[12:15], v[164:167], v[84:87]
    s_mov_b32 s86, 27525120
    ds_read_b64_tr_b16 a[0:1], v230 offset:45056
    ds_read_b64_tr_b16 a[2:3], v230 offset:47104
    v_mfma_f32_16x16x32_bf16 v[88:91], a[16:19], v[160:163], v[88:91]
    buffer_load_dwordx4 a[212:215], v207, s[40:43], s86 offen sc1
    v_mfma_f32_16x16x32_bf16 v[92:95], a[16:19], v[164:167], v[92:95]
    s_waitcnt lgkmcnt(4)
    ds_read_b64_tr_b16 a[4:5], v224 offset:49152
    v_mfma_f32_16x16x32_bf16 v[96:99], a[20:23], v[160:163], v[96:99]
    buffer_load_dwordx4 v221, s[56:59], s82 offen offset:1024 lds
    v_mfma_f32_16x16x32_bf16 v[100:103], a[20:23], v[164:167], v[100:103]
    ds_read_b64_tr_b16 a[6:7], v224 offset:51200
    v_mfma_f32_16x16x32_bf16 v[104:107], a[24:27], v[160:163], v[104:107]
    ds_read_b64_tr_b16 a[8:9], v226 offset:49152
    ds_read_b64_tr_b16 a[10:11], v226 offset:51200
    v_mfma_f32_16x16x32_bf16 v[108:111], a[24:27], v[164:167], v[108:111]
    s_waitcnt lgkmcnt(4)
    ds_read_b64_tr_b16 a[12:13], v228 offset:49152
    ds_read_b64_tr_b16 a[14:15], v228 offset:51200
    v_mfma_f32_16x16x32_bf16 v[112:115], a[28:31], v[160:163], v[112:115]
    buffer_load_dwordx4 a[244:247], v208, s[40:43], s86 offen sc1
    v_mfma_f32_16x16x32_bf16 v[116:119], a[28:31], v[164:167], v[116:119]
    buffer_load_dwordx4 v222, s[56:59], s82 offen offset:2048 lds
    v_mfma_f32_16x16x32_bf16 v[120:123], a[0:3], v[160:163], v[120:123]
    s_mov_b32 s42, 29360128
    ds_read_b64_tr_b16 a[16:17], v230 offset:49152
    ds_read_b64_tr_b16 a[18:19], v230 offset:51200
    v_mfma_f32_16x16x32_bf16 v[124:127], a[0:3], v[164:167], v[124:127]
    ds_read_b64_tr_b16 a[20:21], v224 offset:53248
    ds_read_b64_tr_b16 a[22:23], v224 offset:55296
    v_mfma_f32_16x16x32_bf16 v[168:171], v[184:187], v[128:131], v[168:171]
    buffer_load_dwordx4 v223, s[56:59], s82 offen offset:3072 lds
    v_mfma_f32_16x16x32_bf16 v[172:175], v[184:187], v[132:135], v[172:175]
    s_waitcnt lgkmcnt(6)
    ds_read_b64_tr_b16 a[24:25], v226 offset:53248
    ds_read_b64_tr_b16 a[26:27], v226 offset:55296
    v_mfma_f32_16x16x32_bf16 v[0:3], a[4:7], v[128:131], v[0:3]
    ds_read_b64_tr_b16 a[28:29], v228 offset:53248
    ds_read_b64_tr_b16 a[30:31], v228 offset:55296
    v_mfma_f32_16x16x32_bf16 v[4:7], a[4:7], v[132:135], v[4:7]
    ds_read_b64_tr_b16 a[0:1], v230 offset:53248
    ds_read_b64_tr_b16 a[2:3], v230 offset:55296
    v_mfma_f32_16x16x32_bf16 v[8:11], a[8:11], v[128:131], v[8:11]
    ds_read_b64_tr_b16 a[4:5], v224 offset:57344
    ds_read_b64_tr_b16 a[6:7], v224 offset:59392
    v_rcp_f32 v192, v168
    v_mov_b32 v190, 0x4b800000
    v_add_f32 v189, v168, v172
    v_cmp_nle_f32 vcc, v189, v190
    v_mfma_f32_16x16x32_bf16 v[12:15], a[8:11], v[132:135], v[12:15]
    s_waitcnt lgkmcnt(10)
    v_rcp_f32 v193, v172
    v_mfma_f32_16x16x32_bf16 v[16:19], a[12:15], v[128:131], v[16:19]
    s_or_b32 s88, vcc_lo, vcc_hi
    ds_read_b64_tr_b16 a[8:9], v226 offset:57344
    ds_read_b64_tr_b16 a[10:11], v226 offset:59392
    v_mfma_f32_16x16x32_bf16 v[20:23], a[12:15], v[132:135], v[20:23]
    v_mul_f32 v0, v0, v192
    v_mul_f32 v1, v1, v192
    v_mul_f32 v2, v2, v192
    v_mul_f32 v3, v3, v192
    v_mul_f32 v8, v8, v192
    v_mul_f32 v9, v9, v192
    v_mul_f32 v10, v10, v192
    v_mul_f32 v11, v11, v192
    v_cvt_pk_bf16_f32 v176, v0, v1
    v_cvt_pk_bf16_f32 v177, v2, v3
    v_cvt_pk_bf16_f32 v178, v8, v9
    v_cvt_pk_bf16_f32 v179, v10, v11
    v_mul_f32 v4, v4, v193
    v_mul_f32 v5, v5, v193
    v_mul_f32 v6, v6, v193
    v_mul_f32 v7, v7, v193
    v_mfma_f32_16x16x32_bf16 v[24:27], a[16:19], v[128:131], v[24:27]
    ds_write_b128 v210, v[176:179] offset:0
    v_mul_f32 v12, v12, v193
    v_mul_f32 v13, v13, v193
    v_mul_f32 v14, v14, v193
    v_mul_f32 v15, v15, v193
    v_cvt_pk_bf16_f32 v180, v4, v5
    v_cvt_pk_bf16_f32 v181, v6, v7
    v_cvt_pk_bf16_f32 v182, v12, v13
    v_cvt_pk_bf16_f32 v183, v14, v15
    v_mfma_f32_16x16x32_bf16 v[28:31], a[16:19], v[132:135], v[28:31]
    s_waitcnt lgkmcnt(9)
    ds_read_b64_tr_b16 a[12:13], v228 offset:57344
    ds_read_b64_tr_b16 a[14:15], v228 offset:59392
    v_mfma_f32_16x16x32_bf16 v[32:35], a[20:23], v[128:131], v[32:35]
    ds_read_b64_tr_b16 a[16:17], v230 offset:57344
    ds_read_b64_tr_b16 a[18:19], v230 offset:59392
    v_mfma_f32_16x16x32_bf16 v[36:39], a[20:23], v[132:135], v[36:39]
    v_mul_f32 v16, v16, v192
    v_mul_f32 v17, v17, v192
    v_mul_f32 v18, v18, v192
    v_mul_f32 v19, v19, v192
    v_mfma_f32_16x16x32_bf16 v[40:43], a[24:27], v[128:131], v[40:43]
    ds_write_b128 v210, v[180:183] offset:1024
    v_mul_f32 v24, v24, v192
    v_mul_f32 v25, v25, v192
    v_mul_f32 v26, v26, v192
    v_mul_f32 v27, v27, v192
    v_cvt_pk_bf16_f32 v176, v16, v17
    v_cvt_pk_bf16_f32 v177, v18, v19
    v_cvt_pk_bf16_f32 v178, v24, v25
    v_cvt_pk_bf16_f32 v179, v26, v27
    v_mul_f32 v20, v20, v193
    v_mul_f32 v21, v21, v193
    v_mul_f32 v22, v22, v193
    v_mul_f32 v23, v23, v193
    v_mfma_f32_16x16x32_bf16 v[44:47], a[24:27], v[132:135], v[44:47]
    s_waitcnt lgkmcnt(10)
    ds_write_b128 v210, v[176:179] offset:2048
    ds_read_b64_tr_b16 a[20:21], v224 offset:61440
    ds_read_b64_tr_b16 a[22:23], v224 offset:63488
    v_mul_f32 v28, v28, v193
    v_mul_f32 v29, v29, v193
    v_mul_f32 v30, v30, v193
    v_mul_f32 v31, v31, v193
    v_cvt_pk_bf16_f32 v180, v20, v21
    v_cvt_pk_bf16_f32 v181, v22, v23
    v_cvt_pk_bf16_f32 v182, v28, v29
    v_cvt_pk_bf16_f32 v183, v30, v31
    v_mfma_f32_16x16x32_bf16 v[48:51], a[28:31], v[128:131], v[48:51]
    ds_read_b64_tr_b16 a[24:25], v226 offset:61440
    ds_read_b64_tr_b16 a[26:27], v226 offset:63488
    v_mfma_f32_16x16x32_bf16 v[52:55], a[28:31], v[132:135], v[52:55]
    v_mul_f32 v32, v32, v192
    v_mul_f32 v33, v33, v192
    v_mul_f32 v34, v34, v192
    v_mul_f32 v35, v35, v192
    v_mfma_f32_16x16x32_bf16 v[56:59], a[0:3], v[128:131], v[56:59]
    ds_write_b128 v210, v[180:183] offset:3072
    v_mul_f32 v40, v40, v192
    v_mul_f32 v41, v41, v192
    v_mul_f32 v42, v42, v192
    v_mul_f32 v43, v43, v192
    v_cvt_pk_bf16_f32 v176, v32, v33
    v_cvt_pk_bf16_f32 v177, v34, v35
    v_cvt_pk_bf16_f32 v178, v40, v41
    v_cvt_pk_bf16_f32 v179, v42, v43
    v_mul_f32 v36, v36, v193
    v_mul_f32 v37, v37, v193
    v_mul_f32 v38, v38, v193
    v_mul_f32 v39, v39, v193
    v_mfma_f32_16x16x32_bf16 v[60:63], a[0:3], v[132:135], v[60:63]
    s_waitcnt lgkmcnt(12)
    ds_write_b128 v210, v[176:179] offset:4096
    ds_read_b64_tr_b16 a[28:29], v228 offset:61440
    ds_read_b64_tr_b16 a[30:31], v228 offset:63488
    v_mul_f32 v44, v44, v193
    v_mul_f32 v45, v45, v193
    v_mul_f32 v46, v46, v193
    v_mul_f32 v47, v47, v193
    v_cvt_pk_bf16_f32 v180, v36, v37
    v_cvt_pk_bf16_f32 v181, v38, v39
    v_cvt_pk_bf16_f32 v182, v44, v45
    v_cvt_pk_bf16_f32 v183, v46, v47
    v_mfma_f32_16x16x32_bf16 v[64:67], a[4:7], v[128:131], v[64:67]
    ds_read_b64_tr_b16 a[0:1], v230 offset:61440
    ds_read_b64_tr_b16 a[2:3], v230 offset:63488
    v_mfma_f32_16x16x32_bf16 v[68:71], a[4:7], v[132:135], v[68:71]
    v_mul_f32 v48, v48, v192
    v_mul_f32 v49, v49, v192
    v_mul_f32 v50, v50, v192
    v_mul_f32 v51, v51, v192
    v_mfma_f32_16x16x32_bf16 v[72:75], a[8:11], v[128:131], v[72:75]
    ds_write_b128 v210, v[180:183] offset:5120
    v_mul_f32 v56, v56, v192
    v_mul_f32 v57, v57, v192
    v_mul_f32 v58, v58, v192
    v_mul_f32 v59, v59, v192
    v_cvt_pk_bf16_f32 v176, v48, v49
    v_cvt_pk_bf16_f32 v177, v50, v51
    v_cvt_pk_bf16_f32 v178, v56, v57
    v_cvt_pk_bf16_f32 v179, v58, v59
    v_mul_f32 v52, v52, v193
    v_mul_f32 v53, v53, v193
    v_mul_f32 v54, v54, v193
    v_mul_f32 v55, v55, v193
    v_mfma_f32_16x16x32_bf16 v[76:79], a[8:11], v[132:135], v[76:79]
    s_waitcnt lgkmcnt(13)
    s_barrier
    ds_write_b128 v210, v[176:179] offset:6144
    v_mul_f32 v60, v60, v193
    v_mul_f32 v61, v61, v193
    v_mul_f32 v62, v62, v193
    v_mul_f32 v63, v63, v193
    v_cvt_pk_bf16_f32 v180, v52, v53
    v_cvt_pk_bf16_f32 v181, v54, v55
    v_cvt_pk_bf16_f32 v182, v60, v61
    v_cvt_pk_bf16_f32 v183, v62, v63
    v_mfma_f32_16x16x32_bf16 v[80:83], a[12:15], v[128:131], v[80:83]
    ds_read_b64_tr_b16 a[4:5], v232 offset:0
    ds_read_b64_tr_b16 a[6:7], v232 offset:2048
    v_mfma_f32_16x16x32_bf16 v[84:87], a[12:15], v[132:135], v[84:87]
    v_mul_f32 v64, v64, v192
    v_mul_f32 v65, v65, v192
    v_mul_f32 v66, v66, v192
    v_mul_f32 v67, v67, v192
    v_mfma_f32_16x16x32_bf16 v[88:91], a[16:19], v[128:131], v[88:91]
    ds_write_b128 v210, v[180:183] offset:7168
    v_mul_f32 v72, v72, v192
    v_mul_f32 v73, v73, v192
    v_mul_f32 v74, v74, v192
    v_mul_f32 v75, v75, v192
    v_cvt_pk_bf16_f32 v176, v64, v65
    v_cvt_pk_bf16_f32 v177, v66, v67
    v_cvt_pk_bf16_f32 v178, v72, v73
    v_cvt_pk_bf16_f32 v179, v74, v75
    v_mul_f32 v68, v68, v193
    v_mul_f32 v69, v69, v193
    v_mul_f32 v70, v70, v193
    v_mul_f32 v71, v71, v193
    v_mfma_f32_16x16x32_bf16 v[92:95], a[16:19], v[132:135], v[92:95]
    s_waitcnt lgkmcnt(11)
    ds_write_b128 v210, v[176:179] offset:8192
    v_mul_f32 v76, v76, v193
    v_mul_f32 v77, v77, v193
    v_mul_f32 v78, v78, v193
    v_mul_f32 v79, v79, v193
    v_cvt_pk_bf16_f32 v180, v68, v69
    v_cvt_pk_bf16_f32 v181, v70, v71
    v_cvt_pk_bf16_f32 v182, v76, v77
    v_cvt_pk_bf16_f32 v183, v78, v79
    v_mfma_f32_16x16x32_bf16 v[96:99], a[20:23], v[128:131], v[96:99]
    ds_read_b64_tr_b16 a[8:9], v232 offset:4096
    ds_read_b64_tr_b16 a[10:11], v232 offset:6144
    v_mfma_f32_16x16x32_bf16 v[100:103], a[20:23], v[132:135], v[100:103]
    v_mul_f32 v80, v80, v192
    v_mul_f32 v81, v81, v192
    v_mul_f32 v82, v82, v192
    v_mul_f32 v83, v83, v192
    v_mfma_f32_16x16x32_bf16 v[104:107], a[24:27], v[128:131], v[104:107]
    s_add_u32 m0, s81, 32768
    ds_write_b128 v210, v[180:183] offset:9216
    v_mul_f32 v88, v88, v192
    v_mul_f32 v89, v89, v192
    v_mul_f32 v90, v90, v192
    v_mul_f32 v91, v91, v192
    v_cvt_pk_bf16_f32 v176, v80, v81
    v_cvt_pk_bf16_f32 v177, v82, v83
    v_cvt_pk_bf16_f32 v178, v88, v89
    v_cvt_pk_bf16_f32 v179, v90, v91
    v_mul_f32 v84, v84, v193
    v_mul_f32 v85, v85, v193
    v_mul_f32 v86, v86, v193
    v_mul_f32 v87, v87, v193
    v_mfma_f32_16x16x32_bf16 v[108:111], a[24:27], v[132:135], v[108:111]
    s_waitcnt lgkmcnt(9)
    ds_write_b128 v210, v[176:179] offset:10240
    v_mul_f32 v92, v92, v193
    v_mul_f32 v93, v93, v193
    v_mul_f32 v94, v94, v193
    v_mul_f32 v95, v95, v193
    v_cvt_pk_bf16_f32 v180, v84, v85
    v_cvt_pk_bf16_f32 v181, v86, v87
    v_cvt_pk_bf16_f32 v182, v92, v93
    v_cvt_pk_bf16_f32 v183, v94, v95
    v_mfma_f32_16x16x32_bf16 v[112:115], a[28:31], v[128:131], v[112:115]
    s_mov_b32 s82, 128
    ds_read_b64_tr_b16 a[12:13], v232 offset:8192
    ds_read_b64_tr_b16 a[14:15], v232 offset:10240
    v_mfma_f32_16x16x32_bf16 v[116:119], a[28:31], v[132:135], v[116:119]
    v_mul_f32 v96, v96, v192
    v_mul_f32 v97, v97, v192
    v_mul_f32 v98, v98, v192
    v_mul_f32 v99, v99, v192
    v_mfma_f32_16x16x32_bf16 v[120:123], a[0:3], v[128:131], v[120:123]
    ds_write_b128 v210, v[180:183] offset:11264
    v_mul_f32 v104, v104, v192
    v_mul_f32 v105, v105, v192
    v_mul_f32 v106, v106, v192
    v_mul_f32 v107, v107, v192
    v_cvt_pk_bf16_f32 v176, v96, v97
    v_cvt_pk_bf16_f32 v177, v98, v99
    v_cvt_pk_bf16_f32 v178, v104, v105
    v_cvt_pk_bf16_f32 v179, v106, v107
    v_mul_f32 v100, v100, v193
    v_mul_f32 v101, v101, v193
    v_mul_f32 v102, v102, v193
    v_mul_f32 v103, v103, v193
    v_mfma_f32_16x16x32_bf16 v[124:127], a[0:3], v[132:135], v[124:127]
    ds_write_b128 v210, v[176:179] offset:12288
    v_mul_f32 v108, v108, v193
    v_mul_f32 v109, v109, v193
    v_mul_f32 v110, v110, v193
    v_mul_f32 v111, v111, v193
    v_cvt_pk_bf16_f32 v180, v100, v101
    v_cvt_pk_bf16_f32 v181, v102, v103
    v_cvt_pk_bf16_f32 v182, v108, v109
    v_cvt_pk_bf16_f32 v183, v110, v111
    v_mul_f32 v112, v112, v192
    v_mul_f32 v113, v113, v192
    v_mul_f32 v114, v114, v192
    v_mul_f32 v115, v115, v192
    ds_write_b128 v210, v[180:183] offset:13312
    v_mul_f32 v120, v120, v192
    v_mul_f32 v121, v121, v192
    v_mul_f32 v122, v122, v192
    v_mul_f32 v123, v123, v192
    v_cvt_pk_bf16_f32 v176, v112, v113
    v_cvt_pk_bf16_f32 v177, v114, v115
    v_cvt_pk_bf16_f32 v178, v120, v121
    v_cvt_pk_bf16_f32 v179, v122, v123
    v_mul_f32 v116, v116, v193
    v_mul_f32 v117, v117, v193
    v_mul_f32 v118, v118, v193
    v_mul_f32 v119, v119, v193
    ds_write_b128 v210, v[176:179] offset:14336
    v_mul_f32 v124, v124, v193
    v_mul_f32 v125, v125, v193
    v_mul_f32 v126, v126, v193
    v_mul_f32 v127, v127, v193
    v_cvt_pk_bf16_f32 v180, v116, v117
    v_cvt_pk_bf16_f32 v181, v118, v119
    v_cvt_pk_bf16_f32 v182, v124, v125
    v_cvt_pk_bf16_f32 v183, v126, v127
    ds_write_b128 v210, v[180:183] offset:15360
    ds_read_b64_tr_b16 a[16:17], v232 offset:12288
    ds_read_b64_tr_b16 a[18:19], v232 offset:14336
    s_nop 0
    s_cmp_lg_u32 s88, 0
    s_cbranch_scc1 L_slow
L_back:
    s_waitcnt lgkmcnt(2) vmcnt(24)
    s_barrier
    ds_read_b128 a[32:35], v206 offset:0
    ds_read_b128 a[36:39], v206 offset:1024
    ds_read_b128 a[40:43], v206 offset:32768
    ds_read_b128 a[44:47], v206 offset:33792
    ds_read_b128 a[48:51], v206 offset:2048
    ds_read_b128 a[52:55], v206 offset:3072
    ds_read_b128 a[56:59], v206 offset:34816
    ds_read_b128 a[60:63], v206 offset:35840
    ds_read_b128 a[64:67], v206 offset:4096
    ds_read_b128 a[68:71], v206 offset:5120
    ds_read_b128 a[72:75], v206 offset:36864
    ds_read_b128 a[76:79], v206 offset:37888
    ds_read_b128 a[80:83], v206 offset:6144
    ds_read_b128 a[84:87], v206 offset:7168
    ds_read_b128 a[88:91], v206 offset:38912
    ds_read_b128 a[92:95], v206 offset:39936
    ds_read_b128 a[96:99], v206 offset:8192
    ds_read_b128 a[100:103], v206 offset:9216
    ds_read_b128 a[104:107], v206 offset:40960
    ds_read_b128 a[108:111], v206 offset:41984
    ds_read_b128 a[112:115], v206 offset:10240
    ds_read_b128 a[116:119], v206 offset:11264
    ds_read_b128 a[248:251], v206 offset:43008
    ds_read_b128 v[168:171], v206 offset:44032
    ds_read_b128 v[172:175], v206 offset:12288
    ds_read_b128 v[176:179], v206 offset:13312
    ds_read_b128 v[180:183], v206 offset:45056
    ds_read_b128 v[184:187], v206 offset:46080
    ds_read_b128 v[188:191], v206 offset:14336
    ds_read_b128 v[192:195], v206 offset:15360
    ds_read_b128 v[196:199], v206 offset:47104
    ds_read_b128 v[200:203], v206 offset:48128
    ds_read_b128 v[0:3], v206 offset:16384
    ds_read_b128 v[4:7], v206 offset:17408
    ds_read_b128 v[8:11], v206 offset:49152
    ds_read_b128 v[12:15], v206 offset:50176
    ds_read_b128 v[16:19], v206 offset:18432
    ds_read_b128 v[20:23], v206 offset:19456
    ds_read_b128 v[24:27], v206 offset:51200
    ds_read_b128 v[28:31], v206 offset:52224
    ds_read_b128 v[32:35], v206 offset:20480
    ds_read_b128 v[36:39], v206 offset:21504
    ds_read_b128 v[40:43], v206 offset:53248
    ds_read_b128 v[44:47], v206 offset:54272
    ds_read_b128 v[48:51], v206 offset:22528
    ds_read_b128 v[52:55], v206 offset:23552
    buffer_load_dwordx4 v220, s[56:59], s82 offen offset:0 lds
    s_waitcnt lgkmcnt(15)
    v_mfma_f32_16x16x32_bf16 v[144:147], a[4:7], a[32:35], 0
    s_mov_b32 s48, s28
    ds_read_b128 v[56:59], v206 offset:55296
    ds_read_b128 v[60:63], v206 offset:56320
    v_mfma_f32_16x16x32_bf16 v[148:151], a[4:7], a[36:39], 0
    s_mov_b32 s49, s29
    ds_read_b128 v[64:67], v206 offset:24576
    ds_read_b128 v[68:71], v206 offset:25600
    v_mfma_f32_16x16x32_bf16 v[152:155], a[4:7], a[40:43], 0
    s_mov_b32 s50, 1835008
    ds_read_b128 v[72:75], v206 offset:57344
    ds_read_b128 v[76:79], v206 offset:58368
    v_mfma_f32_16x16x32_bf16 v[156:159], a[4:7], a[44:47], 0
    ds_read_b128 v[80:83], v206 offset:26624
    ds_read_b128 v[84:87], v206 offset:27648
    v_mfma_f32_16x16x32_bf16 v[144:147], a[8:11], a[48:51], v[144:147]
    s_mov_b32 s51, 0x20000
    ds_read_b128 v[88:91], v206 offset:59392
    ds_read_b128 v[92:95], v206 offset:60416
    v_mfma_f32_16x16x32_bf16 v[148:151], a[8:11], a[52:55], v[148:151]
    buffer_load_dwordx4 v221, s[56:59], s82 offen offset:1024 lds
    v_mfma_f32_16x16x32_bf16 v[152:155], a[8:11], a[56:59], v[152:155]
    ds_read_b128 v[96:99], v206 offset:28672
    ds_read_b128 v[100:103], v206 offset:29696
    v_mfma_f32_16x16x32_bf16 v[156:159], a[8:11], a[60:63], v[156:159]
    ds_read_b64_tr_b16 a[20:21], v233 offset:0
    ds_read_b64_tr_b16 a[22:23], v233 offset:2048
    v_mfma_f32_16x16x32_bf16 v[144:147], a[12:15], a[64:67], v[144:147]
    buffer_load_dwordx4 v222, s[56:59], s82 offen offset:2048 lds
    v_mfma_f32_16x16x32_bf16 v[148:151], a[12:15], a[68:71], v[148:151]
    ds_read_b128 v[104:107], v206 offset:61440
    ds_read_b128 v[108:111], v206 offset:62464
    v_mfma_f32_16x16x32_bf16 v[152:155], a[12:15], a[72:75], v[152:155]
    ds_read_b64_tr_b16 a[24:25], v233 offset:4096
    ds_read_b64_tr_b16 a[26:27], v233 offset:6144
    v_mfma_f32_16x16x32_bf16 v[156:159], a[12:15], a[76:79], v[156:159]
    buffer_load_dwordx4 v223, s[56:59], s82 offen offset:3072 lds
    v_mfma_f32_16x16x32_bf16 v[144:147], a[16:19], a[80:83], v[144:147]
    s_add_u32 m0, s81, 49152
    ds_read_b128 v[112:115], v206 offset:30720
    ds_read_b128 v[116:119], v206 offset:31744
    v_mfma_f32_16x16x32_bf16 v[148:151], a[16:19], a[84:87], v[148:151]
    s_mov_b32 s82, 114816
    ds_read_b128 v[120:123], v206 offset:63488
    ds_read_b128 v[124:127], v206 offset:64512
    v_mfma_f32_16x16x32_bf16 v[152:155], a[16:19], a[88:91], v[152:155]
    buffer_load_dwordx4 v220, s[56:59], s82 offen offset:0 lds
    v_mfma_f32_16x16x32_bf16 v[156:159], a[16:19], a[92:95], v[156:159]
    s_waitcnt lgkmcnt(8)
    ds_read_b64_tr_b16 a[28:29], v233 offset:8192
    ds_read_b64_tr_b16 a[30:31], v233 offset:10240
    v_mfma_f32_16x16x32_bf16 v[144:147], a[20:23], a[96:99], v[144:147]
    ds_read_b64_tr_b16 a[0:1], v233 offset:12288
    v_mfma_f32_16x16x32_bf16 v[148:151], a[20:23], a[100:103], v[148:151]
    buffer_load_dwordx4 v221, s[56:59], s82 offen offset:1024 lds
    v_mfma_f32_16x16x32_bf16 v[152:155], a[20:23], a[104:107], v[152:155]
    s_waitcnt lgkmcnt(3) vmcnt(6)
    s_barrier
    v_mfma_f32_16x16x32_bf16 v[156:159], a[20:23], a[108:111], v[156:159]
    ds_read_b64_tr_b16 a[2:3], v233 offset:14336
    v_mfma_f32_16x16x32_bf16 v[144:147], a[24:27], a[112:115], v[144:147]
    buffer_load_dwordx4 v222, s[56:59], s82 offen offset:2048 lds
    v_mfma_f32_16x16x32_bf16 v[148:151], a[24:27], a[116:119], v[148:151]
    ds_read_b64_tr_b16 a[4:5], v233 offset:16384
    v_mfma_f32_16x16x32_bf16 v[152:155], a[24:27], a[248:251], v[152:155]
    ds_read_b64_tr_b16 a[6:7], v233 offset:18432
    v_mfma_f32_16x16x32_bf16 v[156:159], a[24:27], v[168:171], v[156:159]
    s_waitcnt lgkmcnt(4)
    ds_read_b64_tr_b16 a[8:9], v233 offset:20480
    v_mfma_f32_16x16x32_bf16 v[144:147], a[28:31], v[172:175], v[144:147]
    buffer_load_dwordx4 v223, s[56:59], s82 offen offset:3072 lds
    v_mfma_f32_16x16x32_bf16 v[148:151], a[28:31], v[176:179], v[148:151]
    s_add_u32 m0, s81, 0
    ds_read_b64_tr_b16 a[10:11], v233 offset:22528
    v_mfma_f32_16x16x32_bf16 v[152:155], a[28:31], v[180:183], v[152:155]
    s_mov_b32 s82, 229504
    ds_read_b64_tr_b16 a[12:13], v233 offset:24576
    v_mfma_f32_16x16x32_bf16 v[156:159], a[28:31], v[184:187], v[156:159]
    s_waitcnt lgkmcnt(5)
    ds_read_b64_tr_b16 a[14:15], v233 offset:26624
    v_mfma_f32_16x16x32_bf16 v[144:147], a[0:3], v[188:191], v[144:147]
    buffer_load_dwordx4 v220, s[56:59], s82 offen offset:0 lds
    v_mfma_f32_16x16x32_bf16 v[148:151], a[0:3], v[192:195], v[148:151]
    v_mfma_f32_16x16x32_bf16 v[152:155], a[0:3], v[196:199], v[152:155]
    buffer_load_dwordx4 v221, s[56:59], s82 offen offset:1024 lds
    v_mfma_f32_16x16x32_bf16 v[156:159], a[0:3], v[200:203], v[156:159]
    s_waitcnt lgkmcnt(4)
    ds_read_b64_tr_b16 a[16:17], v233 offset:28672
    v_mfma_f32_16x16x32_bf16 v[144:147], a[4:7], v[0:3], v[144:147]
    ds_read_b64_tr_b16 a[18:19], v233 offset:30720
    v_mfma_f32_16x16x32_bf16 v[148:151], a[4:7], v[4:7], v[148:151]
    buffer_load_dwordx4 v222, s[56:59], s82 offen offset:2048 lds
    v_mfma_f32_16x16x32_bf16 v[152:155], a[4:7], v[8:11], v[152:155]
    ds_read_b64_tr_b16 a[20:21], v232 offset:16384
    v_mfma_f32_16x16x32_bf16 v[156:159], a[4:7], v[12:15], v[156:159]
    s_waitcnt lgkmcnt(5)
    ds_read_b64_tr_b16 a[22:23], v232 offset:18432
    v_mfma_f32_16x16x32_bf16 v[144:147], a[8:11], v[16:19], v[144:147]
    buffer_load_dwordx4 v223, s[56:59], s82 offen offset:3072 lds
    v_mfma_f32_16x16x32_bf16 v[148:151], a[8:11], v[20:23], v[148:151]
    s_add_u32 m0, s81, 98304
    s_mov_b32 s82, 344192
    v_mfma_f32_16x16x32_bf16 v[152:155], a[8:11], v[24:27], v[152:155]
    ds_read_b64_tr_b16 a[24:25], v232 offset:20480
    v_mfma_f32_16x16x32_bf16 v[156:159], a[8:11], v[28:31], v[156:159]
    s_waitcnt lgkmcnt(5)
    ds_read_b64_tr_b16 a[26:27], v232 offset:22528
    v_mfma_f32_16x16x32_bf16 v[144:147], a[12:15], v[32:35], v[144:147]
    buffer_load_dwordx4 v220, s[56:59], s82 offen offset:0 lds
    v_mfma_f32_16x16x32_bf16 v[148:151], a[12:15], v[36:39], v[148:151]
    v_mfma_f32_16x16x32_bf16 v[152:155], a[12:15], v[40:43], v[152:155]
    ds_read_b64_tr_b16 a[28:29], v232 offset:24576
    v_mfma_f32_16x16x32_bf16 v[156:159], a[12:15], v[44:47], v[156:159]
    s_waitcnt lgkmcnt(5)
    ds_read_b64_tr_b16 a[30:31], v232 offset:26624
    v_mfma_f32_16x16x32_bf16 v[144:147], a[16:19], v[48:51], v[144:147]
    buffer_load_dwordx4 v221, s[56:59], s82 offen offset:1024 lds
    v_mfma_f32_16x16x32_bf16 v[148:151], a[16:19], v[52:55], v[148:151]
    v_mfma_f32_16x16x32_bf16 v[152:155], a[16:19], v[56:59], v[152:155]
    buffer_load_dwordx4 v222, s[56:59], s82 offen offset:2048 lds
    v_mfma_f32_16x16x32_bf16 v[156:159], a[16:19], v[60:63], v[156:159]
    s_waitcnt lgkmcnt(4)
    ds_read_b64_tr_b16 a[0:1], v232 offset:28672
    v_mfma_f32_16x16x32_bf16 v[144:147], a[20:23], v[64:67], v[144:147]
    ds_read_b64_tr_b16 a[2:3], v232 offset:30720
    v_mfma_f32_16x16x32_bf16 v[148:151], a[20:23], v[68:71], v[148:151]
    v_mfma_f32_16x16x32_bf16 v[152:155], a[20:23], v[72:75], v[152:155]
    s_waitcnt vmcnt(7)
    s_barrier
    v_mfma_f32_16x16x32_bf16 v[156:159], a[20:23], v[76:79], v[156:159]
    s_waitcnt lgkmcnt(4)
    buffer_load_dwordx4 v223, s[56:59], s82 offen offset:3072 lds
    v_mfma_f32_16x16x32_bf16 v[144:147], a[24:27], v[80:83], v[144:147]
    s_add_u32 m0, s81, 114688
    s_mov_b32 s82, 256
    v_mfma_f32_16x16x32_bf16 v[148:151], a[24:27], v[84:87], v[148:151]
    buffer_load_dwordx4 v220, s[56:59], s82 offen offset:0 lds
    v_mfma_f32_16x16x32_bf16 v[152:155], a[24:27], v[88:91], v[152:155]
    ds_read_b64_tr_b16 a[4:5], v232 offset:32768
    v_mfma_f32_16x16x32_bf16 v[156:159], a[24:27], v[92:95], v[156:159]
    s_waitcnt lgkmcnt(3)
    ds_read_b64_tr_b16 a[6:7], v232 offset:34816
    v_mfma_f32_16x16x32_bf16 v[144:147], a[28:31], v[96:99], v[144:147]
    buffer_load_dwordx4 v221, s[56:59], s82 offen offset:1024 lds
    v_mfma_f32_16x16x32_bf16 v[148:151], a[28:31], v[100:103], v[148:151]
    ds_read_b64_tr_b16 a[8:9], v232 offset:36864
    v_mfma_f32_16x16x32_bf16 v[152:155], a[28:31], v[104:107], v[152:155]
    ds_read_b64_tr_b16 a[10:11], v232 offset:38912
    v_mfma_f32_16x16x32_bf16 v[156:159], a[28:31], v[108:111], v[156:159]
    s_waitcnt lgkmcnt(4)
    ds_read_b64_tr_b16 a[12:13], v232 offset:40960
    v_mfma_f32_16x16x32_bf16 v[144:147], a[0:3], v[112:115], v[144:147]
    buffer_load_dwordx4 v222, s[56:59], s82 offen offset:2048 lds
    v_mfma_f32_16x16x32_bf16 v[148:151], a[0:3], v[116:119], v[148:151]
    ds_read_b64_tr_b16 a[14:15], v232 offset:43008
    v_mfma_f32_16x16x32_bf16 v[152:155], a[0:3], v[120:123], v[152:155]
    ds_read_b64_tr_b16 a[16:17], v232 offset:45056
    v_mfma_f32_16x16x32_bf16 v[156:159], a[0:3], v[124:127], v[156:159]
    s_waitcnt lgkmcnt(5)
    ds_read_b64_tr_b16 a[18:19], v232 offset:47104
    v_mfma_f32_16x16x32_bf16 v[128:131], a[4:7], a[32:35], 0
    buffer_load_dwordx4 v223, s[56:59], s82 offen offset:3072 lds
    v_mfma_f32_16x16x32_bf16 v[132:135], a[4:7], a[36:39], 0
    s_add_u32 m0, s81, 131072
    s_mov_b32 s82, 114944
    v_mfma_f32_16x16x32_bf16 v[136:139], a[4:7], a[40:43], 0
    buffer_load_dwordx4 v220, s[56:59], s82 offen offset:0 lds
    v_mfma_f32_16x16x32_bf16 v[140:143], a[4:7], a[44:47], 0
    s_waitcnt lgkmcnt(4)
    ds_read_b64_tr_b16 a[20:21], v232 offset:49152
    v_cvt_pk_bf16_f32 v160, v144, v145
    v_mfma_f32_16x16x32_bf16 v[128:131], a[8:11], a[48:51], v[128:131]
    ds_read_b64_tr_b16 a[22:23], v232 offset:51200
    v_cvt_pk_bf16_f32 v161, v146, v147
    v_mfma_f32_16x16x32_bf16 v[132:135], a[8:11], a[52:55], v[132:135]
    buffer_load_dwordx4 v221, s[56:59], s82 offen offset:1024 lds
    v_mfma_f32_16x16x32_bf16 v[136:139], a[8:11], a[56:59], v[136:139]
    ds_read_b64_tr_b16 a[24:25], v232 offset:53248
    v_cvt_pk_bf16_f32 v162, v148, v149
    v_mfma_f32_16x16x32_bf16 v[140:143], a[8:11], a[60:63], v[140:143]
    s_waitcnt lgkmcnt(5)
    ds_read_b64_tr_b16 a[26:27], v232 offset:55296
    v_cvt_pk_bf16_f32 v163, v150, v151
    v_mfma_f32_16x16x32_bf16 v[128:131], a[12:15], a[64:67], v[128:131]
    v_cvt_pk_bf16_f32 v164, v152, v153
    v_cvt_pk_bf16_f32 v165, v154, v155
    v_mfma_f32_16x16x32_bf16 v[132:135], a[12:15], a[68:71], v[132:135]
    buffer_load_dwordx4 v222, s[56:59], s82 offen offset:2048 lds
    v_mfma_f32_16x16x32_bf16 v[136:139], a[12:15], a[72:75], v[136:139]
    ds_read_b64_tr_b16 a[28:29], v232 offset:57344
    v_cvt_pk_bf16_f32 v166, v156, v157
    v_mfma_f32_16x16x32_bf16 v[140:143], a[12:15], a[76:79], v[140:143]
    s_waitcnt lgkmcnt(5)
    ds_read_b64_tr_b16 a[30:31], v232 offset:59392
    v_cvt_pk_bf16_f32 v167, v158, v159
    v_mfma_f32_16x16x32_bf16 v[128:131], a[16:19], a[80:83], v[128:131]
    buffer_load_dwordx4 v223, s[56:59], s82 offen offset:3072 lds
    v_mfma_f32_16x16x32_bf16 v[132:135], a[16:19], a[84:87], v[132:135]
    s_add_u32 m0, s81, 147456
    s_mov_b32 s82, 229632
    s_mov_b32 s83, 0
    v_mfma_f32_16x16x32_bf16 v[136:139], a[16:19], a[88:91], v[136:139]
    ds_read_b64_tr_b16 a[0:1], v232 offset:61440
    v_lshrrev_b32 v217, 4, v251
    v_mfma_f32_16x16x32_bf16 v[140:143], a[16:19], a[92:95], v[140:143]
    s_waitcnt lgkmcnt(5)
    ds_read_b64_tr_b16 a[2:3], v232 offset:63488
    v_lshlrev_b32 v217, 3, v217
    v_mfma_f32_16x16x32_bf16 v[128:131], a[20:23], a[96:99], v[128:131]
    buffer_load_dwordx4 v220, s[56:59], s82 offen offset:0 lds
    v_mfma_f32_16x16x32_bf16 v[132:135], a[20:23], a[100:103], v[132:135]
    v_and_b32 v216, 15, v251
    v_mul_u32_u24 v216, 896, v216
    v_mfma_f32_16x16x32_bf16 v[136:139], a[20:23], a[104:107], v[136:139]
    s_waitcnt vmcnt(9)
    s_barrier
    buffer_store_dwordx4 v[160:163], v211, s[64:67], s83 offen offset:0 sc1
    v_mfma_f32_16x16x32_bf16 v[140:143], a[20:23], a[108:111], v[140:143]
    s_waitcnt lgkmcnt(4)
    ds_read_b64_tr_b16 a[4:5], v232 offset:0
    v_mfma_f32_16x16x32_bf16 v[128:131], a[24:27], a[112:115], v[128:131]
    buffer_load_dwordx4 v221, s[56:59], s82 offen offset:1024 lds
    v_mfma_f32_16x16x32_bf16 v[132:135], a[24:27], a[116:119], v[132:135]
    s_mul_i32 s86, s84, 7
    ds_read_b64_tr_b16 a[6:7], v232 offset:2048
    v_mfma_f32_16x16x32_bf16 v[136:139], a[24:27], a[248:251], v[136:139]
    buffer_load_dwordx4 v222, s[56:59], s82 offen offset:2048 lds
    v_mfma_f32_16x16x32_bf16 v[140:143], a[24:27], v[168:171], v[140:143]
    s_waitcnt lgkmcnt(4)
    ds_read_b64_tr_b16 a[8:9], v232 offset:4096
    v_mfma_f32_16x16x32_bf16 v[128:131], a[28:31], v[172:175], v[128:131]
    s_add_u32 s86, s86, s85
    ds_read_b64_tr_b16 a[10:11], v232 offset:6144
    v_mfma_f32_16x16x32_bf16 v[132:135], a[28:31], v[176:179], v[132:135]
    buffer_load_dwordx4 v223, s[56:59], s82 offen offset:3072 lds
    v_mfma_f32_16x16x32_bf16 v[136:139], a[28:31], v[180:183], v[136:139]
    s_add_u32 m0, s81, 65536
    s_mov_b32 s82, 344320
    s_mul_i32 s87, s80, 56
    v_mfma_f32_16x16x32_bf16 v[140:143], a[28:31], v[184:187], v[140:143]
    s_waitcnt lgkmcnt(4)
    ds_read_b64_tr_b16 a[12:13], v232 offset:8192
    v_mfma_f32_16x16x32_bf16 v[128:131], a[0:3], v[188:191], v[128:131]
    buffer_store_dwordx4 v[164:167], v211, s[64:67], s83 offen offset:1024 sc1
    v_mfma_f32_16x16x32_bf16 v[132:135], a[0:3], v[192:195], v[132:135]
    buffer_load_dwordx4 v220, s[56:59], s82 offen offset:0 lds
    v_mfma_f32_16x16x32_bf16 v[136:139], a[0:3], v[196:199], v[136:139]
    s_add_u32 s87, s87, s86
    ds_read_b64_tr_b16 a[14:15], v232 offset:10240
    v_mfma_f32_16x16x32_bf16 v[140:143], a[0:3], v[200:203], v[140:143]
    s_waitcnt lgkmcnt(4)
    ds_read_b64_tr_b16 a[16:17], v232 offset:12288
    v_mfma_f32_16x16x32_bf16 v[128:131], a[4:7], v[0:3], v[128:131]
    buffer_load_dwordx4 v221, s[56:59], s82 offen offset:1024 lds
    v_mfma_f32_16x16x32_bf16 v[132:135], a[4:7], v[4:7], v[132:135]
    s_lshl_b32 s87, s87, 10
    ds_read_b64_tr_b16 a[18:19], v232 offset:14336
    v_add_u32 v207, s87, v253
    v_mfma_f32_16x16x32_bf16 v[136:139], a[4:7], v[8:11], v[136:139]
    s_mul_i32 s87, s86, 4682
    ds_read_b64_tr_b16 a[20:21], v233 offset:32768
    v_mfma_f32_16x16x32_bf16 v[140:143], a[4:7], v[12:15], v[140:143]
    s_waitcnt lgkmcnt(5)
    ds_read_b64_tr_b16 a[22:23], v233 offset:34816
    v_mfma_f32_16x16x32_bf16 v[128:131], a[8:11], v[16:19], v[128:131]
    buffer_load_dwordx4 v222, s[56:59], s82 offen offset:2048 lds
    v_mfma_f32_16x16x32_bf16 v[132:135], a[8:11], v[20:23], v[132:135]
    s_lshr_b32 s87, s87, 16
    s_mul_i32 s78, s87, 14
    s_sub_u32 s86, s86, s78
    v_mfma_f32_16x16x32_bf16 v[136:139], a[8:11], v[24:27], v[136:139]
    buffer_load_dwordx4 v223, s[56:59], s82 offen offset:3072 lds
    v_mfma_f32_16x16x32_bf16 v[140:143], a[8:11], v[28:31], v[140:143]
    s_waitcnt lgkmcnt(4)
    s_add_u32 m0, s81, 81920
    s_mov_b32 s82, 384
    v_mfma_f32_16x16x32_bf16 v[128:131], a[12:15], v[32:35], v[128:131]
    s_lshl_b32 s87, s87, 5
    ds_read_b64_tr_b16 a[24:25], v233 offset:36864
    v_mfma_f32_16x16x32_bf16 v[132:135], a[12:15], v[36:39], v[132:135]
    s_lshr_b32 s78, s86, 1
    ds_read_b64_tr_b16 a[26:27], v233 offset:38912
    v_mfma_f32_16x16x32_bf16 v[136:139], a[12:15], v[40:43], v[136:139]
    buffer_load_dwordx4 v220, s[56:59], s82 offen offset:0 lds
    v_mfma_f32_16x16x32_bf16 v[140:143], a[12:15], v[44:47], v[140:143]
    s_waitcnt lgkmcnt(4)
    ds_read_b64_tr_b16 a[28:29], v233 offset:40960
    v_mfma_f32_16x16x32_bf16 v[128:131], a[16:19], v[48:51], v[128:131]
    s_lshl_b32 s78, s78, 7
    ds_read_b64_tr_b16 a[30:31], v233 offset:43008
    v_mfma_f32_16x16x32_bf16 v[132:135], a[16:19], v[52:55], v[132:135]
    buffer_load_dwordx4 v221, s[56:59], s82 offen offset:1024 lds
    v_mfma_f32_16x16x32_bf16 v[136:139], a[16:19], v[56:59], v[136:139]
    s_add_u32 s87, s87, s78
    ds_read_b64_tr_b16 a[0:1], v233 offset:45056
    v_add_u32 v214, s87, v217
    v_mfma_f32_16x16x32_bf16 v[140:143], a[16:19], v[60:63], v[140:143]
    s_waitcnt lgkmcnt(5)
    ds_read_b64_tr_b16 a[2:3], v233 offset:47104
    v_mfma_f32_16x16x32_bf16 v[128:131], a[20:23], v[64:67], v[128:131]
    buffer_load_dwordx4 v222, s[56:59], s82 offen offset:2048 lds
    v_mfma_f32_16x16x32_bf16 v[132:135], a[20:23], v[68:71], v[132:135]
    s_and_b32 s86, s86, 1
    s_lshl_b32 s86, s86, 5
    s_lshl_b32 s78, s80, 6
    v_mfma_f32_16x16x32_bf16 v[136:139], a[20:23], v[72:75], v[136:139]
    s_waitcnt vmcnt(13)
    s_barrier
    s_add_u32 s86, s86, s78
    v_mfma_f32_16x16x32_bf16 v[140:143], a[20:23], v[76:79], v[140:143]
    s_waitcnt lgkmcnt(4)
    ds_read_b64_tr_b16 a[4:5], v233 offset:49152
    v_mfma_f32_16x16x32_bf16 v[128:131], a[24:27], v[80:83], v[128:131]
    buffer_load_dwordx4 v223, s[56:59], s82 offen offset:3072 lds
    v_mfma_f32_16x16x32_bf16 v[132:135], a[24:27], v[84:87], v[132:135]
    s_add_u32 m0, s81, 16384
    ds_read_b64_tr_b16 a[6:7], v233 offset:51200
    v_mfma_f32_16x16x32_bf16 v[136:139], a[24:27], v[88:91], v[136:139]
    s_mov_b32 s82, 115072
    ds_read_b64_tr_b16 a[8:9], v233 offset:53248
    v_mfma_f32_16x16x32_bf16 v[140:143], a[24:27], v[92:95], v[140:143]
    s_waitcnt lgkmcnt(5)
    ds_read_b64_tr_b16 a[10:11], v233 offset:55296
    v_mfma_f32_16x16x32_bf16 v[128:131], a[28:31], v[96:99], v[128:131]
    buffer_load_dwordx4 v220, s[56:59], s82 offen offset:0 lds
    v_mfma_f32_16x16x32_bf16 v[132:135], a[28:31], v[100:103], v[132:135]
    s_mul_i32 s86, s86, 896
    v_add3_u32 v212, v216, v214, s86
    v_mfma_f32_16x16x32_bf16 v[136:139], a[28:31], v[104:107], v[136:139]
    buffer_load_dwordx4 v221, s[56:59], s82 offen offset:1024 lds
    v_mfma_f32_16x16x32_bf16 v[140:143], a[28:31], v[108:111], v[140:143]
    s_waitcnt lgkmcnt(4)
    ds_read_b64_tr_b16 a[12:13], v233 offset:57344
    v_mfma_f32_16x16x32_bf16 v[128:131], a[0:3], v[112:115], v[128:131]
    s_mul_i32 s86, s84, 7
    ds_read_b64_tr_b16 a[14:15], v233 offset:59392
    v_mfma_f32_16x16x32_bf16 v[132:135], a[0:3], v[116:119], v[132:135]
    s_add_u32 s86, s86, s85
    s_add_u32 s86, s86, 4
    s_mul_i32 s87, s80, 56
    v_mfma_f32_16x16x32_bf16 v[136:139], a[0:3], v[120:123], v[136:139]
    buffer_load_dwordx4 v222, s[56:59], s82 offen offset:2048 lds
    v_mfma_f32_16x16x32_bf16 v[140:143], a[0:3], v[124:127], v[140:143]
    s_waitcnt lgkmcnt(4)
    ds_read_b64_tr_b16 a[16:17], v233 offset:61440
    v_mfma_f32_16x16x32_bf16 v[144:147], a[4:7], a[32:35], 0
    s_add_u32 s87, s87, s86
    ds_read_b64_tr_b16 a[18:19], v233 offset:63488
    v_mfma_f32_16x16x32_bf16 v[148:151], a[4:7], a[36:39], 0
    buffer_load_dwordx4 v223, s[56:59], s82 offen offset:3072 lds
    v_mfma_f32_16x16x32_bf16 v[152:155], a[4:7], a[40:43], 0
    s_add_u32 m0, s81, 32768
    s_mov_b32 s82, 229760
    v_cvt_pk_bf16_f32 v160, v128, v129
    v_mfma_f32_16x16x32_bf16 v[156:159], a[4:7], a[44:47], 0
    s_waitcnt lgkmcnt(4)
    ds_read_b64_tr_b16 a[20:21], v234 offset:0
    v_cvt_pk_bf16_f32 v161, v130, v131
    v_mfma_f32_16x16x32_bf16 v[144:147], a[8:11], a[48:51], v[144:147]
    buffer_load_dwordx4 v220, s[56:59], s82 offen offset:0 lds
    v_mfma_f32_16x16x32_bf16 v[148:151], a[8:11], a[52:55], v[148:151]
    s_lshl_b32 s87, s87, 10
    ds_read_b64_tr_b16 a[22:23], v234 offset:2048
    v_cvt_pk_bf16_f32 v162, v132, v133
    v_mfma_f32_16x16x32_bf16 v[152:155], a[8:11], a[56:59], v[152:155]
    s_lshl_b32 s35, s85, 29
    ds_read_b64_tr_b16 a[24:25], v234 offset:4096
    v_cvt_pk_bf16_f32 v163, v134, v135
    v_mfma_f32_16x16x32_bf16 v[156:159], a[8:11], a[60:63], v[156:159]
    s_waitcnt lgkmcnt(5)
    ds_read_b64_tr_b16 a[26:27], v234 offset:6144
    v_cvt_pk_bf16_f32 v164, v136, v137
    v_mfma_f32_16x16x32_bf16 v[144:147], a[12:15], a[64:67], v[144:147]
    buffer_load_dwordx4 v221, s[56:59], s82 offen offset:1024 lds
    v_mfma_f32_16x16x32_bf16 v[148:151], a[12:15], a[68:71], v[148:151]
    s_lshl_b32 s78, s85, 30
    v_cvt_pk_bf16_f32 v165, v138, v139
    v_cvt_pk_bf16_f32 v166, v140, v141
    v_mfma_f32_16x16x32_bf16 v[152:155], a[12:15], a[72:75], v[152:155]
    s_and_b32 s35, s35, s78
    ds_read_b64_tr_b16 a[28:29], v234 offset:8192
    v_cvt_pk_bf16_f32 v167, v142, v143
    v_mfma_f32_16x16x32_bf16 v[156:159], a[12:15], a[76:79], v[156:159]
    s_waitcnt lgkmcnt(5)
    ds_read_b64_tr_b16 a[30:31], v234 offset:10240
    v_mfma_f32_16x16x32_bf16 v[144:147], a[16:19], a[80:83], v[144:147]
    buffer_load_dwordx4 v222, s[56:59], s82 offen offset:2048 lds
    v_mfma_f32_16x16x32_bf16 v[148:151], a[16:19], a[84:87], v[148:151]
    s_mov_b32 s83, 2048
    s_add_u32 s87, s87, s35
    v_add_u32 v208, s87, v253
    v_mfma_f32_16x16x32_bf16 v[152:155], a[16:19], a[88:91], v[152:155]
    buffer_load_dwordx4 v223, s[56:59], s82 offen offset:3072 lds
    v_mfma_f32_16x16x32_bf16 v[156:159], a[16:19], a[92:95], v[156:159]
    s_waitcnt lgkmcnt(4)
    s_add_u32 m0, s81, 0
    s_mov_b32 s82, 344448
    v_mfma_f32_16x16x32_bf16 v[144:147], a[20:23], a[96:99], v[144:147]
    s_mul_i32 s87, s86, 4682
    ds_read_b64_tr_b16 a[0:1], v234 offset:12288
    v_mfma_f32_16x16x32_bf16 v[148:151], a[20:23], a[100:103], v[148:151]
    buffer_load_dwordx4 v220, s[56:59], s82 offen offset:0 lds
    v_mfma_f32_16x16x32_bf16 v[152:155], a[20:23], a[104:107], v[152:155]
    s_waitcnt vmcnt(13)
    s_barrier
    s_lshr_b32 s87, s87, 16
    v_mfma_f32_16x16x32_bf16 v[156:159], a[20:23], a[108:111], v[156:159]
    s_waitcnt lgkmcnt(3)
    ds_read_b64_tr_b16 a[2:3], v234 offset:14336
    v_mfma_f32_16x16x32_bf16 v[144:147], a[24:27], a[112:115], v[144:147]
    buffer_store_dwordx4 v[160:163], v211, s[64:67], s83 offen offset:0 sc1
    v_mfma_f32_16x16x32_bf16 v[148:151], a[24:27], a[116:119], v[148:151]
    buffer_load_dwordx4 v221, s[56:59], s82 offen offset:1024 lds
    v_mfma_f32_16x16x32_bf16 v[152:155], a[24:27], a[248:251], v[152:155]
    s_mul_i32 s78, s87, 14
    ds_read_b64_tr_b16 a[4:5], v234 offset:16384
    v_mfma_f32_16x16x32_bf16 v[156:159], a[24:27], v[168:171], v[156:159]
    s_waitcnt lgkmcnt(3)
    ds_read_b64_tr_b16 a[6:7], v234 offset:18432
    v_mfma_f32_16x16x32_bf16 v[144:147], a[28:31], v[172:175], v[144:147]
    buffer_load_dwordx4 v222, s[56:59], s82 offen offset:2048 lds
    v_mfma_f32_16x16x32_bf16 v[148:151], a[28:31], v[176:179], v[148:151]
    s_sub_u32 s86, s86, s78
    ds_read_b64_tr_b16 a[8:9], v234 offset:20480
    v_mfma_f32_16x16x32_bf16 v[152:155], a[28:31], v[180:183], v[152:155]
    s_lshl_b32 s87, s87, 5
    ds_read_b64_tr_b16 a[10:11], v234 offset:22528
    v_mfma_f32_16x16x32_bf16 v[156:159], a[28:31], v[184:187], v[156:159]
    s_waitcnt lgkmcnt(4)
    ds_read_b64_tr_b16 a[12:13], v234 offset:24576
    v_mfma_f32_16x16x32_bf16 v[144:147], a[0:3], v[188:191], v[144:147]
    buffer_load_dwordx4 v223, s[56:59], s82 offen offset:3072 lds
    v_mfma_f32_16x16x32_bf16 v[148:151], a[0:3], v[192:195], v[148:151]
    s_add_u32 m0, s81, 49152
    ds_read_b64_tr_b16 a[14:15], v234 offset:26624
    v_mfma_f32_16x16x32_bf16 v[152:155], a[0:3], v[196:199], v[152:155]
    buffer_store_dwordx4 v[164:167], v211, s[64:67], s83 offen offset:1024 sc1
    v_mfma_f32_16x16x32_bf16 v[156:159], a[0:3], v[200:203], v[156:159]
    s_waitcnt lgkmcnt(4)
    s_mov_b32 s82, 512
    s_lshr_b32 s78, s86, 1
    v_mfma_f32_16x16x32_bf16 v[144:147], a[4:7], v[0:3], v[144:147]
    buffer_load_dwordx4 v220, s[56:59], s82 offen offset:0 lds
    v_mfma_f32_16x16x32_bf16 v[148:151], a[4:7], v[4:7], v[148:151]
    s_lshl_b32 s78, s78, 7
    ds_read_b64_tr_b16 a[16:17], v234 offset:28672
    v_mfma_f32_16x16x32_bf16 v[152:155], a[4:7], v[8:11], v[152:155]
    s_add_u32 s87, s87, s78
    ds_read_b64_tr_b16 a[18:19], v234 offset:30720
    v_add_u32 v215, s87, v217
    v_mfma_f32_16x16x32_bf16 v[156:159], a[4:7], v[12:15], v[156:159]
    s_waitcnt lgkmcnt(4)
    buffer_load_dwordx4 v221, s[56:59], s82 offen offset:1024 lds
    v_mfma_f32_16x16x32_bf16 v[144:147], a[8:11], v[16:19], v[144:147]
    s_and_b32 s86, s86, 1
    ds_read_b64_tr_b16 a[20:21], v233 offset:0
    v_mfma_f32_16x16x32_bf16 v[148:151], a[8:11], v[20:23], v[148:151]
    buffer_load_dwordx4 v222, s[56:59], s82 offen offset:2048 lds
    v_mfma_f32_16x16x32_bf16 v[152:155], a[8:11], v[24:27], v[152:155]
    s_lshl_b32 s86, s86, 5
    ds_read_b64_tr_b16 a[22:23], v233 offset:2048
    v_mfma_f32_16x16x32_bf16 v[156:159], a[8:11], v[28:31], v[156:159]
    s_waitcnt lgkmcnt(4)
    ds_read_b64_tr_b16 a[24:25], v233 offset:4096
    v_mfma_f32_16x16x32_bf16 v[144:147], a[12:15], v[32:35], v[144:147]
    buffer_load_dwordx4 v223, s[56:59], s82 offen offset:3072 lds
    v_mfma_f32_16x16x32_bf16 v[148:151], a[12:15], v[36:39], v[148:151]
    s_add_u32 m0, s81, 98304
    ds_read_b64_tr_b16 a[26:27], v233 offset:6144
    v_mfma_f32_16x16x32_bf16 v[152:155], a[12:15], v[40:43], v[152:155]
    s_mov_b32 s82, 115200
    ds_read_b64_tr_b16 a[28:29], v233 offset:8192
    v_mfma_f32_16x16x32_bf16 v[156:159], a[12:15], v[44:47], v[156:159]
    s_waitcnt lgkmcnt(5)
    ds_read_b64_tr_b16 a[30:31], v233 offset:10240
    v_mfma_f32_16x16x32_bf16 v[144:147], a[16:19], v[48:51], v[144:147]
    buffer_load_dwordx4 v220, s[56:59], s82 offen offset:0 lds
    v_mfma_f32_16x16x32_bf16 v[148:151], a[16:19], v[52:55], v[148:151]
    s_lshl_b32 s78, s80, 6
    s_add_u32 s86, s86, s78
    s_mul_i32 s86, s86, 896
    v_mfma_f32_16x16x32_bf16 v[152:155], a[16:19], v[56:59], v[152:155]
    s_add_u32 s86, s86, s35
    ds_read_b64_tr_b16 a[0:1], v233 offset:12288
    v_add3_u32 v213, v216, v215, s86
    v_mfma_f32_16x16x32_bf16 v[156:159], a[16:19], v[60:63], v[156:159]
    s_waitcnt lgkmcnt(5)
    ds_read_b64_tr_b16 a[2:3], v233 offset:14336
    v_mfma_f32_16x16x32_bf16 v[144:147], a[20:23], v[64:67], v[144:147]
    buffer_load_dwordx4 v221, s[56:59], s82 offen offset:1024 lds
    v_mfma_f32_16x16x32_bf16 v[148:151], a[20:23], v[68:71], v[148:151]
    v_mfma_f32_16x16x32_bf16 v[152:155], a[20:23], v[72:75], v[152:155]
    s_waitcnt vmcnt(16)
    s_barrier
    v_mfma_f32_16x16x32_bf16 v[156:159], a[20:23], v[76:79], v[156:159]
    s_waitcnt lgkmcnt(4)
    buffer_load_dwordx4 v222, s[56:59], s82 offen offset:2048 lds
    v_mfma_f32_16x16x32_bf16 v[144:147], a[24:27], v[80:83], v[144:147]
    ds_read_b64_tr_b16 a[4:5], v233 offset:16384
    v_mfma_f32_16x16x32_bf16 v[148:151], a[24:27], v[84:87], v[148:151]
    ds_read_b64_tr_b16 a[6:7], v233 offset:18432
    v_mfma_f32_16x16x32_bf16 v[152:155], a[24:27], v[88:91], v[152:155]
    buffer_load_dwordx4 v223, s[56:59], s82 offen offset:3072 lds
    v_mfma_f32_16x16x32_bf16 v[156:159], a[24:27], v[92:95], v[156:159]
    s_waitcnt lgkmcnt(4)
    s_add_u32 m0, s81, 114688
    s_mov_b32 s82, 229888
    v_mfma_f32_16x16x32_bf16 v[144:147], a[28:31], v[96:99], v[144:147]
    ds_read_b64_tr_b16 a[8:9], v233 offset:20480
    v_mfma_f32_16x16x32_bf16 v[148:151], a[28:31], v[100:103], v[148:151]
    buffer_load_dwordx4 v220, s[56:59], s82 offen offset:0 lds
    v_mfma_f32_16x16x32_bf16 v[152:155], a[28:31], v[104:107], v[152:155]
    ds_read_b64_tr_b16 a[10:11], v233 offset:22528
    v_mfma_f32_16x16x32_bf16 v[156:159], a[28:31], v[108:111], v[156:159]
    s_waitcnt lgkmcnt(4)
    ds_read_b64_tr_b16 a[12:13], v233 offset:24576
    v_mfma_f32_16x16x32_bf16 v[144:147], a[0:3], v[112:115], v[144:147]
    buffer_load_dwordx4 v221, s[56:59], s82 offen offset:1024 lds
    v_mfma_f32_16x16x32_bf16 v[148:151], a[0:3], v[116:119], v[148:151]
    ds_read_b64_tr_b16 a[14:15], v233 offset:26624
    v_mfma_f32_16x16x32_bf16 v[152:155], a[0:3], v[120:123], v[152:155]
    ds_read_b64_tr_b16 a[16:17], v233 offset:28672
    v_mfma_f32_16x16x32_bf16 v[156:159], a[0:3], v[124:127], v[156:159]
    s_waitcnt lgkmcnt(5)
    ds_read_b64_tr_b16 a[18:19], v233 offset:30720
    v_mfma_f32_16x16x32_bf16 v[128:131], a[4:7], a[32:35], 0
    buffer_load_dwordx4 v222, s[56:59], s82 offen offset:2048 lds
    v_mfma_f32_16x16x32_bf16 v[132:135], a[4:7], a[36:39], 0
    v_mfma_f32_16x16x32_bf16 v[136:139], a[4:7], a[40:43], 0
    ds_read_b64_tr_b16 a[20:21], v232 offset:16384
    v_cvt_pk_bf16_f32 v160, v144, v145
    v_mfma_f32_16x16x32_bf16 v[140:143], a[4:7], a[44:47], 0
    s_waitcnt lgkmcnt(5)
    ds_read_b64_tr_b16 a[22:23], v232 offset:18432
    v_cvt_pk_bf16_f32 v161, v146, v147
    v_mfma_f32_16x16x32_bf16 v[128:131], a[8:11], a[48:51], v[128:131]
    buffer_load_dwordx4 v223, s[56:59], s82 offen offset:3072 lds
    v_mfma_f32_16x16x32_bf16 v[132:135], a[8:11], a[52:55], v[132:135]
    s_add_u32 m0, s81, 131072
    s_mov_b32 s82, 344576
    v_cvt_pk_bf16_f32 v162, v148, v149
    v_mfma_f32_16x16x32_bf16 v[136:139], a[8:11], a[56:59], v[136:139]
    buffer_load_dwordx4 v220, s[56:59], s82 offen offset:0 lds
    v_mfma_f32_16x16x32_bf16 v[140:143], a[8:11], a[60:63], v[140:143]
    s_waitcnt lgkmcnt(4)
    ds_read_b64_tr_b16 a[24:25], v232 offset:20480
    v_cvt_pk_bf16_f32 v163, v150, v151
    v_mfma_f32_16x16x32_bf16 v[128:131], a[12:15], a[64:67], v[128:131]
    ds_read_b64_tr_b16 a[26:27], v232 offset:22528
    v_cvt_pk_bf16_f32 v164, v152, v153
    v_mfma_f32_16x16x32_bf16 v[132:135], a[12:15], a[68:71], v[132:135]
    v_cvt_pk_bf16_f32 v165, v154, v155
    v_cvt_pk_bf16_f32 v166, v156, v157
    v_mfma_f32_16x16x32_bf16 v[136:139], a[12:15], a[72:75], v[136:139]
    buffer_load_dwordx4 v221, s[56:59], s82 offen offset:1024 lds
    v_mfma_f32_16x16x32_bf16 v[140:143], a[12:15], a[76:79], v[140:143]
    s_waitcnt lgkmcnt(4)
    ds_read_b64_tr_b16 a[28:29], v232 offset:24576
    v_cvt_pk_bf16_f32 v167, v158, v159
    v_mfma_f32_16x16x32_bf16 v[128:131], a[16:19], a[80:83], v[128:131]
    s_mov_b32 s83, 4096
    ds_read_b64_tr_b16 a[30:31], v232 offset:26624
    v_mfma_f32_16x16x32_bf16 v[132:135], a[16:19], a[84:87], v[132:135]
    buffer_load_dwordx4 v222, s[56:59], s82 offen offset:2048 lds
    v_mfma_f32_16x16x32_bf16 v[136:139], a[16:19], a[88:91], v[136:139]
    ds_read_b64_tr_b16 a[0:1], v232 offset:28672
    v_mfma_f32_16x16x32_bf16 v[140:143], a[16:19], a[92:95], v[140:143]
    s_waitcnt lgkmcnt(5)
    ds_read_b64_tr_b16 a[2:3], v232 offset:30720
    v_mfma_f32_16x16x32_bf16 v[128:131], a[20:23], a[96:99], v[128:131]
    buffer_load_dwordx4 v223, s[56:59], s82 offen offset:3072 lds
    v_mfma_f32_16x16x32_bf16 v[132:135], a[20:23], a[100:103], v[132:135]
    s_add_u32 m0, s81, 147456
    s_mov_b32 s82, 640
    v_mfma_f32_16x16x32_bf16 v[136:139], a[20:23], a[104:107], v[136:139]
    s_waitcnt vmcnt(17)
    s_barrier
    v_mfma_f32_16x16x32_bf16 v[140:143], a[20:23], a[108:111], v[140:143]
    s_waitcnt lgkmcnt(4)
    ds_read_b64_tr_b16 a[4:5], v232 offset:32768
    v_mfma_f32_16x16x32_bf16 v[128:131], a[24:27], a[112:115], v[128:131]
    buffer_load_dwordx4 v220, s[56:59], s82 offen offset:0 lds
    v_mfma_f32_16x16x32_bf16 v[132:135], a[24:27], a[116:119], v[132:135]
    ds_read_b64_tr_b16 a[6:7], v232 offset:34816
    v_mfma_f32_16x16x32_bf16 v[136:139], a[24:27], a[248:251], v[136:139]
    buffer_store_dwordx4 v[160:163], v211, s[64:67], s83 offen offset:0 sc1
    v_mfma_f32_16x16x32_bf16 v[140:143], a[24:27], v[168:171], v[140:143]
    s_waitcnt lgkmcnt(4)
    ds_read_b64_tr_b16 a[8:9], v232 offset:36864
    v_mfma_f32_16x16x32_bf16 v[128:131], a[28:31], v[172:175], v[128:131]
    buffer_load_dwordx4 v221, s[56:59], s82 offen offset:1024 lds
    v_mfma_f32_16x16x32_bf16 v[132:135], a[28:31], v[176:179], v[132:135]
    ds_read_b64_tr_b16 a[10:11], v232 offset:38912
    v_mfma_f32_16x16x32_bf16 v[136:139], a[28:31], v[180:183], v[136:139]
    buffer_load_dwordx4 v222, s[56:59], s82 offen offset:2048 lds
    v_mfma_f32_16x16x32_bf16 v[140:143], a[28:31], v[184:187], v[140:143]
    s_waitcnt lgkmcnt(4)
    ds_read_b64_tr_b16 a[12:13], v232 offset:40960
    v_mfma_f32_16x16x32_bf16 v[128:131], a[0:3], v[188:191], v[128:131]
    ds_read_b64_tr_b16 a[14:15], v232 offset:43008
    v_mfma_f32_16x16x32_bf16 v[132:135], a[0:3], v[192:195], v[132:135]
    buffer_load_dwordx4 v223, s[56:59], s82 offen offset:3072 lds
    v_mfma_f32_16x16x32_bf16 v[136:139], a[0:3], v[196:199], v[136:139]
    s_add_u32 m0, s81, 65536
    s_mov_b32 s82, 115328
    v_mfma_f32_16x16x32_bf16 v[140:143], a[0:3], v[200:203], v[140:143]
    s_waitcnt lgkmcnt(4)
    ds_read_b64_tr_b16 a[16:17], v232 offset:45056
    v_mfma_f32_16x16x32_bf16 v[128:131], a[4:7], v[0:3], v[128:131]
    buffer_store_dwordx4 v[164:167], v211, s[64:67], s83 offen offset:1024 sc1
    v_mfma_f32_16x16x32_bf16 v[132:135], a[4:7], v[4:7], v[132:135]
    buffer_load_dwordx4 v220, s[56:59], s82 offen offset:0 lds
    v_mfma_f32_16x16x32_bf16 v[136:139], a[4:7], v[8:11], v[136:139]
    ds_read_b64_tr_b16 a[18:19], v232 offset:47104
    v_mfma_f32_16x16x32_bf16 v[140:143], a[4:7], v[12:15], v[140:143]
    s_waitcnt lgkmcnt(4)
    ds_read_b64_tr_b16 a[20:21], v232 offset:0
    v_mfma_f32_16x16x32_bf16 v[128:131], a[8:11], v[16:19], v[128:131]
    buffer_load_dwordx4 v221, s[56:59], s82 offen offset:1024 lds
    v_mfma_f32_16x16x32_bf16 v[132:135], a[8:11], v[20:23], v[132:135]
    ds_read_b64_tr_b16 a[22:23], v232 offset:2048
    v_mfma_f32_16x16x32_bf16 v[136:139], a[8:11], v[24:27], v[136:139]
    ds_read_b64_tr_b16 a[24:25], v232 offset:4096
    v_mfma_f32_16x16x32_bf16 v[140:143], a[8:11], v[28:31], v[140:143]
    s_waitcnt lgkmcnt(5)
    ds_read_b64_tr_b16 a[26:27], v232 offset:6144
    v_mfma_f32_16x16x32_bf16 v[128:131], a[12:15], v[32:35], v[128:131]
    buffer_load_dwordx4 v222, s[56:59], s82 offen offset:2048 lds
    v_mfma_f32_16x16x32_bf16 v[132:135], a[12:15], v[36:39], v[132:135]
    v_mfma_f32_16x16x32_bf16 v[136:139], a[12:15], v[40:43], v[136:139]
    ds_read_b64_tr_b16 a[28:29], v232 offset:8192
    v_mfma_f32_16x16x32_bf16 v[140:143], a[12:15], v[44:47], v[140:143]
    s_waitcnt lgkmcnt(5)
    ds_read_b64_tr_b16 a[30:31], v232 offset:10240
    v_mfma_f32_16x16x32_bf16 v[128:131], a[16:19], v[48:51], v[128:131]
    buffer_load_dwordx4 v223, s[56:59], s82 offen offset:3072 lds
    v_mfma_f32_16x16x32_bf16 v[132:135], a[16:19], v[52:55], v[132:135]
    s_add_u32 m0, s81, 81920
    s_mov_b32 s82, 230016
    v_mfma_f32_16x16x32_bf16 v[136:139], a[16:19], v[56:59], v[136:139]
    buffer_load_dwordx4 v220, s[56:59], s82 offen offset:0 lds
    v_mfma_f32_16x16x32_bf16 v[140:143], a[16:19], v[60:63], v[140:143]
    s_waitcnt lgkmcnt(4)
    ds_read_b64_tr_b16 a[0:1], v232 offset:12288
    v_mfma_f32_16x16x32_bf16 v[128:131], a[20:23], v[64:67], v[128:131]
    ds_read_b64_tr_b16 a[2:3], v232 offset:14336
    v_mfma_f32_16x16x32_bf16 v[132:135], a[20:23], v[68:71], v[132:135]
    buffer_load_dwordx4 v221, s[56:59], s82 offen offset:1024 lds
    v_mfma_f32_16x16x32_bf16 v[136:139], a[20:23], v[72:75], v[136:139]
    s_waitcnt vmcnt(20)
    s_barrier
    v_mfma_f32_16x16x32_bf16 v[140:143], a[20:23], v[76:79], v[140:143]
    s_waitcnt lgkmcnt(4)
    ds_read_b64_tr_b16 a[4:5], v232 offset:49152
    v_mfma_f32_16x16x32_bf16 v[128:131], a[24:27], v[80:83], v[128:131]
    buffer_load_dwordx4 v222, s[56:59], s82 offen offset:2048 lds
    v_mfma_f32_16x16x32_bf16 v[132:135], a[24:27], v[84:87], v[132:135]
    ds_read_b64_tr_b16 a[6:7], v232 offset:51200
    v_mfma_f32_16x16x32_bf16 v[136:139], a[24:27], v[88:91], v[136:139]
    ds_read_b64_tr_b16 a[8:9], v232 offset:53248
    v_mfma_f32_16x16x32_bf16 v[140:143], a[24:27], v[92:95], v[140:143]
    s_waitcnt lgkmcnt(5)
    ds_read_b64_tr_b16 a[10:11], v232 offset:55296
    v_mfma_f32_16x16x32_bf16 v[128:131], a[28:31], v[96:99], v[128:131]
    buffer_load_dwordx4 v223, s[56:59], s82 offen offset:3072 lds
    v_mfma_f32_16x16x32_bf16 v[132:135], a[28:31], v[100:103], v[132:135]
    s_add_u32 m0, s81, 16384
    s_mov_b32 s82, 344704
    v_mfma_f32_16x16x32_bf16 v[136:139], a[28:31], v[104:107], v[136:139]
    ds_read_b64_tr_b16 a[12:13], v232 offset:57344
    v_mfma_f32_16x16x32_bf16 v[140:143], a[28:31], v[108:111], v[140:143]
    s_waitcnt lgkmcnt(5)
    ds_read_b64_tr_b16 a[14:15], v232 offset:59392
    v_mfma_f32_16x16x32_bf16 v[128:131], a[0:3], v[112:115], v[128:131]
    buffer_load_dwordx4 v220, s[56:59], s82 offen offset:0 lds
    v_mfma_f32_16x16x32_bf16 v[132:135], a[0:3], v[116:119], v[132:135]
    v_mfma_f32_16x16x32_bf16 v[136:139], a[0:3], v[120:123], v[136:139]
    buffer_load_dwordx4 v221, s[56:59], s82 offen offset:1024 lds
    v_mfma_f32_16x16x32_bf16 v[140:143], a[0:3], v[124:127], v[140:143]
    s_waitcnt lgkmcnt(4)
    ds_read_b64_tr_b16 a[16:17], v232 offset:61440
    v_mfma_f32_16x16x32_bf16 v[144:147], a[4:7], a[32:35], 0
    ds_read_b64_tr_b16 a[18:19], v232 offset:63488
    v_mfma_f32_16x16x32_bf16 v[148:151], a[4:7], a[36:39], 0
    v_mfma_f32_16x16x32_bf16 v[152:155], a[4:7], a[40:43], 0
    buffer_load_dwordx4 v222, s[56:59], s82 offen offset:2048 lds
    v_mfma_f32_16x16x32_bf16 v[156:159], a[4:7], a[44:47], 0
    s_waitcnt lgkmcnt(4)
    ds_read_b64_tr_b16 a[20:21], v233 offset:32768
    v_cvt_pk_bf16_f32 v160, v128, v129
    v_mfma_f32_16x16x32_bf16 v[144:147], a[8:11], a[48:51], v[144:147]
    ds_read_b64_tr_b16 a[22:23], v233 offset:34816
    v_cvt_pk_bf16_f32 v161, v130, v131
    v_mfma_f32_16x16x32_bf16 v[148:151], a[8:11], a[52:55], v[148:151]
    buffer_load_dwordx4 v223, s[56:59], s82 offen offset:3072 lds
    v_mfma_f32_16x16x32_bf16 v[152:155], a[8:11], a[56:59], v[152:155]
    s_add_u32 m0, s81, 32768
    s_mov_b32 s82, 768
    v_cvt_pk_bf16_f32 v162, v132, v133
    v_mfma_f32_16x16x32_bf16 v[156:159], a[8:11], a[60:63], v[156:159]
    s_waitcnt lgkmcnt(4)
    ds_read_b64_tr_b16 a[24:25], v233 offset:36864
    v_cvt_pk_bf16_f32 v163, v134, v135
    v_mfma_f32_16x16x32_bf16 v[144:147], a[12:15], a[64:67], v[144:147]
    buffer_load_dwordx4 v220, s[56:59], s82 offen offset:0 lds
    v_mfma_f32_16x16x32_bf16 v[148:151], a[12:15], a[68:71], v[148:151]
    ds_read_b64_tr_b16 a[26:27], v233 offset:38912
    v_cvt_pk_bf16_f32 v164, v136, v137
    v_mfma_f32_16x16x32_bf16 v[152:155], a[12:15], a[72:75], v[152:155]
    ds_read_b64_tr_b16 a[28:29], v233 offset:40960
    v_cvt_pk_bf16_f32 v165, v138, v139
    v_mfma_f32_16x16x32_bf16 v[156:159], a[12:15], a[76:79], v[156:159]
    s_waitcnt lgkmcnt(5)
    ds_read_b64_tr_b16 a[30:31], v233 offset:43008
    v_cvt_pk_bf16_f32 v166, v140, v141
    v_mfma_f32_16x16x32_bf16 v[144:147], a[16:19], a[80:83], v[144:147]
    buffer_load_dwordx4 v221, s[56:59], s82 offen offset:1024 lds
    v_mfma_f32_16x16x32_bf16 v[148:151], a[16:19], a[84:87], v[148:151]
    v_cvt_pk_bf16_f32 v167, v142, v143
    v_mfma_f32_16x16x32_bf16 v[152:155], a[16:19], a[88:91], v[152:155]
    s_mov_b32 s83, 6144
    ds_read_b64_tr_b16 a[0:1], v233 offset:45056
    v_mfma_f32_16x16x32_bf16 v[156:159], a[16:19], a[92:95], v[156:159]
    s_waitcnt lgkmcnt(5)
    ds_read_b64_tr_b16 a[2:3], v233 offset:47104
    v_mfma_f32_16x16x32_bf16 v[144:147], a[20:23], a[96:99], v[144:147]
    buffer_load_dwordx4 v222, s[56:59], s82 offen offset:2048 lds
    v_mfma_f32_16x16x32_bf16 v[148:151], a[20:23], a[100:103], v[148:151]
    v_mfma_f32_16x16x32_bf16 v[152:155], a[20:23], a[104:107], v[152:155]
    s_waitcnt vmcnt(21)
    s_barrier
    v_mfma_f32_16x16x32_bf16 v[156:159], a[20:23], a[108:111], v[156:159]
    s_waitcnt lgkmcnt(4)
    buffer_load_dwordx4 v223, s[56:59], s82 offen offset:3072 lds
    v_mfma_f32_16x16x32_bf16 v[144:147], a[24:27], a[112:115], v[144:147]
    s_add_u32 m0, s81, 0
    s_mov_b32 s82, 115456
    v_mfma_f32_16x16x32_bf16 v[148:151], a[24:27], a[116:119], v[148:151]
    buffer_load_dwordx4 v220, s[56:59], s82 offen offset:0 lds
    v_mfma_f32_16x16x32_bf16 v[152:155], a[24:27], a[248:251], v[152:155]
    ds_read_b64_tr_b16 a[4:5], v233 offset:49152
    v_mfma_f32_16x16x32_bf16 v[156:159], a[24:27], v[168:171], v[156:159]
    s_waitcnt lgkmcnt(3)
    ds_read_b64_tr_b16 a[6:7], v233 offset:51200
    v_mfma_f32_16x16x32_bf16 v[144:147], a[28:31], v[172:175], v[144:147]
    buffer_store_dwordx4 v[160:163], v211, s[64:67], s83 offen offset:0 sc1
    v_mfma_f32_16x16x32_bf16 v[148:151], a[28:31], v[176:179], v[148:151]
    buffer_load_dwordx4 v221, s[56:59], s82 offen offset:1024 lds
    v_mfma_f32_16x16x32_bf16 v[152:155], a[28:31], v[180:183], v[152:155]
    ds_read_b64_tr_b16 a[8:9], v233 offset:53248
    v_mfma_f32_16x16x32_bf16 v[156:159], a[28:31], v[184:187], v[156:159]
    s_waitcnt lgkmcnt(3)
    ds_read_b64_tr_b16 a[10:11], v233 offset:55296
    v_mfma_f32_16x16x32_bf16 v[144:147], a[0:3], v[188:191], v[144:147]
    buffer_load_dwordx4 v222, s[56:59], s82 offen offset:2048 lds
    v_mfma_f32_16x16x32_bf16 v[148:151], a[0:3], v[192:195], v[148:151]
    ds_read_b64_tr_b16 a[12:13], v233 offset:57344
    v_mfma_f32_16x16x32_bf16 v[152:155], a[0:3], v[196:199], v[152:155]
    ds_read_b64_tr_b16 a[14:15], v233 offset:59392
    v_mfma_f32_16x16x32_bf16 v[156:159], a[0:3], v[200:203], v[156:159]
    s_waitcnt lgkmcnt(4)
    ds_read_b64_tr_b16 a[16:17], v233 offset:61440
    v_mfma_f32_16x16x32_bf16 v[144:147], a[4:7], v[0:3], v[144:147]
    buffer_load_dwordx4 v223, s[56:59], s82 offen offset:3072 lds
    v_mfma_f32_16x16x32_bf16 v[148:151], a[4:7], v[4:7], v[148:151]
    s_add_u32 m0, s81, 49152
    ds_read_b64_tr_b16 a[18:19], v233 offset:63488
    v_mfma_f32_16x16x32_bf16 v[152:155], a[4:7], v[8:11], v[152:155]
    buffer_store_dwordx4 v[164:167], v211, s[64:67], s83 offen offset:1024 sc1
    v_mfma_f32_16x16x32_bf16 v[156:159], a[4:7], v[12:15], v[156:159]
    s_waitcnt lgkmcnt(4)
    s_mov_b32 s82, 230144
    v_mfma_f32_16x16x32_bf16 v[144:147], a[8:11], v[16:19], v[144:147]
    buffer_load_dwordx4 v220, s[56:59], s82 offen offset:0 lds
    v_mfma_f32_16x16x32_bf16 v[148:151], a[8:11], v[20:23], v[148:151]
    ds_read_b64_tr_b16 a[20:21], v234 offset:0
    v_mfma_f32_16x16x32_bf16 v[152:155], a[8:11], v[24:27], v[152:155]
    ds_read_b64_tr_b16 a[22:23], v234 offset:2048
    v_mfma_f32_16x16x32_bf16 v[156:159], a[8:11], v[28:31], v[156:159]
    s_waitcnt lgkmcnt(4)
    buffer_load_dwordx4 v221, s[56:59], s82 offen offset:1024 lds
    v_mfma_f32_16x16x32_bf16 v[144:147], a[12:15], v[32:35], v[144:147]
    ds_read_b64_tr_b16 a[24:25], v234 offset:4096
    v_mfma_f32_16x16x32_bf16 v[148:151], a[12:15], v[36:39], v[148:151]
    buffer_load_dwordx4 v222, s[56:59], s82 offen offset:2048 lds
    v_mfma_f32_16x16x32_bf16 v[152:155], a[12:15], v[40:43], v[152:155]
    ds_read_b64_tr_b16 a[26:27], v234 offset:6144
    v_mfma_f32_16x16x32_bf16 v[156:159], a[12:15], v[44:47], v[156:159]
    s_waitcnt lgkmcnt(4)
    ds_read_b64_tr_b16 a[28:29], v234 offset:8192
    v_mfma_f32_16x16x32_bf16 v[144:147], a[16:19], v[48:51], v[144:147]
    ds_read_b64_tr_b16 a[30:31], v234 offset:10240
    v_mfma_f32_16x16x32_bf16 v[148:151], a[16:19], v[52:55], v[148:151]
    buffer_load_dwordx4 v223, s[56:59], s82 offen offset:3072 lds
    v_mfma_f32_16x16x32_bf16 v[152:155], a[16:19], v[56:59], v[152:155]
    s_add_u32 m0, s81, 98304
    s_mov_b32 s82, 344832
    v_mfma_f32_16x16x32_bf16 v[156:159], a[16:19], v[60:63], v[156:159]
    s_waitcnt lgkmcnt(4)
    ds_read_b64_tr_b16 a[0:1], v234 offset:12288
    v_mfma_f32_16x16x32_bf16 v[144:147], a[20:23], v[64:67], v[144:147]
    ds_read_b64_tr_b16 a[2:3], v234 offset:14336
    v_mfma_f32_16x16x32_bf16 v[148:151], a[20:23], v[68:71], v[148:151]
    v_mfma_f32_16x16x32_bf16 v[152:155], a[20:23], v[72:75], v[152:155]
    s_waitcnt vmcnt(22)
    s_barrier
    v_mfma_f32_16x16x32_bf16 v[156:159], a[20:23], v[76:79], v[156:159]
    s_waitcnt lgkmcnt(4)
    buffer_load_dwordx4 v220, s[56:59], s82 offen offset:0 lds
    v_mfma_f32_16x16x32_bf16 v[144:147], a[24:27], v[80:83], v[144:147]
    ds_read_b64_tr_b16 a[4:5], v234 offset:16384
    v_mfma_f32_16x16x32_bf16 v[148:151], a[24:27], v[84:87], v[148:151]
    buffer_load_dwordx4 v221, s[56:59], s82 offen offset:1024 lds
    v_mfma_f32_16x16x32_bf16 v[152:155], a[24:27], v[88:91], v[152:155]
    ds_read_b64_tr_b16 a[6:7], v234 offset:18432
    v_mfma_f32_16x16x32_bf16 v[156:159], a[24:27], v[92:95], v[156:159]
    s_waitcnt lgkmcnt(4)
    ds_read_b64_tr_b16 a[8:9], v234 offset:20480
    v_mfma_f32_16x16x32_bf16 v[144:147], a[28:31], v[96:99], v[144:147]
    buffer_load_dwordx4 v222, s[56:59], s82 offen offset:2048 lds
    v_mfma_f32_16x16x32_bf16 v[148:151], a[28:31], v[100:103], v[148:151]
    ds_read_b64_tr_b16 a[10:11], v234 offset:22528
    v_mfma_f32_16x16x32_bf16 v[152:155], a[28:31], v[104:107], v[152:155]
    ds_read_b64_tr_b16 a[12:13], v234 offset:24576
    v_mfma_f32_16x16x32_bf16 v[156:159], a[28:31], v[108:111], v[156:159]
    s_waitcnt lgkmcnt(5)
    ds_read_b64_tr_b16 a[14:15], v234 offset:26624
    v_mfma_f32_16x16x32_bf16 v[144:147], a[0:3], v[112:115], v[144:147]
    buffer_load_dwordx4 v223, s[56:59], s82 offen offset:3072 lds
    v_mfma_f32_16x16x32_bf16 v[148:151], a[0:3], v[116:119], v[148:151]
    v_mfma_f32_16x16x32_bf16 v[152:155], a[0:3], v[120:123], v[152:155]
    ds_read_b64_tr_b16 a[16:17], v234 offset:28672
    v_mfma_f32_16x16x32_bf16 v[156:159], a[0:3], v[124:127], v[156:159]
    s_waitcnt lgkmcnt(5)
    ds_read_b64_tr_b16 a[18:19], v234 offset:30720
    v_mfma_f32_16x16x32_bf16 v[128:131], a[4:7], a[32:35], 0
    v_mfma_f32_16x16x32_bf16 v[132:135], a[4:7], a[36:39], 0
    v_mfma_f32_16x16x32_bf16 v[136:139], a[4:7], a[40:43], 0
    ds_read_b64_tr_b16 a[20:21], v233 offset:0
    v_cvt_pk_bf16_f32 v160, v144, v145
    v_mfma_f32_16x16x32_bf16 v[140:143], a[4:7], a[44:47], 0
    s_waitcnt lgkmcnt(5)
    ds_read_b64_tr_b16 a[22:23], v233 offset:2048
    v_cvt_pk_bf16_f32 v161, v146, v147
    v_mfma_f32_16x16x32_bf16 v[128:131], a[8:11], a[48:51], v[128:131]
    v_cvt_pk_bf16_f32 v162, v148, v149
    v_cvt_pk_bf16_f32 v163, v150, v151
    v_mfma_f32_16x16x32_bf16 v[132:135], a[8:11], a[52:55], v[132:135]
    v_cvt_pk_bf16_f32 v164, v152, v153
    v_cvt_pk_bf16_f32 v165, v154, v155
    v_mfma_f32_16x16x32_bf16 v[136:139], a[8:11], a[56:59], v[136:139]
    ds_read_b64_tr_b16 a[24:25], v233 offset:4096
    v_cvt_pk_bf16_f32 v166, v156, v157
    v_mfma_f32_16x16x32_bf16 v[140:143], a[8:11], a[60:63], v[140:143]
    s_waitcnt lgkmcnt(5)
    ds_read_b64_tr_b16 a[26:27], v233 offset:6144
    v_cvt_pk_bf16_f32 v167, v158, v159
    v_mfma_f32_16x16x32_bf16 v[128:131], a[12:15], a[64:67], v[128:131]
    s_mov_b32 s83, 8192
    v_mfma_f32_16x16x32_bf16 v[132:135], a[12:15], a[68:71], v[132:135]
    buffer_store_dwordx4 v[160:163], v211, s[64:67], s83 offen offset:0 sc1
    v_mfma_f32_16x16x32_bf16 v[136:139], a[12:15], a[72:75], v[136:139]
    ds_read_b64_tr_b16 a[28:29], v233 offset:8192
    v_mfma_f32_16x16x32_bf16 v[140:143], a[12:15], a[76:79], v[140:143]
    s_waitcnt lgkmcnt(5)
    ds_read_b64_tr_b16 a[30:31], v233 offset:10240
    v_mfma_f32_16x16x32_bf16 v[128:131], a[16:19], a[80:83], v[128:131]
    buffer_store_dwordx4 v[164:167], v211, s[64:67], s83 offen offset:1024 sc1
    v_mfma_f32_16x16x32_bf16 v[132:135], a[16:19], a[84:87], v[132:135]
    v_mfma_f32_16x16x32_bf16 v[136:139], a[16:19], a[88:91], v[136:139]
    ds_read_b64_tr_b16 a[0:1], v233 offset:12288
    v_mfma_f32_16x16x32_bf16 v[140:143], a[16:19], a[92:95], v[140:143]
    s_waitcnt lgkmcnt(5)
    ds_read_b64_tr_b16 a[2:3], v233 offset:14336
    v_mfma_f32_16x16x32_bf16 v[128:131], a[20:23], a[96:99], v[128:131]
    v_mfma_f32_16x16x32_bf16 v[132:135], a[20:23], a[100:103], v[132:135]
    v_mfma_f32_16x16x32_bf16 v[136:139], a[20:23], a[104:107], v[136:139]
    s_waitcnt vmcnt(20)
    s_barrier
    v_mfma_f32_16x16x32_bf16 v[140:143], a[20:23], a[108:111], v[140:143]
    s_waitcnt lgkmcnt(4)
    ds_read_b64_tr_b16 a[4:5], v233 offset:16384
    v_mfma_f32_16x16x32_bf16 v[128:131], a[24:27], a[112:115], v[128:131]
    ds_read_b64_tr_b16 a[6:7], v233 offset:18432
    v_mfma_f32_16x16x32_bf16 v[132:135], a[24:27], a[116:119], v[132:135]
    v_mfma_f32_16x16x32_bf16 v[136:139], a[24:27], a[248:251], v[136:139]
    ds_read_b64_tr_b16 a[8:9], v233 offset:20480
    v_mfma_f32_16x16x32_bf16 v[140:143], a[24:27], v[168:171], v[140:143]
    s_waitcnt lgkmcnt(5)
    ds_read_b64_tr_b16 a[10:11], v233 offset:22528
    v_mfma_f32_16x16x32_bf16 v[128:131], a[28:31], v[172:175], v[128:131]
    v_mfma_f32_16x16x32_bf16 v[132:135], a[28:31], v[176:179], v[132:135]
    v_mfma_f32_16x16x32_bf16 v[136:139], a[28:31], v[180:183], v[136:139]
    ds_read_b64_tr_b16 a[12:13], v233 offset:24576
    v_mfma_f32_16x16x32_bf16 v[140:143], a[28:31], v[184:187], v[140:143]
    s_waitcnt lgkmcnt(5)
    ds_read_b64_tr_b16 a[14:15], v233 offset:26624
    v_mfma_f32_16x16x32_bf16 v[128:131], a[0:3], v[188:191], v[128:131]
    v_mfma_f32_16x16x32_bf16 v[132:135], a[0:3], v[192:195], v[132:135]
    v_mfma_f32_16x16x32_bf16 v[136:139], a[0:3], v[196:199], v[136:139]
    ds_read_b64_tr_b16 a[16:17], v233 offset:28672
    v_mfma_f32_16x16x32_bf16 v[140:143], a[0:3], v[200:203], v[140:143]
    s_waitcnt lgkmcnt(5)
    ds_read_b64_tr_b16 a[18:19], v233 offset:30720
    v_mfma_f32_16x16x32_bf16 v[128:131], a[4:7], v[0:3], v[128:131]
    v_mfma_f32_16x16x32_bf16 v[132:135], a[4:7], v[4:7], v[132:135]
    v_mfma_f32_16x16x32_bf16 v[136:139], a[4:7], v[8:11], v[136:139]
    ds_read_b64_tr_b16 a[20:21], v232 offset:16384
    v_mfma_f32_16x16x32_bf16 v[140:143], a[4:7], v[12:15], v[140:143]
    s_waitcnt lgkmcnt(5)
    ds_read_b64_tr_b16 a[22:23], v232 offset:18432
    v_mfma_f32_16x16x32_bf16 v[128:131], a[8:11], v[16:19], v[128:131]
    v_mfma_f32_16x16x32_bf16 v[132:135], a[8:11], v[20:23], v[132:135]
    v_mfma_f32_16x16x32_bf16 v[136:139], a[8:11], v[24:27], v[136:139]
    ds_read_b64_tr_b16 a[24:25], v232 offset:20480
    v_mfma_f32_16x16x32_bf16 v[140:143], a[8:11], v[28:31], v[140:143]
    s_waitcnt lgkmcnt(5)
    ds_read_b64_tr_b16 a[26:27], v232 offset:22528
    v_mfma_f32_16x16x32_bf16 v[128:131], a[12:15], v[32:35], v[128:131]
    v_mfma_f32_16x16x32_bf16 v[132:135], a[12:15], v[36:39], v[132:135]
    v_mfma_f32_16x16x32_bf16 v[136:139], a[12:15], v[40:43], v[136:139]
    ds_read_b64_tr_b16 a[28:29], v232 offset:24576
    v_mfma_f32_16x16x32_bf16 v[140:143], a[12:15], v[44:47], v[140:143]
    s_waitcnt lgkmcnt(5)
    ds_read_b64_tr_b16 a[30:31], v232 offset:26624
    v_mfma_f32_16x16x32_bf16 v[128:131], a[16:19], v[48:51], v[128:131]
    v_mfma_f32_16x16x32_bf16 v[132:135], a[16:19], v[52:55], v[132:135]
    v_mfma_f32_16x16x32_bf16 v[136:139], a[16:19], v[56:59], v[136:139]
    ds_read_b64_tr_b16 a[0:1], v232 offset:28672
    v_mfma_f32_16x16x32_bf16 v[140:143], a[16:19], v[60:63], v[140:143]
    s_waitcnt lgkmcnt(5)
    ds_read_b64_tr_b16 a[2:3], v232 offset:30720
    v_mfma_f32_16x16x32_bf16 v[128:131], a[20:23], v[64:67], v[128:131]
    v_add_u32 v240, 0xfffff000, v242
    v_cmp_gt_u32 vcc, 8, v251
    v_mfma_f32_16x16x32_bf16 v[132:135], a[20:23], v[68:71], v[132:135]
    s_nop 0
    v_cndmask_b32 v240, v240, v242, vcc
    v_mfma_f32_16x16x32_bf16 v[136:139], a[20:23], v[72:75], v[136:139]
    s_waitcnt vmcnt(11)
    s_barrier
    v_mfma_f32_16x16x32_bf16 v[140:143], a[20:23], v[76:79], v[140:143]
    s_waitcnt lgkmcnt(4)
    ds_read_b64_tr_b16 a[4:5], v232 offset:32768
    v_mfma_f32_16x16x32_bf16 v[128:131], a[24:27], v[80:83], v[128:131]
    ds_read_b64_tr_b16 a[6:7], v232 offset:34816
    v_mfma_f32_16x16x32_bf16 v[132:135], a[24:27], v[84:87], v[132:135]
    v_mfma_f32_16x16x32_bf16 v[136:139], a[24:27], v[88:91], v[136:139]
    ds_read_b64_tr_b16 a[8:9], v232 offset:36864
    v_mfma_f32_16x16x32_bf16 v[140:143], a[24:27], v[92:95], v[140:143]
    s_waitcnt lgkmcnt(5)
    ds_read_b64_tr_b16 a[10:11], v232 offset:38912
    v_mfma_f32_16x16x32_bf16 v[128:131], a[28:31], v[96:99], v[128:131]
    v_mfma_f32_16x16x32_bf16 v[132:135], a[28:31], v[100:103], v[132:135]
    v_mfma_f32_16x16x32_bf16 v[136:139], a[28:31], v[104:107], v[136:139]
    ds_read_b64_tr_b16 a[12:13], v232 offset:40960
    v_mfma_f32_16x16x32_bf16 v[140:143], a[28:31], v[108:111], v[140:143]
    s_waitcnt lgkmcnt(5)
    ds_read_b64_tr_b16 a[14:15], v232 offset:43008
    v_mfma_f32_16x16x32_bf16 v[128:131], a[0:3], v[112:115], v[128:131]
    v_mfma_f32_16x16x32_bf16 v[132:135], a[0:3], v[116:119], v[132:135]
    v_mfma_f32_16x16x32_bf16 v[136:139], a[0:3], v[120:123], v[136:139]
    ds_read_b64_tr_b16 a[16:17], v232 offset:45056
    v_mfma_f32_16x16x32_bf16 v[140:143], a[0:3], v[124:127], v[140:143]
    s_waitcnt lgkmcnt(5)
    ds_read_b64_tr_b16 a[18:19], v232 offset:47104
    v_mfma_f32_16x16x32_bf16 v[144:147], a[4:7], a[32:35], 0
    v_mfma_f32_16x16x32_bf16 v[148:151], a[4:7], a[36:39], 0
    v_mfma_f32_16x16x32_bf16 v[152:155], a[4:7], a[40:43], 0
    ds_read_b64_tr_b16 a[20:21], v232 offset:0
    v_cvt_pk_bf16_f32 v160, v128, v129
    v_mfma_f32_16x16x32_bf16 v[156:159], a[4:7], a[44:47], 0
    s_waitcnt lgkmcnt(5)
    ds_read_b64_tr_b16 a[22:23], v232 offset:2048
    v_cvt_pk_bf16_f32 v161, v130, v131
    v_mfma_f32_16x16x32_bf16 v[144:147], a[8:11], a[48:51], v[144:147]
    v_cvt_pk_bf16_f32 v162, v132, v133
    v_cvt_pk_bf16_f32 v163, v134, v135
    v_mfma_f32_16x16x32_bf16 v[148:151], a[8:11], a[52:55], v[148:151]
    v_cvt_pk_bf16_f32 v164, v136, v137
    v_cvt_pk_bf16_f32 v165, v138, v139
    v_mfma_f32_16x16x32_bf16 v[152:155], a[8:11], a[56:59], v[152:155]
    ds_read_b64_tr_b16 a[24:25], v232 offset:4096
    v_cvt_pk_bf16_f32 v166, v140, v141
    v_mfma_f32_16x16x32_bf16 v[156:159], a[8:11], a[60:63], v[156:159]
    s_waitcnt lgkmcnt(5)
    ds_read_b64_tr_b16 a[26:27], v232 offset:6144
    v_cvt_pk_bf16_f32 v167, v142, v143
    v_mfma_f32_16x16x32_bf16 v[144:147], a[12:15], a[64:67], v[144:147]
    s_mov_b32 s83, 10240
    v_mfma_f32_16x16x32_bf16 v[148:151], a[12:15], a[68:71], v[148:151]
    buffer_store_dwordx4 v[160:163], v211, s[64:67], s83 offen offset:0 sc1
    v_mfma_f32_16x16x32_bf16 v[152:155], a[12:15], a[72:75], v[152:155]
    ds_read_b64_tr_b16 a[28:29], v232 offset:8192
    v_mfma_f32_16x16x32_bf16 v[156:159], a[12:15], a[76:79], v[156:159]
    s_waitcnt lgkmcnt(5)
    ds_read_b64_tr_b16 a[30:31], v232 offset:10240
    v_mfma_f32_16x16x32_bf16 v[144:147], a[16:19], a[80:83], v[144:147]
    buffer_store_dwordx4 v[164:167], v211, s[64:67], s83 offen offset:1024 sc1
    v_mfma_f32_16x16x32_bf16 v[148:151], a[16:19], a[84:87], v[148:151]
    v_mfma_f32_16x16x32_bf16 v[152:155], a[16:19], a[88:91], v[152:155]
    ds_read_b64_tr_b16 a[0:1], v232 offset:12288
    v_mfma_f32_16x16x32_bf16 v[156:159], a[16:19], a[92:95], v[156:159]
    s_waitcnt lgkmcnt(5)
    ds_read_b64_tr_b16 a[2:3], v232 offset:14336
    v_mfma_f32_16x16x32_bf16 v[144:147], a[20:23], a[96:99], v[144:147]
    v_mfma_f32_16x16x32_bf16 v[148:151], a[20:23], a[100:103], v[148:151]
    v_mfma_f32_16x16x32_bf16 v[152:155], a[20:23], a[104:107], v[152:155]
    s_waitcnt vmcnt(4)
    s_barrier
    v_mfma_f32_16x16x32_bf16 v[156:159], a[20:23], a[108:111], v[156:159]
    s_waitcnt lgkmcnt(4)
    ds_read_b64_tr_b16 a[4:5], v232 offset:49152
    v_mfma_f32_16x16x32_bf16 v[144:147], a[24:27], a[112:115], v[144:147]
    ds_read_b64_tr_b16 a[6:7], v232 offset:51200
    v_mfma_f32_16x16x32_bf16 v[148:151], a[24:27], a[116:119], v[148:151]
    v_mfma_f32_16x16x32_bf16 v[152:155], a[24:27], a[248:251], v[152:155]
    ds_read_b64_tr_b16 a[8:9], v232 offset:53248
    v_mfma_f32_16x16x32_bf16 v[156:159], a[24:27], v[168:171], v[156:159]
    s_waitcnt lgkmcnt(5)
    ds_read_b64_tr_b16 a[10:11], v232 offset:55296
    v_mfma_f32_16x16x32_bf16 v[144:147], a[28:31], v[172:175], v[144:147]
    v_mfma_f32_16x16x32_bf16 v[148:151], a[28:31], v[176:179], v[148:151]
    v_mfma_f32_16x16x32_bf16 v[152:155], a[28:31], v[180:183], v[152:155]
    ds_read_b64_tr_b16 a[12:13], v232 offset:57344
    v_mfma_f32_16x16x32_bf16 v[156:159], a[28:31], v[184:187], v[156:159]
    s_waitcnt lgkmcnt(5)
    ds_read_b64_tr_b16 a[14:15], v232 offset:59392
    v_mfma_f32_16x16x32_bf16 v[144:147], a[0:3], v[188:191], v[144:147]
    v_mfma_f32_16x16x32_bf16 v[148:151], a[0:3], v[192:195], v[148:151]
    v_mfma_f32_16x16x32_bf16 v[152:155], a[0:3], v[196:199], v[152:155]
    ds_read_b64_tr_b16 a[16:17], v232 offset:61440
    v_mfma_f32_16x16x32_bf16 v[156:159], a[0:3], v[200:203], v[156:159]
    s_waitcnt lgkmcnt(5)
    ds_read_b64_tr_b16 a[18:19], v232 offset:63488
    v_mfma_f32_16x16x32_bf16 v[144:147], a[4:7], v[0:3], v[144:147]
    v_mfma_f32_16x16x32_bf16 v[148:151], a[4:7], v[4:7], v[148:151]
    v_mfma_f32_16x16x32_bf16 v[152:155], a[4:7], v[8:11], v[152:155]
    buffer_load_dwordx2 v[238:239], v240, s[68:71], 0 offen sc1
    v_mfma_f32_16x16x32_bf16 v[156:159], a[4:7], v[12:15], v[156:159]
    s_waitcnt lgkmcnt(4)
    ds_read_b64_tr_b16 a[20:21], v233 offset:32768
    v_mfma_f32_16x16x32_bf16 v[144:147], a[8:11], v[16:19], v[144:147]
    ds_read_b64_tr_b16 a[22:23], v233 offset:34816
    v_mfma_f32_16x16x32_bf16 v[148:151], a[8:11], v[20:23], v[148:151]
    v_mfma_f32_16x16x32_bf16 v[152:155], a[8:11], v[24:27], v[152:155]
    ds_read_b64_tr_b16 a[24:25], v233 offset:36864
    v_mfma_f32_16x16x32_bf16 v[156:159], a[8:11], v[28:31], v[156:159]
    s_waitcnt lgkmcnt(5)
    ds_read_b64_tr_b16 a[26:27], v233 offset:38912
    v_mfma_f32_16x16x32_bf16 v[144:147], a[12:15], v[32:35], v[144:147]
    v_mfma_f32_16x16x32_bf16 v[148:151], a[12:15], v[36:39], v[148:151]
    v_mfma_f32_16x16x32_bf16 v[152:155], a[12:15], v[40:43], v[152:155]
    ds_read_b64_tr_b16 a[28:29], v233 offset:40960
    v_mfma_f32_16x16x32_bf16 v[156:159], a[12:15], v[44:47], v[156:159]
    s_waitcnt lgkmcnt(5)
    ds_read_b64_tr_b16 a[30:31], v233 offset:43008
    v_mfma_f32_16x16x32_bf16 v[144:147], a[16:19], v[48:51], v[144:147]
    v_mfma_f32_16x16x32_bf16 v[148:151], a[16:19], v[52:55], v[148:151]
    v_mfma_f32_16x16x32_bf16 v[152:155], a[16:19], v[56:59], v[152:155]
    ds_read_b64_tr_b16 a[0:1], v233 offset:45056
    v_mfma_f32_16x16x32_bf16 v[156:159], a[16:19], v[60:63], v[156:159]
    s_waitcnt lgkmcnt(5)
    ds_read_b64_tr_b16 a[2:3], v233 offset:47104
    v_mfma_f32_16x16x32_bf16 v[144:147], a[20:23], v[64:67], v[144:147]
    v_mfma_f32_16x16x32_bf16 v[148:151], a[20:23], v[68:71], v[148:151]
    v_mfma_f32_16x16x32_bf16 v[152:155], a[20:23], v[72:75], v[152:155]
    v_mfma_f32_16x16x32_bf16 v[156:159], a[20:23], v[76:79], v[156:159]
    s_waitcnt lgkmcnt(4)
    v_mfma_f32_16x16x32_bf16 v[144:147], a[24:27], v[80:83], v[144:147]
    v_mfma_f32_16x16x32_bf16 v[148:151], a[24:27], v[84:87], v[148:151]
    v_mfma_f32_16x16x32_bf16 v[152:155], a[24:27], v[88:91], v[152:155]
    v_mfma_f32_16x16x32_bf16 v[156:159], a[24:27], v[92:95], v[156:159]
    s_waitcnt lgkmcnt(2)
    v_mfma_f32_16x16x32_bf16 v[144:147], a[28:31], v[96:99], v[144:147]
    v_mfma_f32_16x16x32_bf16 v[148:151], a[28:31], v[100:103], v[148:151]
    v_mfma_f32_16x16x32_bf16 v[152:155], a[28:31], v[104:107], v[152:155]
    v_mfma_f32_16x16x32_bf16 v[156:159], a[28:31], v[108:111], v[156:159]
    s_waitcnt lgkmcnt(0)
    v_mfma_f32_16x16x32_bf16 v[144:147], a[0:3], v[112:115], v[144:147]
    v_mfma_f32_16x16x32_bf16 v[148:151], a[0:3], v[116:119], v[148:151]
    v_mfma_f32_16x16x32_bf16 v[152:155], a[0:3], v[120:123], v[152:155]
    v_mfma_f32_16x16x32_bf16 v[156:159], a[0:3], v[124:127], v[156:159]
    s_nop 4
    v_cvt_pk_bf16_f32 v160, v144, v145
    v_cvt_pk_bf16_f32 v161, v146, v147
    v_cvt_pk_bf16_f32 v162, v148, v149
    v_cvt_pk_bf16_f32 v163, v150, v151
    v_cvt_pk_bf16_f32 v164, v152, v153
    v_cvt_pk_bf16_f32 v165, v154, v155
    v_cvt_pk_bf16_f32 v166, v156, v157
    v_cvt_pk_bf16_f32 v167, v158, v159
    s_mov_b32 s83, 12288
    buffer_store_dwordx4 v[160:163], v211, s[64:67], s83 offen offset:0 sc1
    buffer_store_dwordx4 v[164:167], v211, s[64:67], s83 offen offset:1024 sc1
    v_mov_b32 v184, 0x41317218
    v_mov_b32 v185, 0x41317218
    v_mov_b32 v116, 1
    v_mov_b32 v115, 0
    s_waitcnt vmcnt(2)
    v_cmp_eq_u64 vcc, v[238:239], v[246:247]
    s_cmp_eq_u32 s34, 0
    s_nop 0
    s_cselect_b32 s82, 0, vcc_lo
    s_bitset1_b32 s82, s79
    s_and_b32 s86, s82, 0xff
    v_mov_b32 v115, s86
    ds_write_b32 v253, v115
    s_mov_b32 s88, 1
    s_mov_b32 s83, 0
    s_mov_b32 s89, 0
    s_waitcnt vmcnt(0) lgkmcnt(0)
    s_barrier
    buffer_store_dwordx2 v[246:247], v244, s[68:71], 0 offen sc1
    s_bfe_u32 s78, s82, 0x80008
    s_mov_b32 s82, 0
    s_mov_b32 s87, 14336
    buffer_load_dwordx2 v[224:225], v212, s[44:47], 0 offen
    buffer_load_dwordx2 v[226:227], v212, s[44:47], s87 offen
    buffer_load_dwordx2 v[228:229], v213, s[44:47], 0 offen
    buffer_load_dwordx2 v[230:231], v213, s[44:47], s87 offen
    s_cmp_eq_u32 s77, 8
    s_cbranch_scc1 L_bok
    s_cmp_eq_u32 s78, 0xff
    s_cbranch_scc0 L_bok
    s_mov_b32 s86, 14680064
    buffer_load_dwordx4 a[184:187], v207, s[40:43], s86 offen sc1
    buffer_load_dwordx4 a[216:219], v208, s[40:43], s86 offen sc1
    s_mov_b32 s86, 16515072
    buffer_load_dwordx4 a[188:191], v207, s[40:43], s86 offen sc1
    buffer_load_dwordx4 a[220:223], v208, s[40:43], s86 offen sc1
    s_mov_b32 s86, 18350080
    buffer_load_dwordx4 a[192:195], v207, s[40:43], s86 offen sc1
    buffer_load_dwordx4 a[224:227], v208, s[40:43], s86 offen sc1
    s_mov_b32 s86, 20185088
    buffer_load_dwordx4 a[196:199], v207, s[40:43], s86 offen sc1
    buffer_load_dwordx4 a[228:231], v208, s[40:43], s86 offen sc1
    s_mov_b32 s86, 22020096
    buffer_load_dwordx4 a[200:203], v207, s[40:43], s86 offen sc1
    buffer_load_dwordx4 a[232:235], v208, s[40:43], s86 offen sc1
    s_mov_b32 s86, 23855104
    buffer_load_dwordx4 a[204:207], v207, s[40:43], s86 offen sc1
    buffer_load_dwordx4 a[236:239], v208, s[40:43], s86 offen sc1
    s_mov_b32 s86, 25690112
    buffer_load_dwordx4 a[208:211], v207, s[40:43], s86 offen sc1
    buffer_load_dwordx4 a[240:243], v208, s[40:43], s86 offen sc1
    s_mov_b32 s86, 27525120
    buffer_load_dwordx4 a[212:215], v207, s[40:43], s86 offen sc1
    buffer_load_dwordx4 a[244:247], v208, s[40:43], s86 offen sc1
    s_mov_b32 s77, 8
    s_waitcnt vmcnt(0)
L_bok:
    s_cmp_eq_u32 s76, 3
    s_cbranch_scc0 L_w012
    s_cmp_eq_u32 s77, 8
    s_cbranch_scc0 L_poll
    buffer_load_dwordx2 v[118:119], v242, s[68:71], 0 offen sc1
    s_branch L_bcomp
L_w012:
    buffer_atomic_add v116, v243, s[72:75], 0 offen sc0
L_mail:
    ds_read_b32 v115, v253
    s_waitcnt lgkmcnt(0)
    v_readfirstlane_b32 s78, v115
    s_nop 1
    s_bitcmp1_b32 s78, 8
    s_cbranch_scc1 L_k1_done
    s_cmp_eq_u32 s77, 8
    s_cselect_b32 s87, 31, 0xff
    s_and_b32 s78, s78, s87
L_fetch:
    s_andn2_b32 s87, s78, s89
    s_or_b32 s89, s89, s78
    s_bitcmp1_b32 s87, 0
    s_cbranch_scc0 L_f0
    s_mov_b32 s86, 0
    buffer_load_dwordx4 v[0:3], v207, s[40:43], s86 offen sc1
    buffer_load_dwordx4 v[32:35], v208, s[40:43], s86 offen sc1
L_f0:
    s_bitcmp1_b32 s87, 1
    s_cbranch_scc0 L_f1
    s_mov_b32 s86, 1835008
    buffer_load_dwordx4 v[4:7], v207, s[40:43], s86 offen sc1
    buffer_load_dwordx4 v[36:39], v208, s[40:43], s86 offen sc1
L_f1:
    s_bitcmp1_b32 s87, 2
    s_cbranch_scc0 L_f2
    s_mov_b32 s86, 3670016
    buffer_load_dwordx4 v[8:11], v207, s[40:43], s86 offen sc1
    buffer_load_dwordx4 v[40:43], v208, s[40:43], s86 offen sc1
L_f2:
    s_bitcmp1_b32 s87, 3
    s_cbranch_scc0 L_f3
    s_mov_b32 s86, 5505024
    buffer_load_dwordx4 v[12:15], v207, s[40:43], s86 offen sc1
    buffer_load_dwordx4 v[44:47], v208, s[40:43], s86 offen sc1
L_f3:
    s_bitcmp1_b32 s87, 4
    s_cbranch_scc0 L_f4
    s_mov_b32 s86, 7340032
    buffer_load_dwordx4 v[16:19], v207, s[40:43], s86 offen sc1
    buffer_load_dwordx4 v[48:51], v208, s[40:43], s86 offen sc1
L_f4:
    s_bitcmp1_b32 s87, 5
    s_cbranch_scc0 L_f5
    s_mov_b32 s86, 9175040
    buffer_load_dwordx4 v[20:23], v207, s[40:43], s86 offen sc1
    buffer_load_dwordx4 v[52:55], v208, s[40:43], s86 offen sc1
L_f5:
    s_bitcmp1_b32 s87, 6
    s_cbranch_scc0 L_f6
    s_mov_b32 s86, 11010048
    buffer_load_dwordx4 v[24:27], v207, s[40:43], s86 offen sc1
    buffer_load_dwordx4 v[56:59], v208, s[40:43], s86 offen sc1
L_f6:
    s_bitcmp1_b32 s87, 7
    s_cbranch_scc0 L_f7
    s_mov_b32 s86, 12845056
    buffer_load_dwordx4 v[28:31], v207, s[40:43], s86 offen sc1
    buffer_load_dwordx4 v[60:63], v208, s[40:43], s86 offen sc1
L_f7:
    s_cmp_eq_u32 s77, 8
    s_cbranch_scc1 L_bcomp
    s_cmp_eq_u32 s89, 0xff
    s_cbranch_scc1 L_all
    s_sleep 1
    s_branch L_mail
L_poll:
    buffer_load_dwordx2 v[118:119], v242, s[68:71], 0 offen sc1
L_check:
    s_waitcnt vmcnt(0)
    v_cmp_eq_u64 vcc, v[118:119], v[246:247]
    s_nop 1
    s_and_b32 s78, vcc_lo, 0xff
    s_cmp_eq_u32 s34, 0
    s_cselect_b32 s78, 0, s78
    s_bitset1_b32 s78, s79
L_post:
    v_mov_b32 v115, s78
    ds_write_b32 v253, v115
    s_bitcmp1_b32 s78, 8
    s_cbranch_scc1 L_k1_done
    s_cmp_eq_u32 s78, 0xff
    s_cbranch_scc1 L_fetch
    s_sleep 1
    s_add_u32 s82, s82, 1
    s_and_b32 s78, s82, 31
    s_cmp_lg_u32 s78, 0
    s_cbranch_scc1 L_poll
    s_add_u32 s78, s79, 8
    s_lshl_b32 s86, 1, s78
    s_cmp_lt_u32 s82, 256
    s_cselect_b32 s86, 0, s86
    v_mov_b32 v117, s86
    v_lshl_add_u32 v114, v251, 8, v255
    buffer_atomic_or v117, v114, s[72:75], 0 offen sc0
    s_waitcnt vmcnt(0)
    v_readfirstlane_b32 s86, v117
    s_nop 1
    s_and_b32 s86, s86, 15
    s_mov_b32 s78, 0xff
    s_cmp_eq_u32 s86, 8
    s_cbranch_scc1 L_post
    s_mov_b32 s78, 0x100
    s_cmp_lt_u32 s82, 256
    s_cbranch_scc0 L_post
    s_branch L_poll
L_item:
    v_lshrrev_b32 v217, 4, v251
    v_lshlrev_b32 v217, 3, v217
    v_and_b32 v216, 15, v251
    v_mul_u32_u24 v216, 896, v216
    s_mul_i32 s86, s84, 7
    s_add_u32 s86, s86, s85
    s_mul_i32 s87, s80, 56
    s_add_u32 s87, s87, s86
    s_lshl_b32 s87, s87, 10
    v_add_u32 v207, s87, v253
    s_mul_i32 s87, s86, 4682
    s_lshr_b32 s87, s87, 16
    s_mul_i32 s78, s87, 14
    s_sub_u32 s86, s86, s78
    s_lshl_b32 s87, s87, 5
    s_lshr_b32 s78, s86, 1
    s_lshl_b32 s78, s78, 7
    s_add_u32 s87, s87, s78
    v_add_u32 v214, s87, v217
    s_and_b32 s86, s86, 1
    s_lshl_b32 s86, s86, 5
    s_lshl_b32 s78, s80, 6
    s_add_u32 s86, s86, s78
    s_mul_i32 s86, s86, 896
    v_add3_u32 v212, v216, v214, s86
    s_mul_i32 s86, s84, 7
    s_add_u32 s86, s86, s85
    s_add_u32 s86, s86, 4
    s_mul_i32 s87, s80, 56
    s_add_u32 s87, s87, s86
    s_lshl_b32 s87, s87, 10
    s_lshl_b32 s35, s85, 29
    s_lshl_b32 s78, s85, 30
    s_and_b32 s35, s35, s78
    s_add_u32 s87, s87, s35
    v_add_u32 v208, s87, v253
    s_mul_i32 s87, s86, 4682
    s_lshr_b32 s87, s87, 16
    s_mul_i32 s78, s87, 14
    s_sub_u32 s86, s86, s78
    s_lshl_b32 s87, s87, 5
    s_lshr_b32 s78, s86, 1
    s_lshl_b32 s78, s78, 7
    s_add_u32 s87, s87, s78
    v_add_u32 v215, s87, v217
    s_and_b32 s86, s86, 1
    s_lshl_b32 s86, s86, 5
    s_lshl_b32 s78, s80, 6
    s_add_u32 s86, s86, s78
    s_mul_i32 s86, s86, 896
    s_add_u32 s86, s86, s35
    v_add3_u32 v213, v216, v215, s86
    buffer_load_dwordx2 a[252:253], v214, s[36:39], 0 offen
    buffer_load_dwordx2 a[254:255], v215, s[36:39], 0 offen
    s_mov_b32 s87, 14336
    buffer_load_dwordx2 v[224:225], v212, s[44:47], 0 offen
    buffer_load_dwordx2 v[226:227], v212, s[44:47], s87 offen
    buffer_load_dwordx2 v[228:229], v213, s[44:47], 0 offen
    buffer_load_dwordx2 v[230:231], v213, s[44:47], s87 offen
    s_mov_b32 s89, 0
    s_mov_b32 s77, 0
    s_mov_b32 s78, 0xff
    s_branch L_fetch
L_all:
    s_cmp_eq_u32 s77, 9
    s_cbranch_scc1 L_spart
    s_mov_b32 s86, 14680064
    buffer_load_dwordx4 a[184:187], v207, s[40:43], s86 offen sc1
    buffer_load_dwordx4 a[216:219], v208, s[40:43], s86 offen sc1
    s_mov_b32 s86, 16515072
    buffer_load_dwordx4 a[188:191], v207, s[40:43], s86 offen sc1
    buffer_load_dwordx4 a[220:223], v208, s[40:43], s86 offen sc1
    s_mov_b32 s86, 18350080
    buffer_load_dwordx4 a[192:195], v207, s[40:43], s86 offen sc1
    buffer_load_dwordx4 a[224:227], v208, s[40:43], s86 offen sc1
    s_mov_b32 s86, 20185088
    buffer_load_dwordx4 a[196:199], v207, s[40:43], s86 offen sc1
    buffer_load_dwordx4 a[228:231], v208, s[40:43], s86 offen sc1
    s_mov_b32 s86, 22020096
    buffer_load_dwordx4 a[200:203], v207, s[40:43], s86 offen sc1
    buffer_load_dwordx4 a[232:235], v208, s[40:43], s86 offen sc1
    s_mov_b32 s86, 23855104
    buffer_load_dwordx4 a[204:207], v207, s[40:43], s86 offen sc1
    buffer_load_dwordx4 a[236:239], v208, s[40:43], s86 offen sc1
    s_mov_b32 s86, 25690112
    buffer_load_dwordx4 a[208:211], v207, s[40:43], s86 offen sc1
    buffer_load_dwordx4 a[240:243], v208, s[40:43], s86 offen sc1
    s_mov_b32 s86, 27525120
    buffer_load_dwordx4 a[212:215], v207, s[40:43], s86 offen sc1
    buffer_load_dwordx4 a[244:247], v208, s[40:43], s86 offen sc1
    s_waitcnt vmcnt(0)
L_bcomp:
    s_mov_b32 s77, 9
    s_mov_b32 s86, 0x3f80
    s_mov_b32 s87, 0x3f800000
    v_accvgpr_read_b32 v128, a184
    v_accvgpr_read_b32 v129, a185
    v_accvgpr_read_b32 v130, a186
    v_accvgpr_read_b32 v131, a187
    v_accvgpr_read_b32 v132, a216
    v_accvgpr_read_b32 v133, a217
    v_accvgpr_read_b32 v134, a218
    v_accvgpr_read_b32 v135, a219
    v_accvgpr_read_b32 v136, a188
    v_accvgpr_read_b32 v137, a189
    v_accvgpr_read_b32 v138, a190
    v_accvgpr_read_b32 v139, a191
    v_accvgpr_read_b32 v140, a220
    v_accvgpr_read_b32 v141, a221
    v_accvgpr_read_b32 v142, a222
    v_accvgpr_read_b32 v143, a223
    v_dot2_f32_bf16 v80, v128, s86, 0
    v_dot2_f32_bf16 v81, v128, s87, 0
    v_dot2_f32_bf16 v82, v129, s86, 0
    v_dot2_f32_bf16 v83, v129, s87, 0
    v_dot2_f32_bf16 v84, v130, s86, 0
    v_dot2_f32_bf16 v85, v130, s87, 0
    v_dot2_f32_bf16 v86, v131, s86, 0
    v_dot2_f32_bf16 v87, v131, s87, 0
    v_dot2_f32_bf16 v88, v132, s86, 0
    v_dot2_f32_bf16 v89, v132, s87, 0
    v_dot2_f32_bf16 v90, v133, s86, 0
    v_dot2_f32_bf16 v91, v133, s87, 0
    v_dot2_f32_bf16 v92, v134, s86, 0
    v_dot2_f32_bf16 v93, v134, s87, 0
    v_dot2_f32_bf16 v94, v135, s86, 0
    v_dot2_f32_bf16 v95, v135, s87, 0
    v_accvgpr_read_b32 v128, a192
    v_accvgpr_read_b32 v129, a193
    v_accvgpr_read_b32 v130, a194
    v_accvgpr_read_b32 v131, a195
    v_accvgpr_read_b32 v132, a224
    v_accvgpr_read_b32 v133, a225
    v_accvgpr_read_b32 v134, a226
    v_accvgpr_read_b32 v135, a227
    v_dot2_f32_bf16 v80, v136, s86, v80
    v_dot2_f32_bf16 v81, v136, s87, v81
    v_dot2_f32_bf16 v82, v137, s86, v82
    v_dot2_f32_bf16 v83, v137, s87, v83
    v_dot2_f32_bf16 v84, v138, s86, v84
    v_dot2_f32_bf16 v85, v138, s87, v85
    v_dot2_f32_bf16 v86, v139, s86, v86
    v_dot2_f32_bf16 v87, v139, s87, v87
    v_dot2_f32_bf16 v88, v140, s86, v88
    v_dot2_f32_bf16 v89, v140, s87, v89
    v_dot2_f32_bf16 v90, v141, s86, v90
    v_dot2_f32_bf16 v91, v141, s87, v91
    v_dot2_f32_bf16 v92, v142, s86, v92
    v_dot2_f32_bf16 v93, v142, s87, v93
    v_dot2_f32_bf16 v94, v143, s86, v94
    v_dot2_f32_bf16 v95, v143, s87, v95
    v_accvgpr_read_b32 v136, a196
    v_accvgpr_read_b32 v137, a197
    v_accvgpr_read_b32 v138, a198
    v_accvgpr_read_b32 v139, a199
    v_accvgpr_read_b32 v140, a228
    v_accvgpr_read_b32 v141, a229
    v_accvgpr_read_b32 v142, a230
    v_accvgpr_read_b32 v143, a231
    v_dot2_f32_bf16 v80, v128, s86, v80
    v_dot2_f32_bf16 v81, v128, s87, v81
    v_dot2_f32_bf16 v82, v129, s86, v82
    v_dot2_f32_bf16 v83, v129, s87, v83
    v_dot2_f32_bf16 v84, v130, s86, v84
    v_dot2_f32_bf16 v85, v130, s87, v85
    v_dot2_f32_bf16 v86, v131, s86, v86
    v_dot2_f32_bf16 v87, v131, s87, v87
    v_dot2_f32_bf16 v88, v132, s86, v88
    v_dot2_f32_bf16 v89, v132, s87, v89
    v_dot2_f32_bf16 v90, v133, s86, v90
    v_dot2_f32_bf16 v91, v133, s87, v91
    v_dot2_f32_bf16 v92, v134, s86, v92
    v_dot2_f32_bf16 v93, v134, s87, v93
    v_dot2_f32_bf16 v94, v135, s86, v94
    v_dot2_f32_bf16 v95, v135, s87, v95
    v_accvgpr_read_b32 v128, a200
    v_accvgpr_read_b32 v129, a201
    v_accvgpr_read_b32 v130, a202
    v_accvgpr_read_b32 v131, a203
    v_accvgpr_read_b32 v132, a232
    v_accvgpr_read_b32 v133, a233
    v_accvgpr_read_b32 v134, a234
    v_accvgpr_read_b32 v135, a235
    v_dot2_f32_bf16 v80, v136, s86, v80
    v_dot2_f32_bf16 v81, v136, s87, v81
    v_dot2_f32_bf16 v82, v137, s86, v82
    v_dot2_f32_bf16 v83, v137, s87, v83
    v_dot2_f32_bf16 v84, v138, s86, v84
    v_dot2_f32_bf16 v85, v138, s87, v85
    v_dot2_f32_bf16 v86, v139, s86, v86
    v_dot2_f32_bf16 v87, v139, s87, v87
    v_dot2_f32_bf16 v88, v140, s86, v88
    v_dot2_f32_bf16 v89, v140, s87, v89
    v_dot2_f32_bf16 v90, v141, s86, v90
    v_dot2_f32_bf16 v91, v141, s87, v91
    v_dot2_f32_bf16 v92, v142, s86, v92
    v_dot2_f32_bf16 v93, v142, s87, v93
    v_dot2_f32_bf16 v94, v143, s86, v94
    v_dot2_f32_bf16 v95, v143, s87, v95
    v_accvgpr_read_b32 v136, a204
    v_accvgpr_read_b32 v137, a205
    v_accvgpr_read_b32 v138, a206
    v_accvgpr_read_b32 v139, a207
    v_accvgpr_read_b32 v140, a236
    v_accvgpr_read_b32 v141, a237
    v_accvgpr_read_b32 v142, a238
    v_accvgpr_read_b32 v143, a239
    v_dot2_f32_bf16 v80, v128, s86, v80
    v_dot2_f32_bf16 v81, v128, s87, v81
    v_dot2_f32_bf16 v82, v129, s86, v82
    v_dot2_f32_bf16 v83, v129, s87, v83
    v_dot2_f32_bf16 v84, v130, s86, v84
    v_dot2_f32_bf16 v85, v130, s87, v85
    v_dot2_f32_bf16 v86, v131, s86, v86
    v_dot2_f32_bf16 v87, v131, s87, v87
    v_dot2_f32_bf16 v88, v132, s86, v88
    v_dot2_f32_bf16 v89, v132, s87, v89
    v_dot2_f32_bf16 v90, v133, s86, v90
    v_dot2_f32_bf16 v91, v133, s87, v91
    v_dot2_f32_bf16 v92, v134, s86, v92
    v_dot2_f32_bf16 v93, v134, s87, v93
    v_dot2_f32_bf16 v94, v135, s86, v94
    v_dot2_f32_bf16 v95, v135, s87, v95
    v_accvgpr_read_b32 v128, a208
    v_accvgpr_read_b32 v129, a209
    v_accvgpr_read_b32 v130, a210
    v_accvgpr_read_b32 v131, a211
    v_accvgpr_read_b32 v132, a240
    v_accvgpr_read_b32 v133, a241
    v_accvgpr_read_b32 v134, a242
    v_accvgpr_read_b32 v135, a243
    v_dot2_f32_bf16 v80, v136, s86, v80
    v_dot2_f32_bf16 v81, v136, s87, v81
    v_dot2_f32_bf16 v82, v137, s86, v82
    v_dot2_f32_bf16 v83, v137, s87, v83
    v_dot2_f32_bf16 v84, v138, s86, v84
    v_dot2_f32_bf16 v85, v138, s87, v85
    v_dot2_f32_bf16 v86, v139, s86, v86
    v_dot2_f32_bf16 v87, v139, s87, v87
    v_dot2_f32_bf16 v88, v140, s86, v88
    v_dot2_f32_bf16 v89, v140, s87, v89
    v_dot2_f32_bf16 v90, v141, s86, v90
    v_dot2_f32_bf16 v91, v141, s87, v91
    v_dot2_f32_bf16 v92, v142, s86, v92
    v_dot2_f32_bf16 v93, v142, s87, v93
    v_dot2_f32_bf16 v94, v143, s86, v94
    v_dot2_f32_bf16 v95, v143, s87, v95
    v_accvgpr_read_b32 v136, a212
    v_accvgpr_read_b32 v137, a213
    v_accvgpr_read_b32 v138, a214
    v_accvgpr_read_b32 v139, a215
    v_accvgpr_read_b32 v140, a244
    v_accvgpr_read_b32 v141, a245
    v_accvgpr_read_b32 v142, a246
    v_accvgpr_read_b32 v143, a247
    v_dot2_f32_bf16 v80, v128, s86, v80
    v_dot2_f32_bf16 v81, v128, s87, v81
    v_dot2_f32_bf16 v82, v129, s86, v82
    v_dot2_f32_bf16 v83, v129, s87, v83
    v_dot2_f32_bf16 v84, v130, s86, v84
    v_dot2_f32_bf16 v85, v130, s87, v85
    v_dot2_f32_bf16 v86, v131, s86, v86
    v_dot2_f32_bf16 v87, v131, s87, v87
    v_dot2_f32_bf16 v88, v132, s86, v88
    v_dot2_f32_bf16 v89, v132, s87, v89
    v_dot2_f32_bf16 v90, v133, s86, v90
    v_dot2_f32_bf16 v91, v133, s87, v91
    v_dot2_f32_bf16 v92, v134, s86, v92
    v_dot2_f32_bf16 v93, v134, s87, v93
    v_dot2_f32_bf16 v94, v135, s86, v94
    v_dot2_f32_bf16 v95, v135, s87, v95
    v_accvgpr_read_b32 v128, a252
    v_accvgpr_read_b32 v129, a253
    v_accvgpr_read_b32 v130, a254
    v_accvgpr_read_b32 v131, a255
    v_dot2_f32_bf16 v80, v136, s86, v80
    v_dot2_f32_bf16 v81, v136, s87, v81
    v_dot2_f32_bf16 v82, v137, s86, v82
    v_dot2_f32_bf16 v83, v137, s87, v83
    v_dot2_f32_bf16 v84, v138, s86, v84
    v_dot2_f32_bf16 v85, v138, s87, v85
    v_dot2_f32_bf16 v86, v139, s86, v86
    v_dot2_f32_bf16 v87, v139, s87, v87
    v_dot2_f32_bf16 v88, v140, s86, v88
    v_dot2_f32_bf16 v89, v140, s87, v89
    v_dot2_f32_bf16 v90, v141, s86, v90
    v_dot2_f32_bf16 v91, v141, s87, v91
    v_dot2_f32_bf16 v92, v142, s86, v92
    v_dot2_f32_bf16 v93, v142, s87, v93
    v_dot2_f32_bf16 v94, v143, s86, v94
    v_dot2_f32_bf16 v95, v143, s87, v95
    v_pk_mul_f32 v[80:81], v[80:81], v[184:185]
    v_pk_mul_f32 v[82:83], v[82:83], v[184:185]
    v_pk_mul_f32 v[84:85], v[84:85], v[184:185]
    v_pk_mul_f32 v[86:87], v[86:87], v[184:185]
    v_pk_mul_f32 v[88:89], v[88:89], v[184:185]
    v_pk_mul_f32 v[90:91], v[90:91], v[184:185]
    v_pk_mul_f32 v[92:93], v[92:93], v[184:185]
    v_pk_mul_f32 v[94:95], v[94:95], v[184:185]
    v_dot2_f32_bf16 v80, v128, s86, v80
    v_dot2_f32_bf16 v81, v128, s87, v81
    v_dot2_f32_bf16 v82, v129, s86, v82
    v_dot2_f32_bf16 v83, v129, s87, v83
    v_dot2_f32_bf16 v84, v128, s86, v84
    v_dot2_f32_bf16 v85, v128, s87, v85
    v_dot2_f32_bf16 v86, v129, s86, v86
    v_dot2_f32_bf16 v87, v129, s87, v87
    v_dot2_f32_bf16 v88, v130, s86, v88
    v_dot2_f32_bf16 v89, v130, s87, v89
    v_dot2_f32_bf16 v90, v131, s86, v90
    v_dot2_f32_bf16 v91, v131, s87, v91
    v_dot2_f32_bf16 v92, v130, s86, v92
    v_dot2_f32_bf16 v93, v130, s87, v93
    v_dot2_f32_bf16 v94, v131, s86, v94
    v_dot2_f32_bf16 v95, v131, s87, v95
    v_mul_f32 v96, 0xbfb8aa3b, v80
    v_mul_f32 v97, 0xbfb8aa3b, v81
    v_mul_f32 v98, 0xbfb8aa3b, v82
    v_mul_f32 v99, 0xbfb8aa3b, v83
    v_mul_f32 v100, 0xbfb8aa3b, v84
    v_mul_f32 v101, 0xbfb8aa3b, v85
    v_mul_f32 v102, 0xbfb8aa3b, v86
    v_mul_f32 v103, 0xbfb8aa3b, v87
    v_mul_f32 v104, 0xbfb8aa3b, v88
    v_mul_f32 v105, 0xbfb8aa3b, v89
    v_mul_f32 v106, 0xbfb8aa3b, v90
    v_mul_f32 v107, 0xbfb8aa3b, v91
    v_mul_f32 v108, 0xbfb8aa3b, v92
    v_mul_f32 v109, 0xbfb8aa3b, v93
    v_mul_f32 v110, 0xbfb8aa3b, v94
    v_mul_f32 v111, 0xbfb8aa3b, v95
    v_exp_f32 v96, v96
    v_exp_f32 v97, v97
    v_exp_f32 v98, v98
    v_exp_f32 v99, v99
    v_exp_f32 v100, v100
    v_exp_f32 v101, v101
    v_exp_f32 v102, v102
    v_exp_f32 v103, v103
    v_exp_f32 v104, v104
    v_exp_f32 v105, v105
    v_exp_f32 v106, v106
    v_exp_f32 v107, v107
    v_exp_f32 v108, v108
    v_exp_f32 v109, v109
    v_exp_f32 v110, v110
    v_exp_f32 v111, v111
    v_add_f32 v96, 1.0, v96
    v_add_f32 v97, 1.0, v97
    v_add_f32 v98, 1.0, v98
    v_add_f32 v99, 1.0, v99
    v_add_f32 v100, 1.0, v100
    v_add_f32 v101, 1.0, v101
    v_add_f32 v102, 1.0, v102
    v_add_f32 v103, 1.0, v103
    v_add_f32 v104, 1.0, v104
    v_add_f32 v105, 1.0, v105
    v_add_f32 v106, 1.0, v106
    v_add_f32 v107, 1.0, v107
    v_add_f32 v108, 1.0, v108
    v_add_f32 v109, 1.0, v109
    v_add_f32 v110, 1.0, v110
    v_add_f32 v111, 1.0, v111
    v_rcp_f32 v96, v96
    v_rcp_f32 v97, v97
    v_rcp_f32 v98, v98
    v_rcp_f32 v99, v99
    v_rcp_f32 v100, v100
    v_rcp_f32 v101, v101
    v_rcp_f32 v102, v102
    v_rcp_f32 v103, v103
    v_rcp_f32 v104, v104
    v_rcp_f32 v105, v105
    v_rcp_f32 v106, v106
    v_rcp_f32 v107, v107
    v_rcp_f32 v108, v108
    v_rcp_f32 v109, v109
    v_rcp_f32 v110, v110
    v_rcp_f32 v111, v111
    v_pk_mul_f32 v[80:81], v[80:81], v[96:97]
    v_pk_mul_f32 v[82:83], v[82:83], v[98:99]
    v_pk_mul_f32 v[84:85], v[84:85], v[100:101]
    v_pk_mul_f32 v[86:87], v[86:87], v[102:103]
    v_pk_mul_f32 v[88:89], v[88:89], v[104:105]
    v_pk_mul_f32 v[90:91], v[90:91], v[106:107]
    v_pk_mul_f32 v[92:93], v[92:93], v[108:109]
    v_pk_mul_f32 v[94:95], v[94:95], v[110:111]
    s_cmp_eq_u32 s89, 0xff
    s_cbranch_scc1 L_spart
    s_cmp_eq_u32 s76, 3
    s_cbranch_scc1 L_check
    s_branch L_mail
L_spart:
    s_mov_b32 s86, 0x3f80
    s_mov_b32 s87, 0x3f800000
    s_waitcnt vmcnt(0)
    v_dot2_f32_bf16 v96, v0, s86, 0
    v_dot2_f32_bf16 v97, v0, s87, 0
    v_dot2_f32_bf16 v98, v1, s86, 0
    v_dot2_f32_bf16 v99, v1, s87, 0
    v_dot2_f32_bf16 v100, v2, s86, 0
    v_dot2_f32_bf16 v101, v2, s87, 0
    v_dot2_f32_bf16 v102, v3, s86, 0
    v_dot2_f32_bf16 v103, v3, s87, 0
    v_dot2_f32_bf16 v104, v32, s86, 0
    v_dot2_f32_bf16 v105, v32, s87, 0
    v_dot2_f32_bf16 v106, v33, s86, 0
    v_dot2_f32_bf16 v107, v33, s87, 0
    v_dot2_f32_bf16 v108, v34, s86, 0
    v_dot2_f32_bf16 v109, v34, s87, 0
    v_dot2_f32_bf16 v110, v35, s86, 0
    v_dot2_f32_bf16 v111, v35, s87, 0
    v_dot2_f32_bf16 v96, v4, s86, v96
    v_dot2_f32_bf16 v97, v4, s87, v97
    v_dot2_f32_bf16 v98, v5, s86, v98
    v_dot2_f32_bf16 v99, v5, s87, v99
    v_dot2_f32_bf16 v100, v6, s86, v100
    v_dot2_f32_bf16 v101, v6, s87, v101
    v_dot2_f32_bf16 v102, v7, s86, v102
    v_dot2_f32_bf16 v103, v7, s87, v103
    v_dot2_f32_bf16 v104, v36, s86, v104
    v_dot2_f32_bf16 v105, v36, s87, v105
    v_dot2_f32_bf16 v106, v37, s86, v106
    v_dot2_f32_bf16 v107, v37, s87, v107
    v_dot2_f32_bf16 v108, v38, s86, v108
    v_dot2_f32_bf16 v109, v38, s87, v109
    v_dot2_f32_bf16 v110, v39, s86, v110
    v_dot2_f32_bf16 v111, v39, s87, v111
    v_dot2_f32_bf16 v96, v8, s86, v96
    v_dot2_f32_bf16 v97, v8, s87, v97
    v_dot2_f32_bf16 v98, v9, s86, v98
    v_dot2_f32_bf16 v99, v9, s87, v99
    v_dot2_f32_bf16 v100, v10, s86, v100
    v_dot2_f32_bf16 v101, v10, s87, v101
    v_dot2_f32_bf16 v102, v11, s86, v102
    v_dot2_f32_bf16 v103, v11, s87, v103
    v_dot2_f32_bf16 v104, v40, s86, v104
    v_dot2_f32_bf16 v105, v40, s87, v105
    v_dot2_f32_bf16 v106, v41, s86, v106
    v_dot2_f32_bf16 v107, v41, s87, v107
    v_dot2_f32_bf16 v108, v42, s86, v108
    v_dot2_f32_bf16 v109, v42, s87, v109
    v_dot2_f32_bf16 v110, v43, s86, v110
    v_dot2_f32_bf16 v111, v43, s87, v111
    v_dot2_f32_bf16 v96, v12, s86, v96
    v_dot2_f32_bf16 v97, v12, s87, v97
    v_dot2_f32_bf16 v98, v13, s86, v98
    v_dot2_f32_bf16 v99, v13, s87, v99
    v_dot2_f32_bf16 v100, v14, s86, v100
    v_dot2_f32_bf16 v101, v14, s87, v101
    v_dot2_f32_bf16 v102, v15, s86, v102
    v_dot2_f32_bf16 v103, v15, s87, v103
    v_dot2_f32_bf16 v104, v44, s86, v104
    v_dot2_f32_bf16 v105, v44, s87, v105
    v_dot2_f32_bf16 v106, v45, s86, v106
    v_dot2_f32_bf16 v107, v45, s87, v107
    v_dot2_f32_bf16 v108, v46, s86, v108
    v_dot2_f32_bf16 v109, v46, s87, v109
    v_dot2_f32_bf16 v110, v47, s86, v110
    v_dot2_f32_bf16 v111, v47, s87, v111
    v_dot2_f32_bf16 v96, v16, s86, v96
    v_dot2_f32_bf16 v97, v16, s87, v97
    v_dot2_f32_bf16 v98, v17, s86, v98
    v_dot2_f32_bf16 v99, v17, s87, v99
    v_dot2_f32_bf16 v100, v18, s86, v100
    v_dot2_f32_bf16 v101, v18, s87, v101
    v_dot2_f32_bf16 v102, v19, s86, v102
    v_dot2_f32_bf16 v103, v19, s87, v103
    v_dot2_f32_bf16 v104, v48, s86, v104
    v_dot2_f32_bf16 v105, v48, s87, v105
    v_dot2_f32_bf16 v106, v49, s86, v106
    v_dot2_f32_bf16 v107, v49, s87, v107
    v_dot2_f32_bf16 v108, v50, s86, v108
    v_dot2_f32_bf16 v109, v50, s87, v109
    v_dot2_f32_bf16 v110, v51, s86, v110
    v_dot2_f32_bf16 v111, v51, s87, v111
    v_dot2_f32_bf16 v96, v20, s86, v96
    v_dot2_f32_bf16 v97, v20, s87, v97
    v_dot2_f32_bf16 v98, v21, s86, v98
    v_dot2_f32_bf16 v99, v21, s87, v99
    v_dot2_f32_bf16 v100, v22, s86, v100
    v_dot2_f32_bf16 v101, v22, s87, v101
    v_dot2_f32_bf16 v102, v23, s86, v102
    v_dot2_f32_bf16 v103, v23, s87, v103
    v_dot2_f32_bf16 v104, v52, s86, v104
    v_dot2_f32_bf16 v105, v52, s87, v105
    v_dot2_f32_bf16 v106, v53, s86, v106
    v_dot2_f32_bf16 v107, v53, s87, v107
    v_dot2_f32_bf16 v108, v54, s86, v108
    v_dot2_f32_bf16 v109, v54, s87, v109
    v_dot2_f32_bf16 v110, v55, s86, v110
    v_dot2_f32_bf16 v111, v55, s87, v111
    v_dot2_f32_bf16 v96, v24, s86, v96
    v_dot2_f32_bf16 v97, v24, s87, v97
    v_dot2_f32_bf16 v98, v25, s86, v98
    v_dot2_f32_bf16 v99, v25, s87, v99
    v_dot2_f32_bf16 v100, v26, s86, v100
    v_dot2_f32_bf16 v101, v26, s87, v101
    v_dot2_f32_bf16 v102, v27, s86, v102
    v_dot2_f32_bf16 v103, v27, s87, v103
    v_dot2_f32_bf16 v104, v56, s86, v104
    v_dot2_f32_bf16 v105, v56, s87, v105
    v_dot2_f32_bf16 v106, v57, s86, v106
    v_dot2_f32_bf16 v107, v57, s87, v107
    v_dot2_f32_bf16 v108, v58, s86, v108
    v_dot2_f32_bf16 v109, v58, s87, v109
    v_dot2_f32_bf16 v110, v59, s86, v110
    v_dot2_f32_bf16 v111, v59, s87, v111
    v_dot2_f32_bf16 v96, v28, s86, v96
    v_dot2_f32_bf16 v97, v28, s87, v97
    v_dot2_f32_bf16 v98, v29, s86, v98
    v_dot2_f32_bf16 v99, v29, s87, v99
    v_dot2_f32_bf16 v100, v30, s86, v100
    v_dot2_f32_bf16 v101, v30, s87, v101
    v_dot2_f32_bf16 v102, v31, s86, v102
    v_dot2_f32_bf16 v103, v31, s87, v103
    v_dot2_f32_bf16 v104, v60, s86, v104
    v_dot2_f32_bf16 v105, v60, s87, v105
    v_dot2_f32_bf16 v106, v61, s86, v106
    v_dot2_f32_bf16 v107, v61, s87, v107
    v_dot2_f32_bf16 v108, v62, s86, v108
    v_dot2_f32_bf16 v109, v62, s87, v109
    v_dot2_f32_bf16 v110, v63, s86, v110
    v_dot2_f32_bf16 v111, v63, s87, v111
    v_pk_mul_f32 v[96:97], v[96:97], v[80:81]
    v_pk_mul_f32 v[98:99], v[98:99], v[82:83]
    v_pk_mul_f32 v[100:101], v[100:101], v[84:85]
    v_pk_mul_f32 v[102:103], v[102:103], v[86:87]
    v_pk_mul_f32 v[104:105], v[104:105], v[88:89]
    v_pk_mul_f32 v[106:107], v[106:107], v[90:91]
    v_pk_mul_f32 v[108:109], v[108:109], v[92:93]
    v_pk_mul_f32 v[110:111], v[110:111], v[94:95]
    v_dot2_f32_bf16 v96, v224, s86, v96
    v_dot2_f32_bf16 v97, v224, s87, v97
    v_dot2_f32_bf16 v98, v225, s86, v98
    v_dot2_f32_bf16 v99, v225, s87, v99
    v_dot2_f32_bf16 v100, v226, s86, v100
    v_dot2_f32_bf16 v101, v226, s87, v101
    v_dot2_f32_bf16 v102, v227, s86, v102
    v_dot2_f32_bf16 v103, v227, s87, v103
    v_dot2_f32_bf16 v104, v228, s86, v104
    v_dot2_f32_bf16 v105, v228, s87, v105
    v_dot2_f32_bf16 v106, v229, s86, v106
    v_dot2_f32_bf16 v107, v229, s87, v107
    v_dot2_f32_bf16 v108, v230, s86, v108
    v_dot2_f32_bf16 v109, v230, s87, v109
    v_dot2_f32_bf16 v110, v231, s86, v110
    v_dot2_f32_bf16 v111, v231, s87, v111
    v_cvt_pk_bf16_f32 v64, v96, v97
    v_cvt_pk_bf16_f32 v65, v98, v99
    v_cvt_pk_bf16_f32 v66, v100, v101
    v_cvt_pk_bf16_f32 v67, v102, v103
    v_cvt_pk_bf16_f32 v68, v104, v105
    v_cvt_pk_bf16_f32 v69, v106, v107
    v_cvt_pk_bf16_f32 v70, v108, v109
    v_cvt_pk_bf16_f32 v71, v110, v111
    s_mov_b32 s87, 14336
    buffer_store_dwordx2 v[64:65], v212, s[48:51], 0 offen sc1
    buffer_store_dwordx2 v[66:67], v212, s[48:51], s87 offen sc1
    buffer_store_dwordx2 v[68:69], v213, s[48:51], 0 offen sc1
    buffer_store_dwordx2 v[70:71], v213, s[48:51], s87 offen sc1
    s_cmp_eq_u32 s88, 0
    s_mov_b32 s88, 0
    s_cbranch_scc1 L_next
    v_readfirstlane_b32 s86, v116
    s_nop 1
    s_and_b32 s78, s86, 15
    s_bfe_u32 s86, s86, 0x80008
    s_cmp_eq_u32 s78, 7
    s_cselect_b32 s83, s86, 0
    s_mov_b32 s82, 4
L_next:
    s_cmp_eq_u32 s83, 0
    s_cbranch_scc1 L_k1_done
    s_ff1_i32_b32 s84, s83
    s_sub_u32 s82, s82, 1
    s_mov_b32 s85, s82
    s_cmp_lg_u32 s82, 0
    s_cbranch_scc1 L_more
    s_bitset0_b32 s83, s84
    s_mov_b32 s82, 4
L_more:
    s_waitcnt vmcnt(0)
    s_branch L_item
L_k1_done:
L_k1_end:
    s_endpgm
L_slow:
    s_waitcnt vmcnt(0) lgkmcnt(0)
    s_mov_b32 s87, m0
    s_mov_b32 s88, s82
    s_lshl_b32 s83, s76, 14
    s_add_u32 s83, s83, 98304
    s_lshl_b32 s86, s76, 7
    v_subrev_u32 v212, s86, v212
    v_subrev_u32 v216, s86, v216
    v_subrev_u32 v213, s86, v213
    v_subrev_u32 v217, s86, v217
    v_subrev_u32 v214, s86, v214
    v_subrev_u32 v218, s86, v218
    v_subrev_u32 v215, s86, v215
    v_subrev_u32 v219, s86, v219
    v_add_u32 v192, s83, v238
    v_add_u32 v193, s83, v240
    v_add_u32 v194, s83, v224
    v_add_u32 v195, s83, v226
    v_add_u32 v196, s83, v228
    v_add_u32 v197, s83, v230
    v_mov_b32 v188, 0xff800000
    v_mov_b32 v190, 0xff800000
    s_mov_b32 s86, 0
L_slow1:
    s_add_u32 m0, s83, 0
    s_add_u32 s82, s86, 0
    buffer_load_dwordx4 v212, s[48:51], s82 offen offset:0 lds
    buffer_load_dwordx4 v213, s[48:51], s82 offen offset:1024 lds
    buffer_load_dwordx4 v214, s[48:51], s82 offen offset:2048 lds
    buffer_load_dwordx4 v215, s[48:51], s82 offen offset:3072 lds
    s_add_u32 m0, s83, 4096
    s_add_u32 s82, s86, 128
    buffer_load_dwordx4 v212, s[48:51], s82 offen offset:0 lds
    buffer_load_dwordx4 v213, s[48:51], s82 offen offset:1024 lds
    buffer_load_dwordx4 v214, s[48:51], s82 offen offset:2048 lds
    buffer_load_dwordx4 v215, s[48:51], s82 offen offset:3072 lds
    s_add_u32 m0, s83, 8192
    s_add_u32 s82, s86, 256
    buffer_load_dwordx4 v212, s[48:51], s82 offen offset:0 lds
    buffer_load_dwordx4 v213, s[48:51], s82 offen offset:1024 lds
    buffer_load_dwordx4 v214, s[48:51], s82 offen offset:2048 lds
    buffer_load_dwordx4 v215, s[48:51], s82 offen offset:3072 lds
    s_add_u32 m0, s83, 12288
    s_add_u32 s82, s86, 384
    buffer_load_dwordx4 v212, s[48:51], s82 offen offset:0 lds
    buffer_load_dwordx4 v213, s[48:51], s82 offen offset:1024 lds
    buffer_load_dwordx4 v214, s[48:51], s82 offen offset:2048 lds
    buffer_load_dwordx4 v215, s[48:51], s82 offen offset:3072 lds
    s_waitcnt vmcnt(0)
    ds_read_b128 a[32:35], v192 offset:0
    ds_read_b128 a[36:39], v192 offset:2048
    ds_read_b128 a[40:43], v193 offset:0
    ds_read_b128 a[44:47], v193 offset:2048
    ds_read_b128 a[48:51], v192 offset:4096
    ds_read_b128 a[52:55], v192 offset:6144
    ds_read_b128 a[56:59], v193 offset:4096
    ds_read_b128 a[60:63], v193 offset:6144
    ds_read_b128 a[64:67], v192 offset:8192
    ds_read_b128 a[68:71], v192 offset:10240
    ds_read_b128 a[72:75], v193 offset:8192
    ds_read_b128 a[76:79], v193 offset:10240
    ds_read_b128 a[80:83], v192 offset:12288
    ds_read_b128 a[84:87], v192 offset:14336
    ds_read_b128 a[88:91], v193 offset:12288
    ds_read_b128 a[92:95], v193 offset:14336
    s_waitcnt lgkmcnt(0)
    v_mfma_f32_16x16x32_bf16 v[128:131], a[32:35], a[120:123], 0
    v_mfma_f32_16x16x32_bf16 v[132:135], a[32:35], a[124:127], 0
    v_mfma_f32_16x16x32_bf16 v[136:139], a[36:39], a[120:123], 0
    v_mfma_f32_16x16x32_bf16 v[140:143], a[36:39], a[124:127], 0
    v_mfma_f32_16x16x32_bf16 v[128:131], a[40:43], a[128:131], v[128:131]
    v_mfma_f32_16x16x32_bf16 v[132:135], a[40:43], a[132:135], v[132:135]
    v_mfma_f32_16x16x32_bf16 v[136:139], a[44:47], a[128:131], v[136:139]
    v_mfma_f32_16x16x32_bf16 v[140:143], a[44:47], a[132:135], v[140:143]
    v_mfma_f32_16x16x32_bf16 v[128:131], a[48:51], a[136:139], v[128:131]
    v_mfma_f32_16x16x32_bf16 v[132:135], a[48:51], a[140:143], v[132:135]
    v_mfma_f32_16x16x32_bf16 v[136:139], a[52:55], a[136:139], v[136:139]
    v_mfma_f32_16x16x32_bf16 v[140:143], a[52:55], a[140:143], v[140:143]
    v_mfma_f32_16x16x32_bf16 v[128:131], a[56:59], a[144:147], v[128:131]
    v_mfma_f32_16x16x32_bf16 v[132:135], a[56:59], a[148:151], v[132:135]
    v_mfma_f32_16x16x32_bf16 v[136:139], a[60:63], a[144:147], v[136:139]
    v_mfma_f32_16x16x32_bf16 v[140:143], a[60:63], a[148:151], v[140:143]
    v_mfma_f32_16x16x32_bf16 v[128:131], a[64:67], a[152:155], v[128:131]
    v_mfma_f32_16x16x32_bf16 v[132:135], a[64:67], a[156:159], v[132:135]
    v_mfma_f32_16x16x32_bf16 v[136:139], a[68:71], a[152:155], v[136:139]
    v_mfma_f32_16x16x32_bf16 v[140:143], a[68:71], a[156:159], v[140:143]
    v_mfma_f32_16x16x32_bf16 v[128:131], a[72:75], a[160:163], v[128:131]
    v_mfma_f32_16x16x32_bf16 v[132:135], a[72:75], a[164:167], v[132:135]
    v_mfma_f32_16x16x32_bf16 v[136:139], a[76:79], a[160:163], v[136:139]
    v_mfma_f32_16x16x32_bf16 v[140:143], a[76:79], a[164:167], v[140:143]
    v_mfma_f32_16x16x32_bf16 v[128:131], a[80:83], a[168:171], v[128:131]
    v_mfma_f32_16x16x32_bf16 v[132:135], a[80:83], a[172:175], v[132:135]
    v_mfma_f32_16x16x32_bf16 v[136:139], a[84:87], a[168:171], v[136:139]
    v_mfma_f32_16x16x32_bf16 v[140:143], a[84:87], a[172:175], v[140:143]
    v_mfma_f32_16x16x32_bf16 v[128:131], a[88:91], a[176:179], v[128:131]
    v_mfma_f32_16x16x32_bf16 v[132:135], a[88:91], a[180:183], v[132:135]
    v_mfma_f32_16x16x32_bf16 v[136:139], a[92:95], a[176:179], v[136:139]
    v_mfma_f32_16x16x32_bf16 v[140:143], a[92:95], a[180:183], v[140:143]
    s_nop 4
    v_max3_f32 v188, v188, v128, v129
    v_max3_f32 v188, v188, v130, v131
    v_max3_f32 v188, v188, v136, v137
    v_max3_f32 v188, v188, v138, v139
    v_max3_f32 v190, v190, v132, v133
    v_max3_f32 v190, v190, v134, v135
    v_max3_f32 v190, v190, v140, v141
    v_max3_f32 v190, v190, v142, v143
    s_add_u32 s86, s86, 16384
    s_cmp_lt_u32 s86, 262144
    s_cbranch_scc1 L_slow1
    v_mov_b32 v189, v188
    v_mov_b32 v191, v190
    s_nop 0
    v_permlane32_swap_b32 v188, v189
    v_permlane32_swap_b32 v190, v191
    v_max_f32 v188, v188, v189
    v_max_f32 v190, v190, v191
    v_mov_b32 v189, v188
    v_mov_b32 v191, v190
    s_nop 0
    v_permlane16_swap_b32 v188, v189
    v_permlane16_swap_b32 v190, v191
    v_max_f32 v188, v188, v189
    v_max_f32 v190, v190, v191
    v_sub_f32 v176, 0, v188
    v_sub_f32 v177, 0, v188
    v_sub_f32 v178, 0, v188
    v_sub_f32 v179, 0, v188
    v_sub_f32 v180, 0, v190
    v_sub_f32 v181, 0, v190
    v_sub_f32 v182, 0, v190
    v_sub_f32 v183, 0, v190
    v_mov_b32 v0, 0
    v_mov_b32 v1, 0
    v_mov_b32 v2, 0
    v_mov_b32 v3, 0
    v_mov_b32 v4, 0
    v_mov_b32 v5, 0
    v_mov_b32 v6, 0
    v_mov_b32 v7, 0
    v_mov_b32 v8, 0
    v_mov_b32 v9, 0
    v_mov_b32 v10, 0
    v_mov_b32 v11, 0
    v_mov_b32 v12, 0
    v_mov_b32 v13, 0
    v_mov_b32 v14, 0
    v_mov_b32 v15, 0
    v_mov_b32 v16, 0
    v_mov_b32 v17, 0
    v_mov_b32 v18, 0
    v_mov_b32 v19, 0
    v_mov_b32 v20, 0
    v_mov_b32 v21, 0
    v_mov_b32 v22, 0
    v_mov_b32 v23, 0
    v_mov_b32 v24, 0
    v_mov_b32 v25, 0
    v_mov_b32 v26, 0
    v_mov_b32 v27, 0
    v_mov_b32 v28, 0
    v_mov_b32 v29, 0
    v_mov_b32 v30, 0
    v_mov_b32 v31, 0
    v_mov_b32 v32, 0
    v_mov_b32 v33, 0
    v_mov_b32 v34, 0
    v_mov_b32 v35, 0
    v_mov_b32 v36, 0
    v_mov_b32 v37, 0
    v_mov_b32 v38, 0
    v_mov_b32 v39, 0
    v_mov_b32 v40, 0
    v_mov_b32 v41, 0
    v_mov_b32 v42, 0
    v_mov_b32 v43, 0
    v_mov_b32 v44, 0
    v_mov_b32 v45, 0
    v_mov_b32 v46, 0
    v_mov_b32 v47, 0
    v_mov_b32 v48, 0
    v_mov_b32 v49, 0
    v_mov_b32 v50, 0
    v_mov_b32 v51, 0
    v_mov_b32 v52, 0
    v_mov_b32 v53, 0
    v_mov_b32 v54, 0
    v_mov_b32 v55, 0
    v_mov_b32 v56, 0
    v_mov_b32 v57, 0
    v_mov_b32 v58, 0
    v_mov_b32 v59, 0
    v_mov_b32 v60, 0
    v_mov_b32 v61, 0
    v_mov_b32 v62, 0
    v_mov_b32 v63, 0
    v_mov_b32 v64, 0
    v_mov_b32 v65, 0
    v_mov_b32 v66, 0
    v_mov_b32 v67, 0
    v_mov_b32 v68, 0
    v_mov_b32 v69, 0
    v_mov_b32 v70, 0
    v_mov_b32 v71, 0
    v_mov_b32 v72, 0
    v_mov_b32 v73, 0
    v_mov_b32 v74, 0
    v_mov_b32 v75, 0
    v_mov_b32 v76, 0
    v_mov_b32 v77, 0
    v_mov_b32 v78, 0
    v_mov_b32 v79, 0
    v_mov_b32 v80, 0
    v_mov_b32 v81, 0
    v_mov_b32 v82, 0
    v_mov_b32 v83, 0
    v_mov_b32 v84, 0
    v_mov_b32 v85, 0
    v_mov_b32 v86, 0
    v_mov_b32 v87, 0
    v_mov_b32 v88, 0
    v_mov_b32 v89, 0
    v_mov_b32 v90, 0
    v_mov_b32 v91, 0
    v_mov_b32 v92, 0
    v_mov_b32 v93, 0
    v_mov_b32 v94, 0
    v_mov_b32 v95, 0
    v_mov_b32 v96, 0
    v_mov_b32 v97, 0
    v_mov_b32 v98, 0
    v_mov_b32 v99, 0
    v_mov_b32 v100, 0
    v_mov_b32 v101, 0
    v_mov_b32 v102, 0
    v_mov_b32 v103, 0
    v_mov_b32 v104, 0
    v_mov_b32 v105, 0
    v_mov_b32 v106, 0
    v_mov_b32 v107, 0
    v_mov_b32 v108, 0
    v_mov_b32 v109, 0
    v_mov_b32 v110, 0
    v_mov_b32 v111, 0
    v_mov_b32 v112, 0
    v_mov_b32 v113, 0
    v_mov_b32 v114, 0
    v_mov_b32 v115, 0
    v_mov_b32 v116, 0
    v_mov_b32 v117, 0
    v_mov_b32 v118, 0
    v_mov_b32 v119, 0
    v_mov_b32 v120, 0
    v_mov_b32 v121, 0
    v_mov_b32 v122, 0
    v_mov_b32 v123, 0
    v_mov_b32 v124, 0
    v_mov_b32 v125, 0
    v_mov_b32 v126, 0
    v_mov_b32 v127, 0
    v_mov_b32 v168, 0
    v_mov_b32 v169, 0
    v_mov_b32 v170, 0
    v_mov_b32 v171, 0
    v_mov_b32 v172, 0
    v_mov_b32 v173, 0
    v_mov_b32 v174, 0
    v_mov_b32 v175, 0
    s_mov_b32 s86, 0
L_slow2:
    s_add_u32 m0, s83, 0
    s_add_u32 s82, s86, 0
    buffer_load_dwordx4 v212, s[48:51], s82 offen offset:0 lds
    buffer_load_dwordx4 v213, s[48:51], s82 offen offset:1024 lds
    buffer_load_dwordx4 v214, s[48:51], s82 offen offset:2048 lds
    buffer_load_dwordx4 v215, s[48:51], s82 offen offset:3072 lds
    s_add_u32 m0, s83, 4096
    s_add_u32 s82, s86, 128
    buffer_load_dwordx4 v212, s[48:51], s82 offen offset:0 lds
    buffer_load_dwordx4 v213, s[48:51], s82 offen offset:1024 lds
    buffer_load_dwordx4 v214, s[48:51], s82 offen offset:2048 lds
    buffer_load_dwordx4 v215, s[48:51], s82 offen offset:3072 lds
    s_add_u32 m0, s83, 8192
    s_add_u32 s82, s86, 256
    buffer_load_dwordx4 v212, s[48:51], s82 offen offset:0 lds
    buffer_load_dwordx4 v213, s[48:51], s82 offen offset:1024 lds
    buffer_load_dwordx4 v214, s[48:51], s82 offen offset:2048 lds
    buffer_load_dwordx4 v215, s[48:51], s82 offen offset:3072 lds
    s_add_u32 m0, s83, 12288
    s_add_u32 s82, s86, 384
    buffer_load_dwordx4 v212, s[48:51], s82 offen offset:0 lds
    buffer_load_dwordx4 v213, s[48:51], s82 offen offset:1024 lds
    buffer_load_dwordx4 v214, s[48:51], s82 offen offset:2048 lds
    buffer_load_dwordx4 v215, s[48:51], s82 offen offset:3072 lds
    s_waitcnt vmcnt(0)
    ds_read_b128 a[32:35], v192 offset:0
    ds_read_b128 a[36:39], v192 offset:2048
    ds_read_b128 a[40:43], v193 offset:0
    ds_read_b128 a[44:47], v193 offset:2048
    ds_read_b128 a[48:51], v192 offset:4096
    ds_read_b128 a[52:55], v192 offset:6144
    ds_read_b128 a[56:59], v193 offset:4096
    ds_read_b128 a[60:63], v193 offset:6144
    ds_read_b128 a[64:67], v192 offset:8192
    ds_read_b128 a[68:71], v192 offset:10240
    ds_read_b128 a[72:75], v193 offset:8192
    ds_read_b128 a[76:79], v193 offset:10240
    ds_read_b128 a[80:83], v192 offset:12288
    ds_read_b128 a[84:87], v192 offset:14336
    ds_read_b128 a[88:91], v193 offset:12288
    ds_read_b128 a[92:95], v193 offset:14336
    s_waitcnt lgkmcnt(0)
    v_mfma_f32_16x16x32_bf16 v[128:131], a[32:35], a[120:123], v[176:179]
    v_mfma_f32_16x16x32_bf16 v[132:135], a[32:35], a[124:127], v[180:183]
    v_mfma_f32_16x16x32_bf16 v[136:139], a[36:39], a[120:123], v[176:179]
    v_mfma_f32_16x16x32_bf16 v[140:143], a[36:39], a[124:127], v[180:183]
    v_mfma_f32_16x16x32_bf16 v[128:131], a[40:43], a[128:131], v[128:131]
    v_mfma_f32_16x16x32_bf16 v[132:135], a[40:43], a[132:135], v[132:135]
    v_mfma_f32_16x16x32_bf16 v[136:139], a[44:47], a[128:131], v[136:139]
    v_mfma_f32_16x16x32_bf16 v[140:143], a[44:47], a[132:135], v[140:143]
    v_mfma_f32_16x16x32_bf16 v[128:131], a[48:51], a[136:139], v[128:131]
    v_mfma_f32_16x16x32_bf16 v[132:135], a[48:51], a[140:143], v[132:135]
    v_mfma_f32_16x16x32_bf16 v[136:139], a[52:55], a[136:139], v[136:139]
    v_mfma_f32_16x16x32_bf16 v[140:143], a[52:55], a[140:143], v[140:143]
    v_mfma_f32_16x16x32_bf16 v[128:131], a[56:59], a[144:147], v[128:131]
    v_mfma_f32_16x16x32_bf16 v[132:135], a[56:59], a[148:151], v[132:135]
    v_mfma_f32_16x16x32_bf16 v[136:139], a[60:63], a[144:147], v[136:139]
    v_mfma_f32_16x16x32_bf16 v[140:143], a[60:63], a[148:151], v[140:143]
    v_mfma_f32_16x16x32_bf16 v[128:131], a[64:67], a[152:155], v[128:131]
    v_mfma_f32_16x16x32_bf16 v[132:135], a[64:67], a[156:159], v[132:135]
    v_mfma_f32_16x16x32_bf16 v[136:139], a[68:71], a[152:155], v[136:139]
    v_mfma_f32_16x16x32_bf16 v[140:143], a[68:71], a[156:159], v[140:143]
    v_mfma_f32_16x16x32_bf16 v[128:131], a[72:75], a[160:163], v[128:131]
    v_mfma_f32_16x16x32_bf16 v[132:135], a[72:75], a[164:167], v[132:135]
    v_mfma_f32_16x16x32_bf16 v[136:139], a[76:79], a[160:163], v[136:139]
    v_mfma_f32_16x16x32_bf16 v[140:143], a[76:79], a[164:167], v[140:143]
    v_mfma_f32_16x16x32_bf16 v[128:131], a[80:83], a[168:171], v[128:131]
    v_mfma_f32_16x16x32_bf16 v[132:135], a[80:83], a[172:175], v[132:135]
    v_mfma_f32_16x16x32_bf16 v[136:139], a[84:87], a[168:171], v[136:139]
    v_mfma_f32_16x16x32_bf16 v[140:143], a[84:87], a[172:175], v[140:143]
    v_mfma_f32_16x16x32_bf16 v[128:131], a[88:91], a[176:179], v[128:131]
    v_mfma_f32_16x16x32_bf16 v[132:135], a[88:91], a[180:183], v[132:135]
    v_mfma_f32_16x16x32_bf16 v[136:139], a[92:95], a[176:179], v[136:139]
    v_mfma_f32_16x16x32_bf16 v[140:143], a[92:95], a[180:183], v[140:143]
    s_nop 4
    v_exp_f32 v128, v128
    v_exp_f32 v129, v129
    v_exp_f32 v130, v130
    v_exp_f32 v131, v131
    v_exp_f32 v132, v132
    v_exp_f32 v133, v133
    v_exp_f32 v134, v134
    v_exp_f32 v135, v135
    v_exp_f32 v136, v136
    v_exp_f32 v137, v137
    v_exp_f32 v138, v138
    v_exp_f32 v139, v139
    v_exp_f32 v140, v140
    v_exp_f32 v141, v141
    v_exp_f32 v142, v142
    v_exp_f32 v143, v143
    v_cvt_pk_bf16_f32 v160, v128, v129
    v_cvt_pk_bf16_f32 v161, v130, v131
    v_cvt_pk_bf16_f32 v162, v136, v137
    v_cvt_pk_bf16_f32 v163, v138, v139
    v_cvt_pk_bf16_f32 v164, v132, v133
    v_cvt_pk_bf16_f32 v165, v134, v135
    v_cvt_pk_bf16_f32 v166, v140, v141
    v_cvt_pk_bf16_f32 v167, v142, v143
    s_add_u32 m0, s83, 0
    s_add_u32 s82, s86, 0
    buffer_load_dwordx4 v216, s[52:55], s82 offen offset:0 lds
    buffer_load_dwordx4 v217, s[52:55], s82 offen offset:1024 lds
    buffer_load_dwordx4 v218, s[52:55], s82 offen offset:2048 lds
    buffer_load_dwordx4 v219, s[52:55], s82 offen offset:3072 lds
    s_add_u32 m0, s83, 4096
    s_add_u32 s82, s86, 128
    buffer_load_dwordx4 v216, s[52:55], s82 offen offset:0 lds
    buffer_load_dwordx4 v217, s[52:55], s82 offen offset:1024 lds
    buffer_load_dwordx4 v218, s[52:55], s82 offen offset:2048 lds
    buffer_load_dwordx4 v219, s[52:55], s82 offen offset:3072 lds
    s_add_u32 m0, s83, 8192
    s_add_u32 s82, s86, 256
    buffer_load_dwordx4 v216, s[52:55], s82 offen offset:0 lds
    buffer_load_dwordx4 v217, s[52:55], s82 offen offset:1024 lds
    buffer_load_dwordx4 v218, s[52:55], s82 offen offset:2048 lds
    buffer_load_dwordx4 v219, s[52:55], s82 offen offset:3072 lds
    s_add_u32 m0, s83, 12288
    s_add_u32 s82, s86, 384
    buffer_load_dwordx4 v216, s[52:55], s82 offen offset:0 lds
    buffer_load_dwordx4 v217, s[52:55], s82 offen offset:1024 lds
    buffer_load_dwordx4 v218, s[52:55], s82 offen offset:2048 lds
    buffer_load_dwordx4 v219, s[52:55], s82 offen offset:3072 lds
    s_waitcnt vmcnt(0)
    ds_read_b64_tr_b16 a[32:33], v194 offset:0
    ds_read_b64_tr_b16 a[34:35], v194 offset:2048
    ds_read_b64_tr_b16 a[36:37], v195 offset:0
    ds_read_b64_tr_b16 a[38:39], v195 offset:2048
    ds_read_b64_tr_b16 a[40:41], v196 offset:0
    ds_read_b64_tr_b16 a[42:43], v196 offset:2048
    ds_read_b64_tr_b16 a[44:45], v197 offset:0
    ds_read_b64_tr_b16 a[46:47], v197 offset:2048
    ds_read_b64_tr_b16 a[48:49], v194 offset:4096
    ds_read_b64_tr_b16 a[50:51], v194 offset:6144
    ds_read_b64_tr_b16 a[52:53], v195 offset:4096
    ds_read_b64_tr_b16 a[54:55], v195 offset:6144
    ds_read_b64_tr_b16 a[56:57], v196 offset:4096
    ds_read_b64_tr_b16 a[58:59], v196 offset:6144
    ds_read_b64_tr_b16 a[60:61], v197 offset:4096
    ds_read_b64_tr_b16 a[62:63], v197 offset:6144
    ds_read_b64_tr_b16 a[64:65], v194 offset:8192
    ds_read_b64_tr_b16 a[66:67], v194 offset:10240
    ds_read_b64_tr_b16 a[68:69], v195 offset:8192
    ds_read_b64_tr_b16 a[70:71], v195 offset:10240
    ds_read_b64_tr_b16 a[72:73], v196 offset:8192
    ds_read_b64_tr_b16 a[74:75], v196 offset:10240
    ds_read_b64_tr_b16 a[76:77], v197 offset:8192
    ds_read_b64_tr_b16 a[78:79], v197 offset:10240
    ds_read_b64_tr_b16 a[80:81], v194 offset:12288
    ds_read_b64_tr_b16 a[82:83], v194 offset:14336
    ds_read_b64_tr_b16 a[84:85], v195 offset:12288
    ds_read_b64_tr_b16 a[86:87], v195 offset:14336
    ds_read_b64_tr_b16 a[88:89], v196 offset:12288
    ds_read_b64_tr_b16 a[90:91], v196 offset:14336
    ds_read_b64_tr_b16 a[92:93], v197 offset:12288
    ds_read_b64_tr_b16 a[94:95], v197 offset:14336
    s_waitcnt lgkmcnt(0)
    v_mfma_f32_16x16x32_bf16 v[168:171], v[184:187], v[160:163], v[168:171]
    v_mfma_f32_16x16x32_bf16 v[172:175], v[184:187], v[164:167], v[172:175]
    v_mfma_f32_16x16x32_bf16 v[0:3], a[32:35], v[160:163], v[0:3]
    v_mfma_f32_16x16x32_bf16 v[4:7], a[32:35], v[164:167], v[4:7]
    v_mfma_f32_16x16x32_bf16 v[8:11], a[36:39], v[160:163], v[8:11]
    v_mfma_f32_16x16x32_bf16 v[12:15], a[36:39], v[164:167], v[12:15]
    v_mfma_f32_16x16x32_bf16 v[16:19], a[40:43], v[160:163], v[16:19]
    v_mfma_f32_16x16x32_bf16 v[20:23], a[40:43], v[164:167], v[20:23]
    v_mfma_f32_16x16x32_bf16 v[24:27], a[44:47], v[160:163], v[24:27]
    v_mfma_f32_16x16x32_bf16 v[28:31], a[44:47], v[164:167], v[28:31]
    v_mfma_f32_16x16x32_bf16 v[32:35], a[48:51], v[160:163], v[32:35]
    v_mfma_f32_16x16x32_bf16 v[36:39], a[48:51], v[164:167], v[36:39]
    v_mfma_f32_16x16x32_bf16 v[40:43], a[52:55], v[160:163], v[40:43]
    v_mfma_f32_16x16x32_bf16 v[44:47], a[52:55], v[164:167], v[44:47]
    v_mfma_f32_16x16x32_bf16 v[48:51], a[56:59], v[160:163], v[48:51]
    v_mfma_f32_16x16x32_bf16 v[52:55], a[56:59], v[164:167], v[52:55]
    v_mfma_f32_16x16x32_bf16 v[56:59], a[60:63], v[160:163], v[56:59]
    v_mfma_f32_16x16x32_bf16 v[60:63], a[60:63], v[164:167], v[60:63]
    v_mfma_f32_16x16x32_bf16 v[64:67], a[64:67], v[160:163], v[64:67]
    v_mfma_f32_16x16x32_bf16 v[68:71], a[64:67], v[164:167], v[68:71]
    v_mfma_f32_16x16x32_bf16 v[72:75], a[68:71], v[160:163], v[72:75]
    v_mfma_f32_16x16x32_bf16 v[76:79], a[68:71], v[164:167], v[76:79]
    v_mfma_f32_16x16x32_bf16 v[80:83], a[72:75], v[160:163], v[80:83]
    v_mfma_f32_16x16x32_bf16 v[84:87], a[72:75], v[164:167], v[84:87]
    v_mfma_f32_16x16x32_bf16 v[88:91], a[76:79], v[160:163], v[88:91]
    v_mfma_f32_16x16x32_bf16 v[92:95], a[76:79], v[164:167], v[92:95]
    v_mfma_f32_16x16x32_bf16 v[96:99], a[80:83], v[160:163], v[96:99]
    v_mfma_f32_16x16x32_bf16 v[100:103], a[80:83], v[164:167], v[100:103]
    v_mfma_f32_16x16x32_bf16 v[104:107], a[84:87], v[160:163], v[104:107]
    v_mfma_f32_16x16x32_bf16 v[108:111], a[84:87], v[164:167], v[108:111]
    v_mfma_f32_16x16x32_bf16 v[112:115], a[88:91], v[160:163], v[112:115]
    v_mfma_f32_16x16x32_bf16 v[116:119], a[88:91], v[164:167], v[116:119]
    v_mfma_f32_16x16x32_bf16 v[120:123], a[92:95], v[160:163], v[120:123]
    v_mfma_f32_16x16x32_bf16 v[124:127], a[92:95], v[164:167], v[124:127]
    s_add_u32 s86, s86, 16384
    s_cmp_lt_u32 s86, 262144
    s_nop 7
    s_cbranch_scc1 L_slow2
    v_rcp_f32 v192, v168
    v_rcp_f32 v193, v172
    v_mul_f32 v0, v0, v192
    v_mul_f32 v1, v1, v192
    v_mul_f32 v2, v2, v192
    v_mul_f32 v3, v3, v192
    v_mul_f32 v8, v8, v192
    v_mul_f32 v9, v9, v192
    v_mul_f32 v10, v10, v192
    v_mul_f32 v11, v11, v192
    v_cvt_pk_bf16_f32 v176, v0, v1
    v_cvt_pk_bf16_f32 v177, v2, v3
    v_cvt_pk_bf16_f32 v178, v8, v9
    v_cvt_pk_bf16_f32 v179, v10, v11
    v_mul_f32 v4, v4, v193
    v_mul_f32 v5, v5, v193
    v_mul_f32 v6, v6, v193
    v_mul_f32 v7, v7, v193
    ds_write_b128 v210, v[176:179] offset:0
    v_mul_f32 v12, v12, v193
    v_mul_f32 v13, v13, v193
    v_mul_f32 v14, v14, v193
    v_mul_f32 v15, v15, v193
    v_cvt_pk_bf16_f32 v180, v4, v5
    v_cvt_pk_bf16_f32 v181, v6, v7
    v_cvt_pk_bf16_f32 v182, v12, v13
    v_cvt_pk_bf16_f32 v183, v14, v15
    v_mul_f32 v16, v16, v192
    v_mul_f32 v17, v17, v192
    v_mul_f32 v18, v18, v192
    v_mul_f32 v19, v19, v192
    ds_write_b128 v210, v[180:183] offset:1024
    v_mul_f32 v24, v24, v192
    v_mul_f32 v25, v25, v192
    v_mul_f32 v26, v26, v192
    v_mul_f32 v27, v27, v192
    v_cvt_pk_bf16_f32 v176, v16, v17
    v_cvt_pk_bf16_f32 v177, v18, v19
    v_cvt_pk_bf16_f32 v178, v24, v25
    v_cvt_pk_bf16_f32 v179, v26, v27
    v_mul_f32 v20, v20, v193
    v_mul_f32 v21, v21, v193
    v_mul_f32 v22, v22, v193
    v_mul_f32 v23, v23, v193
    ds_write_b128 v210, v[176:179] offset:2048
    v_mul_f32 v28, v28, v193
    v_mul_f32 v29, v29, v193
    v_mul_f32 v30, v30, v193
    v_mul_f32 v31, v31, v193
    v_cvt_pk_bf16_f32 v180, v20, v21
    v_cvt_pk_bf16_f32 v181, v22, v23
    v_cvt_pk_bf16_f32 v182, v28, v29
    v_cvt_pk_bf16_f32 v183, v30, v31
    v_mul_f32 v32, v32, v192
    v_mul_f32 v33, v33, v192
    v_mul_f32 v34, v34, v192
    v_mul_f32 v35, v35, v192
    ds_write_b128 v210, v[180:183] offset:3072
    v_mul_f32 v40, v40, v192
    v_mul_f32 v41, v41, v192
    v_mul_f32 v42, v42, v192
    v_mul_f32 v43, v43, v192
    v_cvt_pk_bf16_f32 v176, v32, v33
    v_cvt_pk_bf16_f32 v177, v34, v35
    v_cvt_pk_bf16_f32 v178, v40, v41
    v_cvt_pk_bf16_f32 v179, v42, v43
    v_mul_f32 v36, v36, v193
    v_mul_f32 v37, v37, v193
    v_mul_f32 v38, v38, v193
    v_mul_f32 v39, v39, v193
    ds_write_b128 v210, v[176:179] offset:4096
    v_mul_f32 v44, v44, v193
    v_mul_f32 v45, v45, v193
    v_mul_f32 v46, v46, v193
    v_mul_f32 v47, v47, v193
    v_cvt_pk_bf16_f32 v180, v36, v37
    v_cvt_pk_bf16_f32 v181, v38, v39
    v_cvt_pk_bf16_f32 v182, v44, v45
    v_cvt_pk_bf16_f32 v183, v46, v47
    v_mul_f32 v48, v48, v192
    v_mul_f32 v49, v49, v192
    v_mul_f32 v50, v50, v192
    v_mul_f32 v51, v51, v192
    ds_write_b128 v210, v[180:183] offset:5120
    v_mul_f32 v56, v56, v192
    v_mul_f32 v57, v57, v192
    v_mul_f32 v58, v58, v192
    v_mul_f32 v59, v59, v192
    v_cvt_pk_bf16_f32 v176, v48, v49
    v_cvt_pk_bf16_f32 v177, v50, v51
    v_cvt_pk_bf16_f32 v178, v56, v57
    v_cvt_pk_bf16_f32 v179, v58, v59
    v_mul_f32 v52, v52, v193
    v_mul_f32 v53, v53, v193
    v_mul_f32 v54, v54, v193
    v_mul_f32 v55, v55, v193
    ds_write_b128 v210, v[176:179] offset:6144
    v_mul_f32 v60, v60, v193
    v_mul_f32 v61, v61, v193
    v_mul_f32 v62, v62, v193
    v_mul_f32 v63, v63, v193
    v_cvt_pk_bf16_f32 v180, v52, v53
    v_cvt_pk_bf16_f32 v181, v54, v55
    v_cvt_pk_bf16_f32 v182, v60, v61
    v_cvt_pk_bf16_f32 v183, v62, v63
    v_mul_f32 v64, v64, v192
    v_mul_f32 v65, v65, v192
    v_mul_f32 v66, v66, v192
    v_mul_f32 v67, v67, v192
    ds_write_b128 v210, v[180:183] offset:7168
    v_mul_f32 v72, v72, v192
    v_mul_f32 v73, v73, v192
    v_mul_f32 v74, v74, v192
    v_mul_f32 v75, v75, v192
    v_cvt_pk_bf16_f32 v176, v64, v65
    v_cvt_pk_bf16_f32 v177, v66, v67
    v_cvt_pk_bf16_f32 v178, v72, v73
    v_cvt_pk_bf16_f32 v179, v74, v75
    v_mul_f32 v68, v68, v193
    v_mul_f32 v69, v69, v193
    v_mul_f32 v70, v70, v193
    v_mul_f32 v71, v71, v193
    ds_write_b128 v210, v[176:179] offset:8192
    v_mul_f32 v76, v76, v193
    v_mul_f32 v77, v77, v193
    v_mul_f32 v78, v78, v193
    v_mul_f32 v79, v79, v193
    v_cvt_pk_bf16_f32 v180, v68, v69
    v_cvt_pk_bf16_f32 v181, v70, v71
    v_cvt_pk_bf16_f32 v182, v76, v77
    v_cvt_pk_bf16_f32 v183, v78, v79
    v_mul_f32 v80, v80, v192
    v_mul_f32 v81, v81, v192
    v_mul_f32 v82, v82, v192
    v_mul_f32 v83, v83, v192
    ds_write_b128 v210, v[180:183] offset:9216
    v_mul_f32 v88, v88, v192
    v_mul_f32 v89, v89, v192
    v_mul_f32 v90, v90, v192
    v_mul_f32 v91, v91, v192
    v_cvt_pk_bf16_f32 v176, v80, v81
    v_cvt_pk_bf16_f32 v177, v82, v83
    v_cvt_pk_bf16_f32 v178, v88, v89
    v_cvt_pk_bf16_f32 v179, v90, v91
    v_mul_f32 v84, v84, v193
    v_mul_f32 v85, v85, v193
    v_mul_f32 v86, v86, v193
    v_mul_f32 v87, v87, v193
    ds_write_b128 v210, v[176:179] offset:10240
    v_mul_f32 v92, v92, v193
    v_mul_f32 v93, v93, v193
    v_mul_f32 v94, v94, v193
    v_mul_f32 v95, v95, v193
    v_cvt_pk_bf16_f32 v180, v84, v85
    v_cvt_pk_bf16_f32 v181, v86, v87
    v_cvt_pk_bf16_f32 v182, v92, v93
    v_cvt_pk_bf16_f32 v183, v94, v95
    v_mul_f32 v96, v96, v192
    v_mul_f32 v97, v97, v192
    v_mul_f32 v98, v98, v192
    v_mul_f32 v99, v99, v192
    ds_write_b128 v210, v[180:183] offset:11264
    v_mul_f32 v104, v104, v192
    v_mul_f32 v105, v105, v192
    v_mul_f32 v106, v106, v192
    v_mul_f32 v107, v107, v192
    v_cvt_pk_bf16_f32 v176, v96, v97
    v_cvt_pk_bf16_f32 v177, v98, v99
    v_cvt_pk_bf16_f32 v178, v104, v105
    v_cvt_pk_bf16_f32 v179, v106, v107
    v_mul_f32 v100, v100, v193
    v_mul_f32 v101, v101, v193
    v_mul_f32 v102, v102, v193
    v_mul_f32 v103, v103, v193
    ds_write_b128 v210, v[176:179] offset:12288
    v_mul_f32 v108, v108, v193
    v_mul_f32 v109, v109, v193
    v_mul_f32 v110, v110, v193
    v_mul_f32 v111, v111, v193
    v_cvt_pk_bf16_f32 v180, v100, v101
    v_cvt_pk_bf16_f32 v181, v102, v103
    v_cvt_pk_bf16_f32 v182, v108, v109
    v_cvt_pk_bf16_f32 v183, v110, v111
    v_mul_f32 v112, v112, v192
    v_mul_f32 v113, v113, v192
    v_mul_f32 v114, v114, v192
    v_mul_f32 v115, v115, v192
    ds_write_b128 v210, v[180:183] offset:13312
    v_mul_f32 v120, v120, v192
    v_mul_f32 v121, v121, v192
    v_mul_f32 v122, v122, v192
    v_mul_f32 v123, v123, v192
    v_cvt_pk_bf16_f32 v176, v112, v113
    v_cvt_pk_bf16_f32 v177, v114, v115
    v_cvt_pk_bf16_f32 v178, v120, v121
    v_cvt_pk_bf16_f32 v179, v122, v123
    v_mul_f32 v116, v116, v193
    v_mul_f32 v117, v117, v193
    v_mul_f32 v118, v118, v193
    v_mul_f32 v119, v119, v193
    ds_write_b128 v210, v[176:179] offset:14336
    v_mul_f32 v124, v124, v193
    v_mul_f32 v125, v125, v193
    v_mul_f32 v126, v126, v193
    v_mul_f32 v127, v127, v193
    v_cvt_pk_bf16_f32 v180, v116, v117
    v_cvt_pk_bf16_f32 v181, v118, v119
    v_cvt_pk_bf16_f32 v182, v124, v125
    v_cvt_pk_bf16_f32 v183, v126, v127
    ds_write_b128 v210, v[180:183] offset:15360
    s_mov_b32 m0, s87
    s_mov_b32 s82, s88
    s_waitcnt vmcnt(0) lgkmcnt(0)
    s_branch L_back
L_code_end:
.section .rodata,"a"
.p2align 6
.amdhsa_kernel recurrent_scan__sliding_block_cached__dense_activation_gelu__prompt_kernel
  .amdhsa_next_free_vgpr 512
  .amdhsa_next_free_sgpr 102
  .amdhsa_accum_offset 256
  .amdhsa_group_segment_fixed_size 0
  .amdhsa_kernarg_size 104
  .amdhsa_user_sgpr_count 2
  .amdhsa_user_sgpr_kernarg_segment_ptr 1
  .amdhsa_system_sgpr_workgroup_id_x 1
  .amdhsa_float_denorm_mode_32 3
.end_amdhsa_kernel
```
